```python
import torch

def _softmax(x, axis=-1):
    return torch.softmax(x, dim=axis)
def _gelu(x):
    return torch.nn.functional.gelu(x, approximate="tanh")
def _silu(x):
    return torch.nn.functional.silu(x)
def _sigmoid(x):
    return torch.sigmoid(x)
def _layernorm(x, axis=-1, eps=1e-5):
    m = x.mean(dim=axis, keepdim=True)
    v = x.var(dim=axis, keepdim=True, unbiased=False)
    return (x - m) / torch.sqrt(v + eps)
def _scatter_add(tgt, idx, src, axis=0):
    return tgt.clone().index_add_(axis, idx, src)
def _segment_sum(src, seg, n):
    out = torch.zeros((n,) + src.shape[1:], dtype=src.dtype)
    return out.index_add_(0, seg, src)
def _pad(x, pw):
    flat = tuple(v for pair in reversed(pw) for v in pair)
    return torch.nn.functional.pad(x, flat)

kernel_name = 'interleave_layers__ssm_conv_h3__mixer_s_mlp__prompt'

def setup_inputs():

    _w = (lambda a: (lambda t: t.to(torch.bfloat16) if t.is_floating_point() else t)(torch.as_tensor(a)))
    def _A_setup():
        B, S, D = 1, 2048, 640
        ks = 4
        return {
            "q": _w((lambda *s: torch.randn(*s, dtype=torch.bfloat16) * 0.05)(B, S, D)),
            "k": _w((lambda *s: torch.randn(*s, dtype=torch.bfloat16) * 0.8)(B, S, D)),
            "v": _w((lambda *s: torch.randn(*s, dtype=torch.bfloat16) * 0.8)(B, S, D)),
            "shift_k": _w((lambda *s: torch.randn(*s, dtype=torch.bfloat16) * 0.8)(D, ks) * 0.5),
            "ssm_k": _w((lambda *s: torch.randn(*s, dtype=torch.bfloat16) * 0.8)(D, S) * (1.0 / S ** 0.5)),
            "ssm_D": _w((lambda *s: torch.randn(*s, dtype=torch.bfloat16) * 0.8)(D)),
        }
    _A_in = _A_setup()

    def _B_setup():
        B, S, D, F = 1, 2048, 640, 1536
        return {
            "x":  _w((lambda *s: torch.randn(*s, dtype=torch.bfloat16) * 0.05)(B, S, D)),
            "w1": _w((lambda *s: torch.randn(*s, dtype=torch.bfloat16) * 3.2)(D, D) * (D ** -0.5)),
            "w2": _w((lambda *s: torch.randn(*s, dtype=torch.bfloat16) * 3.2)(D, D) * (D ** -0.5)),
            "w3": _w((lambda *s: torch.randn(*s, dtype=torch.bfloat16) * 3.2)(D, F) * (D ** -0.5)),
            "w4": _w((lambda *s: torch.randn(*s, dtype=torch.bfloat16) * 3.2)(F, D) * (F ** -0.5)),
        }
    _B_in = _B_setup()

    return {
        "A_q": _A_in["q"],
        "A_k": _A_in["k"],
        "A_v": _A_in["v"],
        "A_shift_k": _A_in["shift_k"],
        "A_ssm_k": _A_in["ssm_k"],
        "A_ssm_D": _A_in["ssm_D"],
        "B_x": _B_in["x"],
        "B_w1": _B_in["w1"],
        "B_w2": _B_in["w2"],
        "B_w3": _B_in["w3"],
        "B_w4": _B_in["w4"],
    }

def reference(A_q, A_k, A_v, A_shift_k, A_ssm_k, A_ssm_D, B_x, B_w1, B_w2, B_w3, B_w4):
    def _A_ref(q, k, v, shift_k, ssm_k, ssm_D):
        B, S, D = q.shape
        ks = shift_k.shape[-1]
        k_pad = _pad(k, ((0, 0), (ks - 1, 0), (0, 0)))
        k_shift = torch.zeros_like(k)
        for t in range(ks):
            k_shift = k_shift + k_pad[:, t:t + S, :] * shift_k[:, ks - 1 - t][None, None, :]
        kv = k_shift * v
        L = 2 * S
        kv_pad = _pad(kv, ((0, 0), (0, S), (0, 0)))
        kf_pad = _pad(ssm_k, ((0, 0), (0, S)))
        kv_f = (lambda x, axes=(-2,-1): torch.fft.rfft2(x.float(), dim=axes))(kv_pad[:, None, :, :], axes=(1, 2))
        kf_f = (lambda x, axes=(-2,-1): torch.fft.rfft2(x.float(), dim=axes))(kf_pad[:, None, :], axes=(1, 2))
        kf_f = (lambda x, *d: x.permute(*d))(kf_f, 1, 2, 0)
        y_f = kv_f * kf_f[None, :, :, :]
        y = (lambda x, s, axes=(-2,-1): torch.fft.irfft2(x, s=s, dim=axes).to(torch.bfloat16))(y_f, (1, L), axes=(1, 2))[:, 0, :S, :]
        y = y + kv * ssm_D[None, None, :]
        return q * y

    def _B_ref(x, w1, w2, w3, w4):
        B, S, D = x.shape
        h = _gelu(_layernorm(x, axis=-1) @ w1)
        c = D // 4
        g0 = _pad(h[:, :, 0*c:1*c], ((0, 0), (1, 0), (0, 0)))[:, :S, :]
        g1 = _pad(h[:, :, 1*c:2*c], ((0, 0), (0, 1), (0, 0)))[:, 1:, :]
        g2 = _pad(h[:, :, 2*c:3*c], ((0, 0), (2, 0), (0, 0)))[:, :S, :]
        g3 = _pad(h[:, :, 3*c:   ], ((0, 0), (0, 2), (0, 0)))[:, 2:, :]
        hs = torch.concatenate([g0, g1, g2, g3], axis=-1) @ w2
        x1 = x + hs
        h2 = _gelu(_layernorm(x1, axis=-1) @ w3) @ w4
        return x1 + h2

    x = A_q
    x = x + _A_ref(_layernorm(x, axis=-1), A_k, A_v, A_shift_k, A_ssm_k, A_ssm_D)
    x = x + _B_ref(_layernorm(x, axis=-1), B_w1, B_w2, B_w3, B_w4)
    x = x + _A_ref(_layernorm(x, axis=-1), A_k, A_v, A_shift_k, A_ssm_k, A_ssm_D)
    x = x + _B_ref(_layernorm(x, axis=-1), B_w1, B_w2, B_w3, B_w4)
    return x
```

```asm
; @launch grid=(256,1,1) block=(512,1,1) lds=161536
.amdgcn_target "amdgcn-amd-amdhsa--gfx950"
.text
.globl interleave_layers__ssm_conv_h3__mixer_s_mlp__prompt_kernel
.p2align 8
.type interleave_layers__ssm_conv_h3__mixer_s_mlp__prompt_kernel,@function
interleave_layers__ssm_conv_h3__mixer_s_mlp__prompt_kernel:

s_cmp_ge_u32 s2, 256
s_cbranch_scc1 F_end
s_load_dwordx4 s[4:7], s[0:1], 96
s_load_dwordx8 s[8:15], s[0:1], 8
s_load_dwordx2 s[16:17], s[0:1], 40
s_load_dwordx8 s[84:91], s[0:1], 56
s_load_dwordx2 s[92:93], s[0:1], 0
v_lshrrev_b32 v1, 6, v0
v_and_b32 v2, 63, v0
v_lshlrev_b32 v3, 4, v2
v_readfirstlane_b32 s28, v1
s_getpc_b64 s[56:57]
F_pc:
s_lshr_b32 s58, s2, 3
s_and_b32 s58, s58, 7
s_lshl_b32 s58, s58, 3
s_add_u32 s58, s58, s28
s_lshl_b32 s58, s58, 7
s_min_u32 s58, s58, F_last-F_pc-4
v_mov_b32 v4, s58
global_load_dword v137, v4, s[56:57] sc1
s_and_b32 s50, s2, 7
s_lshr_b32 s51, s2, 3
s_lshl_b32 s29, s51, 3
s_add_u32 s29, s29, s28
s_mul_i32 s31, s29, 10240
s_mul_i32 s30, s50, 160
s_add_u32 s31, s31, s30
v_lshlrev_b32 v5, 2, v2
v_add_u32 v7, s31, v5
v_subrev_u32 v8, 3840, v7
s_mul_i32 s33, s50, 640
s_mov_b32 s32, 5120
s_lshl_b32 s55, s50, 8
s_add_u32 s55, s55, s29
s_mul_i32 s55, s55, 1280
s_add_u32 s55, s55, 0
v_min_u32 v10, 9, v2
v_lshlrev_b32 v10, 7, v10
s_lshl_b32 s34, s2, 3
s_add_u32 s34, s34, s28
v_mov_b32 v4, 0x80808080
v_add_u32 v6, 160512, v5
ds_write_b32 v6, v4
s_waitcnt lgkmcnt(0)
s_mov_b32 s24, s6
s_and_b32 s25, s7, 0xffff
s_mov_b32 s26, 0x10000000
s_mov_b32 s27, 0x00020000
s_mov_b32 s20, s8
s_and_b32 s21, s9, 0xffff
s_mov_b32 s22, 0x280000
s_mov_b32 s23, 0x00020000
s_cmp_lg_u32 s34, 7
s_cbranch_scc1 F_nz0
s_mov_b32 s35, 11520000
buffer_load_dwordx4 v[104:107], v3, s[24:27], s35 offen offset:0 sc1
buffer_load_dwordx4 v[108:111], v3, s[24:27], s35 offen offset:1024 sc1
buffer_load_dwordx4 v[112:115], v3, s[24:27], s35 offen offset:2048 sc1
v_lshrrev_b32 v4, 3, v2
v_lshlrev_b32 v4, 7, v4
v_and_b32 v6, 7, v2
v_lshl_add_u32 v4, v6, 3, v4
s_mov_b32 s35, 11526144
buffer_load_dwordx2 v[116:117], v4, s[24:27], s35 offen sc1
F_nz0:
s_mul_i32 s48, s50, 384
s_add_u32 s48, s48, 11520000
s_cmp_lg_u32 s28, 7
s_cbranch_scc1 F_nz3
buffer_load_dword v102, off, s[24:27], s48 sc1
F_nz3:
s_lshl_b32 s35, s51, 3
s_add_u32 s35, s35, s28
s_cmp_lg_u32 s35, 6
s_cbranch_scc1 F_nz2
s_lshl_b32 s35, s50, 8
s_add_u32 s35, s35, 11524096
v_mov_b32 v120, 0
v_mov_b32 v121, 0
v_mov_b32 v122, 0
v_mov_b32 v123, 0
buffer_store_dword v120, v5, s[24:27], s35 offen sc1
s_lshl_b32 s35, s50, 10
s_add_u32 s35, s35, 11530240
buffer_store_dwordx4 v[120:123], v3, s[24:27], s35 offen sc1
F_nz2:
s_mov_b32 exec_hi, 0xff
buffer_load_dword v16, v8, s[20:23], 0 offen offset:0
buffer_load_dword v17, v8, s[20:23], 0 offen offset:1280
buffer_load_dword v18, v8, s[20:23], 0 offen offset:2560
s_mov_b32 s36, s10
s_and_b32 s37, s11, 0xffff
s_mov_b32 s38, 0x280000
s_mov_b32 s39, 0x00020000
s_mov_b32 s40, s12
s_and_b32 s41, s13, 0xffff
s_mov_b32 s42, 0x1400
s_mov_b32 s43, 0x00020000
buffer_load_dwordx4 v[12:15], v3, s[40:43], s33 offen
buffer_load_dword v19, v7, s[20:23], 0 offen offset:0
buffer_load_dword v27, v7, s[36:39], 0 offen offset:0
buffer_load_dword v20, v7, s[20:23], 0 offen offset:1280
buffer_load_dword v28, v7, s[36:39], 0 offen offset:1280
buffer_load_dword v21, v7, s[20:23], 0 offen offset:2560
buffer_load_dword v29, v7, s[36:39], 0 offen offset:2560
buffer_load_dword v22, v7, s[20:23], 0 offen offset:3840
buffer_load_dword v30, v7, s[36:39], 0 offen offset:3840
buffer_load_dword v23, v7, s[20:23], s32 offen offset:0
buffer_load_dword v31, v7, s[36:39], s32 offen offset:0
buffer_load_dword v24, v7, s[20:23], s32 offen offset:1280
buffer_load_dword v32, v7, s[36:39], s32 offen offset:1280
buffer_load_dword v25, v7, s[20:23], s32 offen offset:2560
buffer_load_dword v33, v7, s[36:39], s32 offen offset:2560
buffer_load_dword v26, v7, s[20:23], s32 offen offset:3840
buffer_load_dword v34, v7, s[36:39], s32 offen offset:3840
s_mov_b64 exec, -1
buffer_load_dword v35, v10, s[24:27], s55 offen sc1
s_mov_b32 s44, s4
s_and_b32 s45, s5, 0xffff
s_mov_b32 s46, 0x100
s_mov_b32 s47, 0x00020000
s_mul_i32 s33, s28, 1280
s_add_u32 s33, s33, 65536
v_lshlrev_b32 v10, 5, v2
v_add_u32 v10, s33, v10
v_add_u32 v11, s33, v3
s_mul_i32 s54, s50, 20
s_add_u32 s54, s54, s51
s_lshl_b32 s52, s54, 2
s_add_u32 s52, s52, s28
s_lshl_b32 s53, s52, 12
s_mov_b32 s49, 400000
s_cmp_lg_u32 s34, 7
s_cbranch_scc1 F_nz1
v_mov_b32 v4, 0
v_add_u32 v6, 81920, v5
ds_write_b32 v6, v4
v_mov_b32 v4, 1
s_waitcnt vmcnt(22)
v_bfe_u32 v98, v104, 5, 5
v_lshlrev_b32 v98, 2, v98
v_add_u32 v98, 81920, v98
v_lshlrev_b32 v99, v104, v4
ds_or_b32 v98, v99
v_bfe_u32 v98, v105, 5, 5
v_lshlrev_b32 v98, 2, v98
v_add_u32 v98, 81920, v98
v_lshlrev_b32 v99, v105, v4
ds_or_b32 v98, v99
v_bfe_u32 v98, v106, 5, 5
v_lshlrev_b32 v98, 2, v98
v_add_u32 v98, 81920, v98
v_lshlrev_b32 v99, v106, v4
ds_or_b32 v98, v99
v_bfe_u32 v98, v107, 5, 5
v_lshlrev_b32 v98, 2, v98
v_add_u32 v98, 81920, v98
v_lshlrev_b32 v99, v107, v4
ds_or_b32 v98, v99
v_bfe_u32 v98, v108, 5, 5
v_lshlrev_b32 v98, 2, v98
v_add_u32 v98, 81920, v98
v_lshlrev_b32 v99, v108, v4
ds_or_b32 v98, v99
v_bfe_u32 v98, v109, 5, 5
v_lshlrev_b32 v98, 2, v98
v_add_u32 v98, 81920, v98
v_lshlrev_b32 v99, v109, v4
ds_or_b32 v98, v99
v_bfe_u32 v98, v110, 5, 5
v_lshlrev_b32 v98, 2, v98
v_add_u32 v98, 81920, v98
v_lshlrev_b32 v99, v110, v4
ds_or_b32 v98, v99
v_bfe_u32 v98, v111, 5, 5
v_lshlrev_b32 v98, 2, v98
v_add_u32 v98, 81920, v98
v_lshlrev_b32 v99, v111, v4
ds_or_b32 v98, v99
v_bfe_u32 v98, v112, 5, 5
v_lshlrev_b32 v98, 2, v98
v_add_u32 v98, 81920, v98
v_lshlrev_b32 v99, v112, v4
ds_or_b32 v98, v99
v_bfe_u32 v98, v113, 5, 5
v_lshlrev_b32 v98, 2, v98
v_add_u32 v98, 81920, v98
v_lshlrev_b32 v99, v113, v4
ds_or_b32 v98, v99
v_bfe_u32 v98, v114, 5, 5
v_lshlrev_b32 v98, 2, v98
v_add_u32 v98, 81920, v98
v_lshlrev_b32 v99, v114, v4
ds_or_b32 v98, v99
v_bfe_u32 v98, v115, 5, 5
v_lshlrev_b32 v98, 2, v98
v_add_u32 v98, 81920, v98
v_lshlrev_b32 v99, v115, v4
ds_or_b32 v98, v99
v_bfe_u32 v98, v116, 5, 5
v_lshlrev_b32 v98, 2, v98
v_add_u32 v98, 81920, v98
v_lshlrev_b32 v99, v116, v4
ds_or_b32 v98, v99
v_bfe_u32 v98, v117, 5, 5
v_lshlrev_b32 v98, 2, v98
v_add_u32 v98, 81920, v98
v_lshlrev_b32 v99, v117, v4
ds_or_b32 v98, v99
ds_read_b32 v98, v6
s_waitcnt lgkmcnt(0)
v_not_b32 v98, v98
v_ffbl_b32 v99, v98
v_cmp_ne_u32 vcc, 0, v98
v_lshl_add_u32 v99, v2, 5, v99
s_nop 2
s_ff1_i32_b64 s35, vcc
s_nop 3
v_readlane_b32 s35, v99, s35
s_nop 1
s_or_b32 s35, s35, 0x400
v_mov_b32 v99, s35
s_mov_b64 exec, 1
buffer_store_dword v99, off, s[44:47], 0 sc1
s_mov_b64 exec, -1
F_nz1:
s_waitcnt vmcnt(17)
v_lshlrev_b32 v74, 16, v12
v_lshlrev_b32 v75, 16, v14
v_and_b32 v76, 0xffff0000, v12
v_and_b32 v77, 0xffff0000, v14
v_lshlrev_b32 v78, 16, v13
v_lshlrev_b32 v79, 16, v15
v_and_b32 v80, 0xffff0000, v13
v_and_b32 v81, 0xffff0000, v15
v_lshlrev_b32 v36, 16, v16
v_and_b32 v37, 0xffff0000, v16
v_lshlrev_b32 v38, 16, v17
v_and_b32 v39, 0xffff0000, v17
v_lshlrev_b32 v40, 16, v18
v_and_b32 v41, 0xffff0000, v18
s_waitcnt vmcnt(15)
v_lshlrev_b32 v42, 16, v19
v_and_b32 v43, 0xffff0000, v19
v_lshlrev_b32 v58, 16, v27
v_and_b32 v59, 0xffff0000, v27
v_pk_mul_f32 v[82:83], v[36:37], v[80:81]
v_pk_fma_f32 v[82:83], v[38:39], v[78:79], v[82:83]
v_pk_fma_f32 v[82:83], v[40:41], v[76:77], v[82:83]
v_pk_fma_f32 v[82:83], v[42:43], v[74:75], v[82:83]
v_pk_mul_f32 v[82:83], v[82:83], v[58:59]
s_waitcnt vmcnt(13)
v_lshlrev_b32 v44, 16, v20
v_and_b32 v45, 0xffff0000, v20
v_lshlrev_b32 v60, 16, v28
v_and_b32 v61, 0xffff0000, v28
v_pk_mul_f32 v[84:85], v[38:39], v[80:81]
v_pk_fma_f32 v[84:85], v[40:41], v[78:79], v[84:85]
v_pk_fma_f32 v[84:85], v[42:43], v[76:77], v[84:85]
v_pk_fma_f32 v[84:85], v[44:45], v[74:75], v[84:85]
v_pk_mul_f32 v[84:85], v[84:85], v[60:61]
s_waitcnt vmcnt(11)
v_lshlrev_b32 v46, 16, v21
v_and_b32 v47, 0xffff0000, v21
v_lshlrev_b32 v62, 16, v29
v_and_b32 v63, 0xffff0000, v29
v_pk_mul_f32 v[86:87], v[40:41], v[80:81]
v_pk_fma_f32 v[86:87], v[42:43], v[78:79], v[86:87]
v_pk_fma_f32 v[86:87], v[44:45], v[76:77], v[86:87]
v_pk_fma_f32 v[86:87], v[46:47], v[74:75], v[86:87]
v_pk_mul_f32 v[86:87], v[86:87], v[62:63]
s_waitcnt vmcnt(9)
v_lshlrev_b32 v48, 16, v22
v_and_b32 v49, 0xffff0000, v22
v_lshlrev_b32 v64, 16, v30
v_and_b32 v65, 0xffff0000, v30
v_pk_mul_f32 v[88:89], v[42:43], v[80:81]
v_pk_fma_f32 v[88:89], v[44:45], v[78:79], v[88:89]
v_pk_fma_f32 v[88:89], v[46:47], v[76:77], v[88:89]
v_pk_fma_f32 v[88:89], v[48:49], v[74:75], v[88:89]
v_pk_mul_f32 v[88:89], v[88:89], v[64:65]
s_waitcnt vmcnt(7)
v_lshlrev_b32 v50, 16, v23
v_and_b32 v51, 0xffff0000, v23
v_lshlrev_b32 v66, 16, v31
v_and_b32 v67, 0xffff0000, v31
v_pk_mul_f32 v[90:91], v[44:45], v[80:81]
v_pk_fma_f32 v[90:91], v[46:47], v[78:79], v[90:91]
v_pk_fma_f32 v[90:91], v[48:49], v[76:77], v[90:91]
v_pk_fma_f32 v[90:91], v[50:51], v[74:75], v[90:91]
v_pk_mul_f32 v[90:91], v[90:91], v[66:67]
s_waitcnt vmcnt(5)
v_lshlrev_b32 v52, 16, v24
v_and_b32 v53, 0xffff0000, v24
v_lshlrev_b32 v68, 16, v32
v_and_b32 v69, 0xffff0000, v32
v_pk_mul_f32 v[92:93], v[46:47], v[80:81]
v_pk_fma_f32 v[92:93], v[48:49], v[78:79], v[92:93]
v_pk_fma_f32 v[92:93], v[50:51], v[76:77], v[92:93]
v_pk_fma_f32 v[92:93], v[52:53], v[74:75], v[92:93]
v_pk_mul_f32 v[92:93], v[92:93], v[68:69]
s_waitcnt vmcnt(3)
v_lshlrev_b32 v54, 16, v25
v_and_b32 v55, 0xffff0000, v25
v_lshlrev_b32 v70, 16, v33
v_and_b32 v71, 0xffff0000, v33
v_pk_mul_f32 v[94:95], v[48:49], v[80:81]
v_pk_fma_f32 v[94:95], v[50:51], v[78:79], v[94:95]
v_pk_fma_f32 v[94:95], v[52:53], v[76:77], v[94:95]
v_pk_fma_f32 v[94:95], v[54:55], v[74:75], v[94:95]
v_pk_mul_f32 v[94:95], v[94:95], v[70:71]
s_waitcnt vmcnt(1)
v_lshlrev_b32 v56, 16, v26
v_and_b32 v57, 0xffff0000, v26
v_lshlrev_b32 v72, 16, v34
v_and_b32 v73, 0xffff0000, v34
v_pk_mul_f32 v[96:97], v[50:51], v[80:81]
v_pk_fma_f32 v[96:97], v[52:53], v[78:79], v[96:97]
v_pk_fma_f32 v[96:97], v[54:55], v[76:77], v[96:97]
v_pk_fma_f32 v[96:97], v[56:57], v[74:75], v[96:97]
v_pk_mul_f32 v[96:97], v[96:97], v[72:73]
s_waitcnt vmcnt(0)
s_cmp_lg_u32 s28, 7
s_cbranch_scc1 F_kvd
buffer_load_dword v101, off, s[44:47], 0 sc1
F_kvd:
s_mov_b32 exec_hi, 0xff
v_cvt_pk_bf16_f32 v12, v96, v94
v_cvt_pk_bf16_f32 v13, v92, v90
v_cvt_pk_bf16_f32 v14, v88, v86
v_cvt_pk_bf16_f32 v15, v84, v82
ds_write_b128 v10, v[12:15] offset:0
v_cvt_pk_bf16_f32 v16, v97, v95
v_cvt_pk_bf16_f32 v17, v93, v91
v_cvt_pk_bf16_f32 v18, v89, v87
v_cvt_pk_bf16_f32 v19, v85, v83
ds_write_b128 v10, v[16:19] offset:16
s_mov_b64 exec, -1
ds_read_b128 v[20:23], v11
ds_read_b128 v[24:27], v11 offset:1024
s_waitcnt lgkmcnt(1)
buffer_store_dwordx4 v[20:23], v3, s[24:27], s55 offen
s_mov_b64 exec, 0xffff
s_waitcnt lgkmcnt(0)
buffer_store_dwordx4 v[24:27], v3, s[24:27], s55 offen offset:1024
s_mov_b64 exec, -1
s_cmp_eq_u32 s28, 7
s_cbranch_scc1 F_w7
s_cmp_ge_u32 s51, 20
s_cbranch_scc1 F_other
s_cmp_ge_u32 s28, 4
s_cbranch_scc1 F_hi
s_mov_b32 s20, s14
s_and_b32 s21, s15, 0xffff
s_mov_b32 s22, 0x280000
s_mov_b32 s23, 0x00020000
s_mov_b32 s36, s16
s_and_b32 s37, s17, 0xffff
s_mov_b32 s38, 0x500
s_mov_b32 s39, 0x00020000
s_lshl_b32 s33, s52, 1
s_waitcnt vmcnt(0)
s_barrier
buffer_load_dwordx4 v[104:107], v3, s[20:23], s53 offen offset:0
buffer_load_dword v108, v3, s[20:23], s53 offen offset:16
buffer_load_dwordx4 v[112:115], v3, s[20:23], s53 offen offset:1024
buffer_load_dword v116, v3, s[20:23], s53 offen offset:1040
buffer_load_dwordx4 v[120:123], v3, s[20:23], s53 offen offset:2048
buffer_load_dword v124, v3, s[20:23], s53 offen offset:2064
buffer_load_dwordx4 v[128:131], v3, s[20:23], s53 offen offset:3072
buffer_load_dword v132, v3, s[20:23], s53 offen offset:3088
buffer_load_ushort v136, off, s[36:39], s33
v_lshrrev_b32 v8, 3, v2
v_and_b32 v9, 7, v2
v_xor_b32 v9, v9, v8
v_mul_u32_u24 v8, 2560, v8
v_and_b32 v4, 1, v9
v_mul_u32_u24 v4, 1280, v4
v_lshrrev_b32 v9, 1, v9
v_lshl_add_u32 v8, v9, 4, v8
v_add_u32 v8, v8, v4
s_mul_i32 s60, s50, 327680
s_mul_i32 s32, s28, 40960
s_add_u32 s60, s60, s32
s_lshl_b32 s32, s51, 6
s_add_u32 s60, s60, s32
s_add_u32 s60, s60, 0
s_lshl_b32 s61, s28, 11
s_mul_i32 s40, s28, 8320
s_add_u32 s40, s40, 120960
v_and_b32 v4, 15, v2
v_lshrrev_b32 v5, 4, v2
v_lshrrev_b32 v6, 1, v5
v_and_b32 v7, 1, v5
v_mov_b32 v12, 0
v_mov_b32 v13, 0
v_mov_b32 v14, 0
v_mov_b32 v15, 0
v_add_u32 v10, s40, v3
s_mul_i32 s32, s28, 544
s_add_u32 s32, s32, 102400
v_add_u32 v11, s32, v3
s_mov_b32 exec_hi, 3
ds_write_b128 v11, v[12:15]
s_mov_b64 exec, 3
ds_write_b128 v10, v[12:15]
s_mov_b64 exec, -1
v_lshlrev_b32 v11, 4, v6
v_add_u32 v11, v11, v4
v_lshlrev_b32 v16, 3, v7
v_sub_u32 v11, v11, v16
v_add_u32 v11, 9, v11
v_and_b32 v16, 1, v11
v_lshrrev_b32 v11, 1, v11
v_lshlrev_b32 v11, 2, v11
v_mul_u32_u24 v16, 4160, v16
v_add_u32 v11, v11, v16
v_add_u32 v60, s40, v11
v_add_u32 v61, 1024, v60
v_add_u32 v62, 2048, v60
v_add_u32 v63, 3072, v60
v_sub_u32 v66, v4, v6
v_add_u32 v66, 24, v66
s_lshl_b32 s32, s28, 1
v_add_u32 v67, s32, v7
v_and_b32 v16, 7, v66
v_xor_b32 v16, v16, v67
v_lshlrev_b32 v16, 4, v16
v_lshl_add_u32 v16, v66, 7, v16
v_add_u32 v64, 101504, v16
v_subrev_u32 v66, 2, v66
v_lshrrev_b32 v65, 2, v4
v_mul_u32_u24 v65, 81920, v65
v_and_b32 v16, 3, v4
v_lshl_add_u32 v65, v16, 5, v65
v_lshl_add_u32 v65, v6, 4, v65
v_mul_u32_u24 v16, 327680, v7
v_add_u32 v65, v65, v16
s_waitcnt vmcnt(0)
ds_write_b128 v10, v[104:107] offset:32
v_readfirstlane_b32 s34, v104
v_alignbit_b32 v52, v105, v104, 16
v_alignbit_b32 v53, v106, v105, 16
v_alignbit_b32 v54, v107, v106, 16
v_alignbit_b32 v55, v108, v107, 16
ds_write_b128 v10, v[52:55] offset:4192
s_lshl_b32 s34, s34, 16
v_mov_b32 v19, s34
v_cmp_eq_u32 vcc, 1, v2
v_mov_b32 v16, 0
v_mov_b32 v17, 0
v_mov_b32 v18, 0
v_cndmask_b32 v19, 0, v19, vcc
s_mov_b64 exec, 3
ds_write_b128 v10, v[16:19] offset:4160
s_mov_b64 exec, -1
ds_write_b128 v10, v[112:115] offset:1056
v_alignbit_b32 v52, v113, v112, 16
v_alignbit_b32 v53, v114, v113, 16
v_alignbit_b32 v54, v115, v114, 16
v_alignbit_b32 v55, v116, v115, 16
ds_write_b128 v10, v[52:55] offset:5216
ds_write_b128 v10, v[120:123] offset:2080
v_alignbit_b32 v52, v121, v120, 16
v_alignbit_b32 v53, v122, v121, 16
v_alignbit_b32 v54, v123, v122, 16
v_alignbit_b32 v55, v124, v123, 16
ds_write_b128 v10, v[52:55] offset:6240
ds_write_b128 v10, v[128:131] offset:3104
v_alignbit_b32 v52, v129, v128, 16
v_alignbit_b32 v53, v130, v129, 16
v_alignbit_b32 v54, v131, v130, 16
v_alignbit_b32 v55, v132, v131, 16
ds_write_b128 v10, v[52:55] offset:7264
ds_read2_b32 v[164:165], v60 offset0:0 offset1:1
ds_read2_b32 v[166:167], v60 offset0:2 offset1:3
ds_read2_b32 v[168:169], v60 offset0:128 offset1:129
ds_read2_b32 v[170:171], v60 offset0:130 offset1:131
ds_read2_b32 v[172:173], v61 offset0:0 offset1:1
ds_read2_b32 v[174:175], v61 offset0:2 offset1:3
ds_read2_b32 v[176:177], v61 offset0:128 offset1:129
ds_read2_b32 v[178:179], v61 offset0:130 offset1:131
ds_read2_b32 v[180:181], v62 offset0:0 offset1:1
ds_read2_b32 v[182:183], v62 offset0:2 offset1:3
ds_read2_b32 v[184:185], v62 offset0:128 offset1:129
ds_read2_b32 v[186:187], v62 offset0:130 offset1:131
ds_read2_b32 v[188:189], v63 offset0:0 offset1:1
ds_read2_b32 v[190:191], v63 offset0:2 offset1:3
ds_read2_b32 v[192:193], v63 offset0:128 offset1:129
ds_read2_b32 v[194:195], v63 offset0:130 offset1:131
v_and_b32 v18, 7, v4
v_sub_u32 v18, 7, v18
v_and_b32 v17, 1, v18
v_lshlrev_b32 v17, 4, v17
v_lshlrev_b32 v9, v17, v136
v_lshrrev_b32 v18, 1, v18
v_lshrrev_b32 v17, 3, v4
v_cmp_eq_u32 vcc, v17, v5
s_nop 1
v_cndmask_b32 v9, 0, v9, vcc
v_cmp_eq_u32 vcc, 0, v18
s_nop 1
v_cndmask_b32 v56, 0, v9, vcc
v_cmp_eq_u32 vcc, 1, v18
s_nop 1
v_cndmask_b32 v57, 0, v9, vcc
v_cmp_eq_u32 vcc, 2, v18
s_nop 1
v_cndmask_b32 v58, 0, v9, vcc
v_cmp_eq_u32 vcc, 3, v18
s_nop 1
v_cndmask_b32 v59, 0, v9, vcc
s_barrier
s_add_u32 m0, s61, 104576
s_add_u32 s32, s60, 0
buffer_load_dwordx4 v8, s[24:27], s32 offen sc1 lds
s_add_u32 m0, s61, 105600
s_add_u32 s32, s60, 20480
buffer_load_dwordx4 v8, s[24:27], s32 offen sc1 lds
s_waitcnt vmcnt(0) lgkmcnt(0)
s_barrier
ds_read_b128 v[196:199], v64 offset:0
ds_read_b128 v[200:203], v64 offset:2048
ds_read_b128 v[204:207], v64 offset:4096
ds_read_b128 v[208:211], v64 offset:6144
ds_read_b128 v[212:215], v64 offset:8192
ds_read_b128 v[216:219], v64 offset:10240
ds_read_b128 v[220:223], v64 offset:12288
ds_read_b128 v[224:227], v64 offset:14336
v_add_u32 v60, 64, v60
v_add_u32 v61, 64, v61
v_add_u32 v62, 64, v62
v_add_u32 v63, 64, v63
v_and_b32 v16, 7, v66
v_xor_b32 v16, v16, v67
v_lshlrev_b32 v16, 4, v16
v_lshl_add_u32 v16, v66, 7, v16
v_add_u32 v64, 101504, v16
v_subrev_u32 v66, 2, v66
s_waitcnt lgkmcnt(0)
v_mfma_f32_16x16x32_bf16 v[68:71], v[56:59], v[196:199], 0
v_mfma_f32_16x16x32_bf16 v[72:75], v[56:59], v[200:203], 0
v_mfma_f32_16x16x32_bf16 v[76:79], v[56:59], v[204:207], 0
v_mfma_f32_16x16x32_bf16 v[80:83], v[56:59], v[208:211], 0
v_mfma_f32_16x16x32_bf16 v[84:87], v[56:59], v[212:215], 0
v_mfma_f32_16x16x32_bf16 v[88:91], v[56:59], v[216:219], 0
v_mfma_f32_16x16x32_bf16 v[92:95], v[56:59], v[220:223], 0
v_mfma_f32_16x16x32_bf16 v[96:99], v[56:59], v[224:227], 0
s_mov_b32 s35, 0
F_loop:
v_mfma_f32_16x16x32_bf16 v[68:71], v[164:167], v[196:199], v[68:71]
ds_read_b128 v[132:135], v64 offset:0
v_mfma_f32_16x16x32_bf16 v[72:75], v[164:167], v[200:203], v[72:75]
ds_read_b128 v[136:139], v64 offset:2048
v_mfma_f32_16x16x32_bf16 v[76:79], v[164:167], v[204:207], v[76:79]
ds_read_b128 v[140:143], v64 offset:4096
v_mfma_f32_16x16x32_bf16 v[80:83], v[164:167], v[208:211], v[80:83]
ds_read_b128 v[144:147], v64 offset:6144
v_mfma_f32_16x16x32_bf16 v[84:87], v[164:167], v[212:215], v[84:87]
ds_read_b128 v[148:151], v64 offset:8192
v_mfma_f32_16x16x32_bf16 v[88:91], v[164:167], v[216:219], v[88:91]
ds_read_b128 v[152:155], v64 offset:10240
v_mfma_f32_16x16x32_bf16 v[92:95], v[164:167], v[220:223], v[92:95]
ds_read_b128 v[156:159], v64 offset:12288
v_mfma_f32_16x16x32_bf16 v[96:99], v[164:167], v[224:227], v[96:99]
ds_read_b128 v[160:163], v64 offset:14336
v_mfma_f32_16x16x32_bf16 v[72:75], v[168:171], v[196:199], v[72:75]
ds_read2_b32 v[100:101], v60 offset0:0 offset1:1
v_mfma_f32_16x16x32_bf16 v[76:79], v[168:171], v[200:203], v[76:79]
ds_read2_b32 v[102:103], v60 offset0:2 offset1:3
v_mfma_f32_16x16x32_bf16 v[80:83], v[168:171], v[204:207], v[80:83]
ds_read2_b32 v[104:105], v60 offset0:128 offset1:129
v_mfma_f32_16x16x32_bf16 v[84:87], v[168:171], v[208:211], v[84:87]
ds_read2_b32 v[106:107], v60 offset0:130 offset1:131
v_mfma_f32_16x16x32_bf16 v[88:91], v[168:171], v[212:215], v[88:91]
ds_read2_b32 v[108:109], v61 offset0:0 offset1:1
v_mfma_f32_16x16x32_bf16 v[92:95], v[168:171], v[216:219], v[92:95]
ds_read2_b32 v[110:111], v61 offset0:2 offset1:3
v_mfma_f32_16x16x32_bf16 v[96:99], v[168:171], v[220:223], v[96:99]
ds_read2_b32 v[112:113], v61 offset0:128 offset1:129
v_mfma_f32_16x16x32_bf16 v[76:79], v[172:175], v[196:199], v[76:79]
ds_read2_b32 v[114:115], v61 offset0:130 offset1:131
v_mfma_f32_16x16x32_bf16 v[80:83], v[172:175], v[200:203], v[80:83]
ds_read2_b32 v[116:117], v62 offset0:0 offset1:1
v_mfma_f32_16x16x32_bf16 v[84:87], v[172:175], v[204:207], v[84:87]
ds_read2_b32 v[118:119], v62 offset0:2 offset1:3
v_mfma_f32_16x16x32_bf16 v[88:91], v[172:175], v[208:211], v[88:91]
ds_read2_b32 v[120:121], v62 offset0:128 offset1:129
v_mfma_f32_16x16x32_bf16 v[92:95], v[172:175], v[212:215], v[92:95]
ds_read2_b32 v[122:123], v62 offset0:130 offset1:131
v_mfma_f32_16x16x32_bf16 v[96:99], v[172:175], v[216:219], v[96:99]
ds_read2_b32 v[124:125], v63 offset0:0 offset1:1
v_mfma_f32_16x16x32_bf16 v[80:83], v[176:179], v[196:199], v[80:83]
ds_read2_b32 v[126:127], v63 offset0:2 offset1:3
v_mfma_f32_16x16x32_bf16 v[84:87], v[176:179], v[200:203], v[84:87]
ds_read2_b32 v[128:129], v63 offset0:128 offset1:129
v_mfma_f32_16x16x32_bf16 v[88:91], v[176:179], v[204:207], v[88:91]
ds_read2_b32 v[130:131], v63 offset0:130 offset1:131
v_mfma_f32_16x16x32_bf16 v[92:95], v[176:179], v[208:211], v[92:95]
v_add_u32 v60, 64, v60
v_mfma_f32_16x16x32_bf16 v[96:99], v[176:179], v[212:215], v[96:99]
v_add_u32 v61, 64, v61
v_mfma_f32_16x16x32_bf16 v[84:87], v[180:183], v[196:199], v[84:87]
v_add_u32 v62, 64, v62
v_mfma_f32_16x16x32_bf16 v[88:91], v[180:183], v[200:203], v[88:91]
v_add_u32 v63, 64, v63
v_mfma_f32_16x16x32_bf16 v[92:95], v[180:183], v[204:207], v[92:95]
v_and_b32 v16, 7, v66
v_mfma_f32_16x16x32_bf16 v[96:99], v[180:183], v[208:211], v[96:99]
v_xor_b32 v16, v16, v67
v_mfma_f32_16x16x32_bf16 v[88:91], v[184:187], v[196:199], v[88:91]
v_lshlrev_b32 v16, 4, v16
v_mfma_f32_16x16x32_bf16 v[92:95], v[184:187], v[200:203], v[92:95]
v_lshl_add_u32 v16, v66, 7, v16
v_mfma_f32_16x16x32_bf16 v[96:99], v[184:187], v[204:207], v[96:99]
v_add_u32 v64, 101504, v16
v_mfma_f32_16x16x32_bf16 v[92:95], v[188:191], v[196:199], v[92:95]
v_subrev_u32 v66, 2, v66
v_mfma_f32_16x16x32_bf16 v[96:99], v[188:191], v[200:203], v[96:99]
v_mfma_f32_16x16x32_bf16 v[96:99], v[192:195], v[196:199], v[96:99]
s_waitcnt lgkmcnt(0)
v_mfma_f32_16x16x32_bf16 v[68:71], v[100:103], v[132:135], v[68:71]
ds_read_b128 v[196:199], v64 offset:0
v_mfma_f32_16x16x32_bf16 v[72:75], v[100:103], v[136:139], v[72:75]
ds_read_b128 v[200:203], v64 offset:2048
v_mfma_f32_16x16x32_bf16 v[76:79], v[100:103], v[140:143], v[76:79]
ds_read_b128 v[204:207], v64 offset:4096
v_mfma_f32_16x16x32_bf16 v[80:83], v[100:103], v[144:147], v[80:83]
ds_read_b128 v[208:211], v64 offset:6144
v_mfma_f32_16x16x32_bf16 v[84:87], v[100:103], v[148:151], v[84:87]
ds_read_b128 v[212:215], v64 offset:8192
v_mfma_f32_16x16x32_bf16 v[88:91], v[100:103], v[152:155], v[88:91]
ds_read_b128 v[216:219], v64 offset:10240
v_mfma_f32_16x16x32_bf16 v[92:95], v[100:103], v[156:159], v[92:95]
ds_read_b128 v[220:223], v64 offset:12288
v_mfma_f32_16x16x32_bf16 v[96:99], v[100:103], v[160:163], v[96:99]
ds_read_b128 v[224:227], v64 offset:14336
v_mfma_f32_16x16x32_bf16 v[72:75], v[104:107], v[132:135], v[72:75]
ds_read2_b32 v[164:165], v60 offset0:0 offset1:1
v_mfma_f32_16x16x32_bf16 v[76:79], v[104:107], v[136:139], v[76:79]
ds_read2_b32 v[166:167], v60 offset0:2 offset1:3
v_mfma_f32_16x16x32_bf16 v[80:83], v[104:107], v[140:143], v[80:83]
ds_read2_b32 v[168:169], v60 offset0:128 offset1:129
v_mfma_f32_16x16x32_bf16 v[84:87], v[104:107], v[144:147], v[84:87]
ds_read2_b32 v[170:171], v60 offset0:130 offset1:131
v_mfma_f32_16x16x32_bf16 v[88:91], v[104:107], v[148:151], v[88:91]
ds_read2_b32 v[172:173], v61 offset0:0 offset1:1
v_mfma_f32_16x16x32_bf16 v[92:95], v[104:107], v[152:155], v[92:95]
ds_read2_b32 v[174:175], v61 offset0:2 offset1:3
v_mfma_f32_16x16x32_bf16 v[96:99], v[104:107], v[156:159], v[96:99]
ds_read2_b32 v[176:177], v61 offset0:128 offset1:129
v_mfma_f32_16x16x32_bf16 v[76:79], v[108:111], v[132:135], v[76:79]
ds_read2_b32 v[178:179], v61 offset0:130 offset1:131
v_mfma_f32_16x16x32_bf16 v[80:83], v[108:111], v[136:139], v[80:83]
ds_read2_b32 v[180:181], v62 offset0:0 offset1:1
v_mfma_f32_16x16x32_bf16 v[84:87], v[108:111], v[140:143], v[84:87]
ds_read2_b32 v[182:183], v62 offset0:2 offset1:3
v_mfma_f32_16x16x32_bf16 v[88:91], v[108:111], v[144:147], v[88:91]
ds_read2_b32 v[184:185], v62 offset0:128 offset1:129
v_mfma_f32_16x16x32_bf16 v[92:95], v[108:111], v[148:151], v[92:95]
ds_read2_b32 v[186:187], v62 offset0:130 offset1:131
v_mfma_f32_16x16x32_bf16 v[96:99], v[108:111], v[152:155], v[96:99]
ds_read2_b32 v[188:189], v63 offset0:0 offset1:1
v_mfma_f32_16x16x32_bf16 v[80:83], v[112:115], v[132:135], v[80:83]
ds_read2_b32 v[190:191], v63 offset0:2 offset1:3
v_mfma_f32_16x16x32_bf16 v[84:87], v[112:115], v[136:139], v[84:87]
ds_read2_b32 v[192:193], v63 offset0:128 offset1:129
v_mfma_f32_16x16x32_bf16 v[88:91], v[112:115], v[140:143], v[88:91]
ds_read2_b32 v[194:195], v63 offset0:130 offset1:131
v_mfma_f32_16x16x32_bf16 v[92:95], v[112:115], v[144:147], v[92:95]
v_add_u32 v60, 64, v60
v_mfma_f32_16x16x32_bf16 v[96:99], v[112:115], v[148:151], v[96:99]
v_add_u32 v61, 64, v61
v_mfma_f32_16x16x32_bf16 v[84:87], v[116:119], v[132:135], v[84:87]
v_add_u32 v62, 64, v62
v_mfma_f32_16x16x32_bf16 v[88:91], v[116:119], v[136:139], v[88:91]
v_add_u32 v63, 64, v63
v_mfma_f32_16x16x32_bf16 v[92:95], v[116:119], v[140:143], v[92:95]
v_and_b32 v16, 7, v66
v_mfma_f32_16x16x32_bf16 v[96:99], v[116:119], v[144:147], v[96:99]
v_xor_b32 v16, v16, v67
v_mfma_f32_16x16x32_bf16 v[88:91], v[120:123], v[132:135], v[88:91]
v_lshlrev_b32 v16, 4, v16
v_mfma_f32_16x16x32_bf16 v[92:95], v[120:123], v[136:139], v[92:95]
v_lshl_add_u32 v16, v66, 7, v16
v_mfma_f32_16x16x32_bf16 v[96:99], v[120:123], v[140:143], v[96:99]
v_add_u32 v64, 101504, v16
v_mfma_f32_16x16x32_bf16 v[92:95], v[124:127], v[132:135], v[92:95]
v_subrev_u32 v66, 2, v66
v_mfma_f32_16x16x32_bf16 v[96:99], v[124:127], v[136:139], v[96:99]
v_mfma_f32_16x16x32_bf16 v[96:99], v[128:131], v[132:135], v[96:99]
s_waitcnt lgkmcnt(0)
s_add_u32 s35, s35, 1
s_cmp_lt_u32 s35, 4
s_cbranch_scc1 F_loop
s_lshl_b32 s31, s52, 7
s_add_u32 s31, s31, 3145728
s_nop 6
v_cvt_pk_bf16_f32 v20, v68, v69
v_cvt_pk_bf16_f32 v22, v72, v73
v_cvt_pk_bf16_f32 v21, v70, v71
v_cvt_pk_bf16_f32 v23, v74, v75
s_nop 0
v_permlane16_swap_b32 v20, v22
v_permlane16_swap_b32 v21, v23
buffer_store_dwordx4 v[20:23], v65, s[24:27], s31 offen sc1
s_add_u32 s31, s31, 655360
v_cvt_pk_bf16_f32 v24, v76, v77
v_cvt_pk_bf16_f32 v26, v80, v81
v_cvt_pk_bf16_f32 v25, v78, v79
v_cvt_pk_bf16_f32 v27, v82, v83
s_nop 0
v_permlane16_swap_b32 v24, v26
v_permlane16_swap_b32 v25, v27
buffer_store_dwordx4 v[24:27], v65, s[24:27], s31 offen sc1
s_add_u32 s31, s31, 655360
v_cvt_pk_bf16_f32 v28, v84, v85
v_cvt_pk_bf16_f32 v30, v88, v89
v_cvt_pk_bf16_f32 v29, v86, v87
v_cvt_pk_bf16_f32 v31, v90, v91
s_nop 0
v_permlane16_swap_b32 v28, v30
v_permlane16_swap_b32 v29, v31
buffer_store_dwordx4 v[28:31], v65, s[24:27], s31 offen sc1
s_add_u32 s31, s31, 655360
v_cvt_pk_bf16_f32 v32, v92, v93
v_cvt_pk_bf16_f32 v34, v96, v97
v_cvt_pk_bf16_f32 v33, v94, v95
v_cvt_pk_bf16_f32 v35, v98, v99
s_nop 0
v_permlane16_swap_b32 v32, v34
v_permlane16_swap_b32 v33, v35
buffer_store_dwordx4 v[32:35], v65, s[24:27], s31 offen sc1
s_add_u32 s31, s31, 655360
v_mov_b32 v4, 160532
F_lsmy:
ds_read_b32 v5, v4
s_cmp_eq_u32 s49, 0
s_cbranch_scc1 F_lomy
s_sub_u32 s49, s49, 1
s_waitcnt lgkmcnt(0)
v_cmp_eq_u32 vcc, 0x80808080, v5
s_cbranch_vccnz F_lsmy
F_lomy:
s_waitcnt lgkmcnt(0)
v_readfirstlane_b32 s36, v5
s_lshl_b32 s37, s50, 10
s_lshl_b32 s38, s51, 2
s_add_u32 s37, s37, s38
s_add_u32 s37, s37, 11530240
v_lshlrev_b32 v6, 7, v2
v_mov_b32 v7, 1
s_lshl_b32 s39, s50, 8
s_add_u32 s38, s38, s39
s_add_u32 s38, s38, 11524224
s_mov_b64 exec, 1
v_mov_b32 v4, 160544
v_mov_b32 v5, 1
s_waitcnt vmcnt(0)
ds_add_rtn_u32 v5, v4, v5
s_waitcnt lgkmcnt(0)
v_cmp_ne_u32 vcc, 0x80808083, v5
s_cbranch_vccnz F_ary
s_mov_b64 exec, 0xff
buffer_store_dword v7, v6, s[24:27], s37 offen sc1
s_mov_b64 exec, 1
s_cmp_lg_u32 s36, 0
s_cbranch_scc1 F_ays
buffer_store_dword v7, off, s[24:27], s38
F_ary:
s_mov_b64 exec, -1
s_branch M_entry
F_w7:
s_waitcnt vmcnt(2)
v_mov_b32 v12, v101
v_cmp_eq_u32 vcc, 0, v101
s_cbranch_vccz F_npo
F_np:
buffer_load_dword v12, off, s[44:47], 0 sc1
s_cmp_eq_u32 s49, 0
s_cbranch_scc1 F_npo
s_sub_u32 s49, s49, 1
s_waitcnt vmcnt(0)
v_cmp_eq_u32 vcc, 0, v12
s_cbranch_vccnz F_np
F_npo:
s_lshl_b32 s35, s51, 2
s_add_u32 s35, s35, s48
v_and_b32 v13, 31, v2
v_lshlrev_b32 v13, 2, v13
s_getreg_b32 s36, hwreg(HW_REG_XCC_ID)
s_and_b32 s36, s36, 15
s_lshl_b32 s36, s36, 12
s_waitcnt vmcnt(0)
v_mov_b32 v15, v12
v_or_b32 v12, s36, v12
s_barrier
s_mov_b64 exec, 1
buffer_store_dword v12, off, s[24:27], s35
s_mov_b64 exec, -1
s_mov_b32 s36, 100
v_lshrrev_b32 v8, 3, v2
v_and_b32 v9, 7, v2
v_xor_b32 v9, v9, v8
v_mul_u32_u24 v8, 2560, v8
v_and_b32 v4, 1, v9
v_mul_u32_u24 v4, 1280, v4
v_lshrrev_b32 v9, 1, v9
v_lshl_add_u32 v8, v9, 4, v8
v_add_u32 v8, v8, v4
s_mul_i32 s60, s50, 327680
s_mul_i32 s32, s28, 40960
s_add_u32 s60, s60, s32
s_lshl_b32 s32, s51, 6
s_add_u32 s60, s60, s32
s_add_u32 s60, s60, 0
s_lshl_b32 s61, s28, 11
F_fp:
buffer_load_dword v14, v13, s[24:27], s48 offen sc1
s_cmp_eq_u32 s36, 0
s_cbranch_scc1 F_thru
s_sub_u32 s36, s36, 1
s_waitcnt vmcnt(0)
v_cmp_ne_u32 vcc, v12, v14
s_cbranch_vccnz F_fp
F_fast:
v_mov_b32 v14, 0
F_rback:
v_mov_b32 v13, 160532
ds_write_b32 v13, v15 offset:20
ds_write_b32 v13, v14
s_cmp_ge_u32 s51, 20
s_cbranch_scc1 F_other2
s_barrier
s_branch F_hx
F_hi:
v_lshrrev_b32 v8, 3, v2
v_and_b32 v9, 7, v2
v_xor_b32 v9, v9, v8
v_mul_u32_u24 v8, 2560, v8
v_and_b32 v4, 1, v9
v_mul_u32_u24 v4, 1280, v4
v_lshrrev_b32 v9, 1, v9
v_lshl_add_u32 v8, v9, 4, v8
v_add_u32 v8, v8, v4
s_mul_i32 s60, s50, 327680
s_mul_i32 s32, s28, 40960
s_add_u32 s60, s60, s32
s_lshl_b32 s32, s51, 6
s_add_u32 s60, s60, s32
s_add_u32 s60, s60, 0
s_lshl_b32 s61, s28, 11
s_cmp_ge_u32 s28, 6
s_cbranch_scc1 F_h6
s_lshl_b32 s29, s54, 1
s_add_u32 s29, s29, s28
s_add_u32 s29, s29, 380
s_mov_b32 s53, s29
s_sub_u32 s40, s28, 4
s_lshl_b32 s40, s40, 13
s_add_u32 s40, s40, 86016
s_cmp_lt_u32 s29, 680
s_cbranch_scc1 F_rep
F_h6:
s_waitcnt vmcnt(0)
s_barrier
s_barrier
F_hx:
s_add_u32 m0, s61, 104576
s_add_u32 s32, s60, 0
buffer_load_dwordx4 v8, s[24:27], s32 offen sc1 lds
s_add_u32 m0, s61, 105600
s_add_u32 s32, s60, 20480
buffer_load_dwordx4 v8, s[24:27], s32 offen sc1 lds
s_waitcnt vmcnt(0) lgkmcnt(0)
s_barrier
s_cmp_ge_u32 s28, 6
s_cbranch_scc1 F_fill
s_branch F_rdone
F_qs:
s_mul_i32 s30, s29, 3
s_add_u32 s30, s30, s28
s_sub_u32 s30, s30, 4
s_lshl_b32 s30, s30, 3
v_lshrrev_b32 v4, 4, v2
v_and_b32 v5, 15, v2
v_add_u32 v6, s30, v4
v_mul_u32_u24 v7, 1280, v6
v_lshl_add_u32 v7, v5, 4, v7
s_mov_b32 s12, s92
s_and_b32 s13, s93, 0xffff
s_mov_b32 s14, 0x280000
s_mov_b32 s15, 0x00020000
s_mov_b32 s31, 0
buffer_load_dwordx4 v[32:35], v7, s[12:15], s31 offen offset:0
buffer_load_dwordx4 v[36:39], v7, s[12:15], s31 offen offset:256
buffer_load_dwordx4 v[40:43], v7, s[12:15], s31 offen offset:512
buffer_load_dwordx4 v[44:47], v7, s[12:15], s31 offen offset:768
buffer_load_dwordx4 v[48:51], v7, s[12:15], s31 offen offset:1024
s_add_u32 s31, s31, 5120
buffer_load_dwordx4 v[52:55], v7, s[12:15], s31 offen offset:0
buffer_load_dwordx4 v[56:59], v7, s[12:15], s31 offen offset:256
buffer_load_dwordx4 v[60:63], v7, s[12:15], s31 offen offset:512
buffer_load_dwordx4 v[64:67], v7, s[12:15], s31 offen offset:768
buffer_load_dwordx4 v[68:71], v7, s[12:15], s31 offen offset:1024
s_add_u32 s31, s31, 5120
s_waitcnt vmcnt(11)
s_barrier
s_cmp_ge_u32 s30, 2048
s_cbranch_scc1 F_rda
v_mov_b32 v14, 0
v_mov_b32 v15, 0
v_mov_b32 v16, 0x3f803f80
v_lshlrev_b32 v8, 6, v6
v_lshl_add_u32 v8, v5, 4, v8
s_mov_b32 s33, 40370176
v_cmp_eq_u32 s[36:37], 0, v5
v_cmp_gt_u32 s[34:35], 4, v5
v_mov_b32 v20, 0
v_mov_b32 v21, 0
s_waitcnt vmcnt(5)
v_dot2c_f32_bf16 v20, v32, v16
v_dot2c_f32_bf16 v21, v32, v32
v_dot2c_f32_bf16 v20, v33, v16
v_dot2c_f32_bf16 v21, v33, v33
v_dot2c_f32_bf16 v20, v34, v16
v_dot2c_f32_bf16 v21, v34, v34
v_dot2c_f32_bf16 v20, v35, v16
v_dot2c_f32_bf16 v21, v35, v35
v_dot2c_f32_bf16 v20, v36, v16
v_dot2c_f32_bf16 v21, v36, v36
v_dot2c_f32_bf16 v20, v37, v16
v_dot2c_f32_bf16 v21, v37, v37
v_dot2c_f32_bf16 v20, v38, v16
v_dot2c_f32_bf16 v21, v38, v38
v_dot2c_f32_bf16 v20, v39, v16
v_dot2c_f32_bf16 v21, v39, v39
v_dot2c_f32_bf16 v20, v40, v16
v_dot2c_f32_bf16 v21, v40, v40
v_dot2c_f32_bf16 v20, v41, v16
v_dot2c_f32_bf16 v21, v41, v41
v_dot2c_f32_bf16 v20, v42, v16
v_dot2c_f32_bf16 v21, v42, v42
v_dot2c_f32_bf16 v20, v43, v16
v_dot2c_f32_bf16 v21, v43, v43
v_dot2c_f32_bf16 v20, v44, v16
v_dot2c_f32_bf16 v21, v44, v44
v_dot2c_f32_bf16 v20, v45, v16
v_dot2c_f32_bf16 v21, v45, v45
v_dot2c_f32_bf16 v20, v46, v16
v_dot2c_f32_bf16 v21, v46, v46
v_dot2c_f32_bf16 v20, v47, v16
v_dot2c_f32_bf16 v21, v47, v47
v_dot2c_f32_bf16 v20, v48, v16
v_dot2c_f32_bf16 v21, v48, v48
v_dot2c_f32_bf16 v20, v49, v16
v_dot2c_f32_bf16 v21, v49, v49
v_dot2c_f32_bf16 v20, v50, v16
v_dot2c_f32_bf16 v21, v50, v50
v_dot2c_f32_bf16 v20, v51, v16
v_dot2c_f32_bf16 v21, v51, v51
s_nop 2
v_add_f32_dpp v20, v20, v20 row_ror:8 row_mask:0xf bank_mask:0xf
v_add_f32_dpp v21, v21, v21 row_ror:8 row_mask:0xf bank_mask:0xf
s_nop 0
v_add_f32_dpp v20, v20, v20 row_ror:4 row_mask:0xf bank_mask:0xf
v_add_f32_dpp v21, v21, v21 row_ror:4 row_mask:0xf bank_mask:0xf
s_nop 0
v_add_f32_dpp v20, v20, v20 row_ror:2 row_mask:0xf bank_mask:0xf
v_add_f32_dpp v21, v21, v21 row_ror:2 row_mask:0xf bank_mask:0xf
s_nop 0
v_add_f32_dpp v20, v20, v20 row_ror:1 row_mask:0xf bank_mask:0xf
v_add_f32_dpp v21, v21, v21 row_ror:1 row_mask:0xf bank_mask:0xf
s_nop 0
v_cndmask_b32 v12, 0, v20, s[36:37]
v_cndmask_b32 v13, 0, v21, s[36:37]
s_mov_b64 exec, s[34:35]
buffer_store_dwordx4 v[12:15], v8, s[24:27], s33 offen offset:0 sc1
s_mov_b64 exec, -1
s_nop 0
v_mov_b32 v20, 0
v_mov_b32 v21, 0
s_waitcnt vmcnt(0)
v_dot2c_f32_bf16 v20, v52, v16
v_dot2c_f32_bf16 v21, v52, v52
v_dot2c_f32_bf16 v20, v53, v16
v_dot2c_f32_bf16 v21, v53, v53
v_dot2c_f32_bf16 v20, v54, v16
v_dot2c_f32_bf16 v21, v54, v54
v_dot2c_f32_bf16 v20, v55, v16
v_dot2c_f32_bf16 v21, v55, v55
v_dot2c_f32_bf16 v20, v56, v16
v_dot2c_f32_bf16 v21, v56, v56
v_dot2c_f32_bf16 v20, v57, v16
v_dot2c_f32_bf16 v21, v57, v57
v_dot2c_f32_bf16 v20, v58, v16
v_dot2c_f32_bf16 v21, v58, v58
v_dot2c_f32_bf16 v20, v59, v16
v_dot2c_f32_bf16 v21, v59, v59
v_dot2c_f32_bf16 v20, v60, v16
v_dot2c_f32_bf16 v21, v60, v60
v_dot2c_f32_bf16 v20, v61, v16
v_dot2c_f32_bf16 v21, v61, v61
v_dot2c_f32_bf16 v20, v62, v16
v_dot2c_f32_bf16 v21, v62, v62
v_dot2c_f32_bf16 v20, v63, v16
v_dot2c_f32_bf16 v21, v63, v63
v_dot2c_f32_bf16 v20, v64, v16
v_dot2c_f32_bf16 v21, v64, v64
v_dot2c_f32_bf16 v20, v65, v16
v_dot2c_f32_bf16 v21, v65, v65
v_dot2c_f32_bf16 v20, v66, v16
v_dot2c_f32_bf16 v21, v66, v66
v_dot2c_f32_bf16 v20, v67, v16
v_dot2c_f32_bf16 v21, v67, v67
v_dot2c_f32_bf16 v20, v68, v16
v_dot2c_f32_bf16 v21, v68, v68
v_dot2c_f32_bf16 v20, v69, v16
v_dot2c_f32_bf16 v21, v69, v69
v_dot2c_f32_bf16 v20, v70, v16
v_dot2c_f32_bf16 v21, v70, v70
v_dot2c_f32_bf16 v20, v71, v16
v_dot2c_f32_bf16 v21, v71, v71
s_nop 2
v_add_f32_dpp v20, v20, v20 row_ror:8 row_mask:0xf bank_mask:0xf
v_add_f32_dpp v21, v21, v21 row_ror:8 row_mask:0xf bank_mask:0xf
s_nop 0
v_add_f32_dpp v20, v20, v20 row_ror:4 row_mask:0xf bank_mask:0xf
v_add_f32_dpp v21, v21, v21 row_ror:4 row_mask:0xf bank_mask:0xf
s_nop 0
v_add_f32_dpp v20, v20, v20 row_ror:2 row_mask:0xf bank_mask:0xf
v_add_f32_dpp v21, v21, v21 row_ror:2 row_mask:0xf bank_mask:0xf
s_nop 0
v_add_f32_dpp v20, v20, v20 row_ror:1 row_mask:0xf bank_mask:0xf
v_add_f32_dpp v21, v21, v21 row_ror:1 row_mask:0xf bank_mask:0xf
s_nop 0
v_cndmask_b32 v12, 0, v20, s[36:37]
v_cndmask_b32 v13, 0, v21, s[36:37]
s_mov_b64 exec, s[34:35]
buffer_store_dwordx4 v[12:15], v8, s[24:27], s33 offen offset:256 sc1
s_mov_b64 exec, -1
s_nop 0
s_branch F_rda
F_fill:
s_setprio 0
v_mov_b32 v12, -1
v_mov_b32 v13, -1
v_mov_b32 v14, -1
v_mov_b32 v15, -1
s_lshl_b32 s29, s54, 1
s_add_u32 s29, s29, s28
s_sub_u32 s29, s29, 6
s_mul_i32 s37, s29, 3072
s_add_u32 s37, s37, 40501248
buffer_store_dwordx4 v[12:15], v3, s[24:27], s37 offen offset:0 sc1
buffer_store_dwordx4 v[12:15], v3, s[24:27], s37 offen offset:1024 sc1
buffer_store_dwordx4 v[12:15], v3, s[24:27], s37 offen offset:2048 sc1
v_lshrrev_b32 v10, 1, v2
v_mul_u32_u24 v10, 81920, v10
v_and_b32 v11, 1, v2
v_lshl_add_u32 v10, v11, 7, v10
s_lshl_b32 s37, s54, 1
s_add_u32 s37, s37, s28
s_sub_u32 s37, s37, 6
s_lshl_b32 s37, s37, 8
s_add_u32 s37, s37, 3145728
s_mov_b32 s39, 2
s_branch F_arra
F_other2:
s_mul_i32 s29, s50, 12
s_add_u32 s29, s29, s51
s_sub_u32 s29, s29, 20
s_branch F_misc
F_other:
s_mul_i32 s29, s50, 12
s_add_u32 s29, s29, s51
s_sub_u32 s29, s29, 20
s_mov_b32 s20, s14
s_and_b32 s21, s15, 0xffff
s_mov_b32 s22, 0x280000
s_mov_b32 s23, 0x00020000
s_sub_u32 s30, s51, 20
s_mul_i32 s30, s30, 7
s_add_u32 s30, s30, s28
s_mul_i32 s30, s30, 31
v_min_u32 v4, 30, v2
v_add_u32 v4, s30, v4
v_min_u32 v4, 2559, v4
v_lshlrev_b32 v4, 7, v4
s_mul_i32 s30, s50, 327680
buffer_load_dword v103, v4, s[20:23], s30 offen nt
s_cmp_ge_u32 s28, 4
s_cbranch_scc1 F_qs
s_mul_i32 s30, s28, 96
s_add_u32 s29, s29, s30
s_mov_b32 s53, s29
s_lshl_b32 s40, s28, 13
s_add_u32 s40, s40, 102400
F_rep:
s_mov_b32 s19, 0x00020000
s_mov_b32 s35, 1280
s_cmp_ge_u32 s29, 200
s_cbranch_scc1 F_n3
s_mov_b32 s18, 819200
s_mov_b32 s38, 102400
s_cmp_ge_u32 s29, 100
s_cselect_b32 s16, s86, s84
s_cselect_b32 s17, s87, s85
s_cselect_b32 s39, 2, 0
s_cselect_b32 s37, 819200, 0
s_cselect_b32 s30, 100, 0
s_add_u32 s37, s37, 5767168
s_sub_u32 s29, s29, s30
s_branch F_d5
F_n3:
s_mov_b32 s18, 1966080
s_cmp_ge_u32 s29, 440
s_cbranch_scc1 F_n4
s_sub_u32 s29, s29, 200
s_mov_b32 s39, 1
s_mul_hi_u32 s31, s29, 357913942
s_mul_i32 s30, s31, 12
s_sub_u32 s30, s29, s30
s_mov_b32 s16, s88
s_mov_b32 s17, s89
s_mov_b32 s35, 3072
s_mov_b32 s37, 7405568
s_mov_b32 s38, 122880
s_branch F_sel
F_n4:
s_sub_u32 s29, s29, 440
s_mov_b32 s39, 3
s_mov_b32 s16, s90
s_mov_b32 s17, s91
s_mov_b32 s37, 9371648
s_mov_b32 s38, 245760
F_d5:
s_mul_hi_u32 s31, s29, 858993460
s_mul_i32 s30, s31, 5
s_sub_u32 s30, s29, s30
F_sel:
s_and_b32 s17, s17, 0xffff
s_cmp_eq_u32 s39, 3
s_cbranch_scc1 F_m4
s_cmp_ge_u32 s31, 16
s_cbranch_scc1 F_split
s_lshr_b32 s44, s31, 1
s_mul_i32 s44, s44, 80
s_and_b32 s45, s31, 1
s_lshl_b32 s45, s45, 5
s_add_u32 s44, s44, s45
s_add_u32 s45, s44, 4
s_add_u32 s46, s44, 8
s_add_u32 s47, s44, 12
s_mov_b32 s41, 16
s_branch F_mapped
F_split:
s_sub_u32 s44, s31, 16
s_mul_i32 s44, s44, 160
s_add_u32 s44, s44, 64
s_add_u32 s45, s44, 8
s_add_u32 s46, s44, 80
s_add_u32 s47, s44, 88
s_mov_b32 s41, 4
s_branch F_mapped
F_m4:
s_mov_b32 s41, 8
s_and_b32 s44, s31, 15
s_mul_i32 s44, s44, 96
s_lshr_b32 s45, s31, 4
s_lshl_b32 s45, s45, 5
s_add_u32 s44, s44, s45
s_add_u32 s45, s44, 4
s_add_u32 s46, s44, 16
s_add_u32 s47, s44, 20
F_mapped:
v_lshrrev_b32 v7, 4, v2
v_and_b32 v5, 15, v2
v_lshlrev_b32 v5, 4, v5
v_mul_lo_u32 v6, v7, s35
v_add_u32 v6, v6, v5
s_lshl_b32 s42, s30, 8
s_mul_i32 s41, s41, s35
s_cmp_lt_u32 s51, 20
s_cbranch_scc1 F_gc
s_waitcnt vmcnt(1)
s_barrier
s_cmp_lt_u32 s53, 200
s_cbranch_scc1 F_go
v_mov_b32 v4, 160532
F_lsgo:
ds_read_b32 v5, v4
s_cmp_eq_u32 s49, 0
s_cbranch_scc1 F_logo
s_sub_u32 s49, s49, 1
s_waitcnt lgkmcnt(0)
v_cmp_eq_u32 vcc, 0x80808080, v5
s_cbranch_vccnz F_lsgo
F_logo:
s_waitcnt lgkmcnt(0)
v_readfirstlane_b32 s36, v5
s_branch F_go
F_gc:
s_waitcnt vmcnt(0)
s_barrier
s_barrier
s_add_u32 m0, s61, 104576
s_add_u32 s32, s60, 0
buffer_load_dwordx4 v8, s[24:27], s32 offen sc1 lds
s_add_u32 m0, s61, 105600
s_add_u32 s32, s60, 20480
buffer_load_dwordx4 v8, s[24:27], s32 offen sc1 lds
F_go:
s_mul_i32 s43, s44, s35
s_add_u32 s43, s43, s42
s_add_u32 m0, s40, 0
s_nop 0
buffer_load_dwordx4 v6, s[16:19], s43 offen nt lds
s_add_u32 s43, s43, s41
s_add_u32 m0, s40, 1024
s_nop 0
buffer_load_dwordx4 v6, s[16:19], s43 offen nt lds
s_mul_i32 s43, s45, s35
s_add_u32 s43, s43, s42
s_add_u32 m0, s40, 2048
s_nop 0
buffer_load_dwordx4 v6, s[16:19], s43 offen nt lds
s_add_u32 s43, s43, s41
s_add_u32 m0, s40, 3072
s_nop 0
buffer_load_dwordx4 v6, s[16:19], s43 offen nt lds
s_mul_i32 s43, s46, s35
s_add_u32 s43, s43, s42
s_add_u32 m0, s40, 4096
s_nop 0
buffer_load_dwordx4 v6, s[16:19], s43 offen nt lds
s_add_u32 s43, s43, s41
s_add_u32 m0, s40, 5120
s_nop 0
buffer_load_dwordx4 v6, s[16:19], s43 offen nt lds
s_mul_i32 s43, s47, s35
s_add_u32 s43, s43, s42
s_add_u32 m0, s40, 6144
s_nop 0
buffer_load_dwordx4 v6, s[16:19], s43 offen nt lds
s_add_u32 s43, s43, s41
s_add_u32 m0, s40, 7168
s_nop 0
buffer_load_dwordx4 v6, s[16:19], s43 offen nt lds
s_cmp_ge_u32 s51, 20
s_cbranch_scc1 F_g2
s_waitcnt vmcnt(8)
s_barrier
s_setprio 0
F_g2:
v_bfe_u32 v8, v2, 2, 2
v_and_b32 v9, 3, v2
v_lshlrev_b32 v8, 8, v8
v_lshl_add_u32 v8, v9, 3, v8
v_add_u32 v8, s40, v8
v_lshlrev_b32 v10, 2, v2
v_mov_b32 v48, 0x3f803f80
v_mov_b32 v49, 0x3f803f80
v_mov_b32 v50, 0x3f803f80
v_mov_b32 v51, 0x3f803f80
s_cmp_eq_u32 s39, 1
s_cbranch_scc1 F_rd3
v_lshl_add_u32 v8, v7, 11, v8
v_cmp_eq_u32 s[62:63], 1, v7
v_cmp_eq_u32 s[44:45], 2, v7
v_cmp_eq_u32 s[46:47], 3, v7
s_waitcnt vmcnt(0)
ds_read_b64_tr_b16 v[12:13], v8 offset:0
ds_read_b64_tr_b16 v[14:15], v8 offset:1024
ds_read_b64_tr_b16 v[16:17], v8 offset:32
ds_read_b64_tr_b16 v[18:19], v8 offset:1056
ds_read_b64_tr_b16 v[20:21], v8 offset:64
ds_read_b64_tr_b16 v[22:23], v8 offset:1088
ds_read_b64_tr_b16 v[24:25], v8 offset:96
ds_read_b64_tr_b16 v[26:27], v8 offset:1120
ds_read_b64_tr_b16 v[28:29], v8 offset:128
ds_read_b64_tr_b16 v[30:31], v8 offset:1152
ds_read_b64_tr_b16 v[32:33], v8 offset:160
ds_read_b64_tr_b16 v[34:35], v8 offset:1184
ds_read_b64_tr_b16 v[36:37], v8 offset:192
ds_read_b64_tr_b16 v[38:39], v8 offset:1216
ds_read_b64_tr_b16 v[40:41], v8 offset:224
ds_read_b64_tr_b16 v[42:43], v8 offset:1248
s_lshl_b32 s43, s30, 3
s_add_u32 s43, s43, 0
s_mul_i32 s48, s43, 52429
s_lshr_b32 s48, s48, 18
s_mul_i32 s49, s48, 5
s_sub_u32 s49, s43, s49
s_mul_i32 s48, s48, s38
s_mul_i32 s50, s31, 5
s_add_u32 s49, s49, s50
s_lshl_b32 s49, s49, 10
s_add_u32 s48, s48, s49
s_add_u32 s48, s48, s37
s_waitcnt lgkmcnt(14)
buffer_store_dwordx4 v[12:15], v3, s[24:27], s48 offen sc1
s_lshl_b32 s43, s30, 3
s_add_u32 s43, s43, 1
s_mul_i32 s48, s43, 52429
s_lshr_b32 s48, s48, 18
s_mul_i32 s49, s48, 5
s_sub_u32 s49, s43, s49
s_mul_i32 s48, s48, s38
s_mul_i32 s50, s31, 5
s_add_u32 s49, s49, s50
s_lshl_b32 s49, s49, 10
s_add_u32 s48, s48, s49
s_add_u32 s48, s48, s37
s_waitcnt lgkmcnt(12)
buffer_store_dwordx4 v[16:19], v3, s[24:27], s48 offen sc1
s_lshl_b32 s43, s30, 3
s_add_u32 s43, s43, 2
s_mul_i32 s48, s43, 52429
s_lshr_b32 s48, s48, 18
s_mul_i32 s49, s48, 5
s_sub_u32 s49, s43, s49
s_mul_i32 s48, s48, s38
s_mul_i32 s50, s31, 5
s_add_u32 s49, s49, s50
s_lshl_b32 s49, s49, 10
s_add_u32 s48, s48, s49
s_add_u32 s48, s48, s37
s_waitcnt lgkmcnt(10)
buffer_store_dwordx4 v[20:23], v3, s[24:27], s48 offen sc1
s_lshl_b32 s43, s30, 3
s_add_u32 s43, s43, 3
s_mul_i32 s48, s43, 52429
s_lshr_b32 s48, s48, 18
s_mul_i32 s49, s48, 5
s_sub_u32 s49, s43, s49
s_mul_i32 s48, s48, s38
s_mul_i32 s50, s31, 5
s_add_u32 s49, s49, s50
s_lshl_b32 s49, s49, 10
s_add_u32 s48, s48, s49
s_add_u32 s48, s48, s37
s_waitcnt lgkmcnt(8)
buffer_store_dwordx4 v[24:27], v3, s[24:27], s48 offen sc1
s_lshl_b32 s43, s30, 3
s_add_u32 s43, s43, 4
s_mul_i32 s48, s43, 52429
s_lshr_b32 s48, s48, 18
s_mul_i32 s49, s48, 5
s_sub_u32 s49, s43, s49
s_mul_i32 s48, s48, s38
s_mul_i32 s50, s31, 5
s_add_u32 s49, s49, s50
s_lshl_b32 s49, s49, 10
s_add_u32 s48, s48, s49
s_add_u32 s48, s48, s37
s_waitcnt lgkmcnt(6)
buffer_store_dwordx4 v[28:31], v3, s[24:27], s48 offen sc1
s_lshl_b32 s43, s30, 3
s_add_u32 s43, s43, 5
s_mul_i32 s48, s43, 52429
s_lshr_b32 s48, s48, 18
s_mul_i32 s49, s48, 5
s_sub_u32 s49, s43, s49
s_mul_i32 s48, s48, s38
s_mul_i32 s50, s31, 5
s_add_u32 s49, s49, s50
s_lshl_b32 s49, s49, 10
s_add_u32 s48, s48, s49
s_add_u32 s48, s48, s37
s_waitcnt lgkmcnt(4)
buffer_store_dwordx4 v[32:35], v3, s[24:27], s48 offen sc1
s_lshl_b32 s43, s30, 3
s_add_u32 s43, s43, 6
s_mul_i32 s48, s43, 52429
s_lshr_b32 s48, s48, 18
s_mul_i32 s49, s48, 5
s_sub_u32 s49, s43, s49
s_mul_i32 s48, s48, s38
s_mul_i32 s50, s31, 5
s_add_u32 s49, s49, s50
s_lshl_b32 s49, s49, 10
s_add_u32 s48, s48, s49
s_add_u32 s48, s48, s37
s_waitcnt lgkmcnt(2)
buffer_store_dwordx4 v[36:39], v3, s[24:27], s48 offen sc1
s_lshl_b32 s43, s30, 3
s_add_u32 s43, s43, 7
s_mul_i32 s48, s43, 52429
s_lshr_b32 s48, s48, 18
s_mul_i32 s49, s48, 5
s_sub_u32 s49, s43, s49
s_mul_i32 s48, s48, s38
s_mul_i32 s50, s31, 5
s_add_u32 s49, s49, s50
s_lshl_b32 s49, s49, 10
s_add_u32 s48, s48, s49
s_add_u32 s48, s48, s37
s_waitcnt lgkmcnt(0)
buffer_store_dwordx4 v[40:43], v3, s[24:27], s48 offen sc1
s_cmp_lg_u32 s39, 0
s_cbranch_scc1 F_rdone
v_mfma_f32_16x16x32_bf16 v[64:67], v[48:51], v[12:15], 0
v_mfma_f32_16x16x32_bf16 v[68:71], v[48:51], v[16:19], 0
v_mfma_f32_16x16x32_bf16 v[72:75], v[48:51], v[20:23], 0
v_mfma_f32_16x16x32_bf16 v[76:79], v[48:51], v[24:27], 0
v_mfma_f32_16x16x32_bf16 v[80:83], v[48:51], v[28:31], 0
v_mfma_f32_16x16x32_bf16 v[84:87], v[48:51], v[32:35], 0
v_mfma_f32_16x16x32_bf16 v[88:91], v[48:51], v[36:39], 0
v_mfma_f32_16x16x32_bf16 v[92:95], v[48:51], v[40:43], 0
s_mul_i32 s36, s31, 2560
s_lshl_b32 s43, s30, 9
s_add_u32 s36, s36, s43
s_add_u32 s36, s36, 11337728
s_nop 7
v_cndmask_b32 v64, v64, v68, s[62:63]
v_cndmask_b32 v64, v64, v72, s[44:45]
v_cndmask_b32 v64, v64, v76, s[46:47]
buffer_store_dword v64, v10, s[24:27], s36 offen offset:0 sc1
v_cndmask_b32 v80, v80, v84, s[62:63]
v_cndmask_b32 v80, v80, v88, s[44:45]
v_cndmask_b32 v80, v80, v92, s[46:47]
buffer_store_dword v80, v10, s[24:27], s36 offen offset:256 sc1
s_branch F_rdone
F_rd3:
s_lshl_b32 s59, s31, 1
s_mul_i32 s56, s59, 3
s_add_u32 s59, s59, 48
s_cmp_lt_u32 s31, 12
s_cselect_b32 s59, s56, s59
s_cselect_b32 s58, 1, 16
s_cselect_b32 s57, 3, 1
v_lshrrev_b32 v9, 1, v7
v_lshl_add_u32 v8, v9, 11, v8
v_and_b32 v9, 1, v7
v_lshl_add_u32 v8, v9, 5, v8
v_cmp_le_u32 vcc, 32, v2
s_waitcnt vmcnt(0)
ds_read_b64_tr_b16 v[12:13], v8 offset:0
ds_read_b64_tr_b16 v[14:15], v8 offset:1024
ds_read_b64_tr_b16 v[16:17], v8 offset:64
ds_read_b64_tr_b16 v[18:19], v8 offset:1088
ds_read_b64_tr_b16 v[20:21], v8 offset:128
ds_read_b64_tr_b16 v[22:23], v8 offset:1152
ds_read_b64_tr_b16 v[24:25], v8 offset:192
ds_read_b64_tr_b16 v[26:27], v8 offset:1216
ds_read_b64_tr_b16 v[28:29], v8 offset:4096
ds_read_b64_tr_b16 v[30:31], v8 offset:5120
ds_read_b64_tr_b16 v[32:33], v8 offset:4160
ds_read_b64_tr_b16 v[34:35], v8 offset:5184
ds_read_b64_tr_b16 v[36:37], v8 offset:4224
ds_read_b64_tr_b16 v[38:39], v8 offset:5248
ds_read_b64_tr_b16 v[40:41], v8 offset:4288
ds_read_b64_tr_b16 v[42:43], v8 offset:5312
s_lshl_b32 s43, s30, 2
s_add_u32 s43, s43, 0
s_mul_i32 s48, s43, 43691
s_lshr_b32 s48, s48, 17
s_mul_i32 s49, s48, 3
s_sub_u32 s49, s43, s49
s_mul_i32 s48, s48, s38
s_mul_i32 s49, s49, s58
s_add_u32 s49, s49, s59
s_add_u32 s49, s49, 0
s_lshl_b32 s49, s49, 10
s_add_u32 s48, s48, s49
s_add_u32 s48, s48, s37
s_waitcnt lgkmcnt(14)
buffer_store_dwordx4 v[12:15], v3, s[24:27], s48 offen sc1
s_lshl_b32 s43, s30, 2
s_add_u32 s43, s43, 1
s_mul_i32 s48, s43, 43691
s_lshr_b32 s48, s48, 17
s_mul_i32 s49, s48, 3
s_sub_u32 s49, s43, s49
s_mul_i32 s48, s48, s38
s_mul_i32 s49, s49, s58
s_add_u32 s49, s49, s59
s_add_u32 s49, s49, 0
s_lshl_b32 s49, s49, 10
s_add_u32 s48, s48, s49
s_add_u32 s48, s48, s37
s_waitcnt lgkmcnt(12)
buffer_store_dwordx4 v[16:19], v3, s[24:27], s48 offen sc1
s_lshl_b32 s43, s30, 2
s_add_u32 s43, s43, 2
s_mul_i32 s48, s43, 43691
s_lshr_b32 s48, s48, 17
s_mul_i32 s49, s48, 3
s_sub_u32 s49, s43, s49
s_mul_i32 s48, s48, s38
s_mul_i32 s49, s49, s58
s_add_u32 s49, s49, s59
s_add_u32 s49, s49, 0
s_lshl_b32 s49, s49, 10
s_add_u32 s48, s48, s49
s_add_u32 s48, s48, s37
s_waitcnt lgkmcnt(10)
buffer_store_dwordx4 v[20:23], v3, s[24:27], s48 offen sc1
s_lshl_b32 s43, s30, 2
s_add_u32 s43, s43, 3
s_mul_i32 s48, s43, 43691
s_lshr_b32 s48, s48, 17
s_mul_i32 s49, s48, 3
s_sub_u32 s49, s43, s49
s_mul_i32 s48, s48, s38
s_mul_i32 s49, s49, s58
s_add_u32 s49, s49, s59
s_add_u32 s49, s49, 0
s_lshl_b32 s49, s49, 10
s_add_u32 s48, s48, s49
s_add_u32 s48, s48, s37
s_waitcnt lgkmcnt(8)
buffer_store_dwordx4 v[24:27], v3, s[24:27], s48 offen sc1
s_lshl_b32 s43, s30, 2
s_add_u32 s43, s43, 0
s_mul_i32 s48, s43, 43691
s_lshr_b32 s48, s48, 17
s_mul_i32 s49, s48, 3
s_sub_u32 s49, s43, s49
s_mul_i32 s48, s48, s38
s_mul_i32 s49, s49, s58
s_add_u32 s49, s49, s59
s_add_u32 s49, s49, s57
s_lshl_b32 s49, s49, 10
s_add_u32 s48, s48, s49
s_add_u32 s48, s48, s37
s_waitcnt lgkmcnt(6)
buffer_store_dwordx4 v[28:31], v3, s[24:27], s48 offen sc1
s_lshl_b32 s43, s30, 2
s_add_u32 s43, s43, 1
s_mul_i32 s48, s43, 43691
s_lshr_b32 s48, s48, 17
s_mul_i32 s49, s48, 3
s_sub_u32 s49, s43, s49
s_mul_i32 s48, s48, s38
s_mul_i32 s49, s49, s58
s_add_u32 s49, s49, s59
s_add_u32 s49, s49, s57
s_lshl_b32 s49, s49, 10
s_add_u32 s48, s48, s49
s_add_u32 s48, s48, s37
s_waitcnt lgkmcnt(4)
buffer_store_dwordx4 v[32:35], v3, s[24:27], s48 offen sc1
s_lshl_b32 s43, s30, 2
s_add_u32 s43, s43, 2
s_mul_i32 s48, s43, 43691
s_lshr_b32 s48, s48, 17
s_mul_i32 s49, s48, 3
s_sub_u32 s49, s43, s49
s_mul_i32 s48, s48, s38
s_mul_i32 s49, s49, s58
s_add_u32 s49, s49, s59
s_add_u32 s49, s49, s57
s_lshl_b32 s49, s49, 10
s_add_u32 s48, s48, s49
s_add_u32 s48, s48, s37
s_waitcnt lgkmcnt(2)
buffer_store_dwordx4 v[36:39], v3, s[24:27], s48 offen sc1
s_lshl_b32 s43, s30, 2
s_add_u32 s43, s43, 3
s_mul_i32 s48, s43, 43691
s_lshr_b32 s48, s48, 17
s_mul_i32 s49, s48, 3
s_sub_u32 s49, s43, s49
s_mul_i32 s48, s48, s38
s_mul_i32 s49, s49, s58
s_add_u32 s49, s49, s59
s_add_u32 s49, s49, s57
s_lshl_b32 s49, s49, 10
s_add_u32 s48, s48, s49
s_add_u32 s48, s48, s37
s_waitcnt lgkmcnt(0)
buffer_store_dwordx4 v[40:43], v3, s[24:27], s48 offen sc1
v_mfma_f32_32x32x16_bf16 v[64:79], v[48:51], v[12:15], 0
v_mfma_f32_32x32x16_bf16 v[80:95], v[48:51], v[16:19], 0
v_mfma_f32_32x32x16_bf16 v[96:111], v[48:51], v[20:23], 0
v_mfma_f32_32x32x16_bf16 v[112:127], v[48:51], v[24:27], 0
v_mfma_f32_32x32x16_bf16 v[64:79], v[48:51], v[28:31], v[64:79]
v_mfma_f32_32x32x16_bf16 v[80:95], v[48:51], v[32:35], v[80:95]
v_mfma_f32_32x32x16_bf16 v[96:111], v[48:51], v[36:39], v[96:111]
v_mfma_f32_32x32x16_bf16 v[112:127], v[48:51], v[40:43], v[112:127]
s_mul_i32 s36, s31, 6144
s_lshl_b32 s43, s30, 9
s_add_u32 s36, s36, s43
s_add_u32 s36, s36, 11388928
s_nop 15
v_cndmask_b32 v64, v64, v80, vcc
buffer_store_dword v64, v10, s[24:27], s36 offen offset:0 sc1
v_cndmask_b32 v96, v96, v112, vcc
buffer_store_dword v96, v10, s[24:27], s36 offen offset:256 sc1
s_branch F_rdone
F_misc:
s_cmp_ge_u32 s29, 4
s_cbranch_scc1 F_nofl
v_mov_b32 v12, 0
v_mov_b32 v13, 0
v_mov_b32 v14, 0
v_mov_b32 v15, 0
s_lshl_b32 s33, s29, 10
s_add_u32 s33, s33, 11513856
buffer_store_dwordx4 v[12:15], v3, s[24:27], s33 offen sc1
F_nofl:
s_getpc_b64 s[44:45]
F_here:
s_add_u32 s44, s44, M_entry-F_here
s_addc_u32 s45, s45, 0
s_sub_u32 s34, s51, 20
s_mul_i32 s34, s34, 3072
v_min_u32 v10, 23, v2
v_lshlrev_b32 v10, 7, v10
v_add_u32 v10, s34, v10
v_min_u32 v10, code_end-M_entry-4, v10
global_load_dword v16, v10, s[44:45] sc1
s_branch F_rda
F_rdone:
s_and_b32 s50, s2, 7
s_mov_b32 s49, 400000
s_cmp_ge_u32 s53, 100
s_cbranch_scc1 F_arrb
F_rda:
s_mul_i32 s29, s50, 12
s_add_u32 s29, s29, s51
s_cmp_lt_u32 s29, 24
s_cselect_b32 s39, 6, 5
F_arra:
s_mov_b64 exec, 1
v_mov_b32 v4, 160540
v_mov_b32 v5, 1
s_waitcnt vmcnt(0)
ds_add_rtn_u32 v5, v4, v5
s_add_u32 s36, s39, 0x8080807f
s_waitcnt lgkmcnt(0)
v_cmp_ne_u32 vcc, s36, v5
s_mov_b64 exec, -1
s_cbranch_vccnz F_ara
v_mov_b32 v4, 160552
F_lsna:
ds_read_b32 v5, v4
s_cmp_eq_u32 s49, 0
s_cbranch_scc1 F_lona
s_sub_u32 s49, s49, 1
s_waitcnt lgkmcnt(0)
v_cmp_eq_u32 vcc, 0x80808080, v5
s_cbranch_vccnz F_lsna
F_lona:
s_waitcnt lgkmcnt(0)
v_readfirstlane_b32 s36, v5
s_lshl_b32 s37, s50, 8
s_add_u32 s37, s37, 11524096
v_mov_b32 v5, 1
s_mov_b64 exec, 1
buffer_atomic_add v5, off, s[24:27], s37 sc0 sc1
s_waitcnt vmcnt(0)
v_cmp_ne_u32 vcc, 31, v5
s_mov_b64 exec, -1
s_cbranch_vccnz F_ara
s_lshl_b32 s37, s50, 2
s_add_u32 s37, s37, 11526144
v_lshlrev_b32 v4, 7, v2
v_mov_b32 v5, s36
s_mov_b64 exec, 0xff
buffer_store_dword v5, v4, s[24:27], s37 offen sc1
s_mov_b64 exec, -1
v_mov_b32 v4, 160532
F_lsma:
ds_read_b32 v5, v4
s_cmp_eq_u32 s49, 0
s_cbranch_scc1 F_loma
s_sub_u32 s49, s49, 1
s_waitcnt lgkmcnt(0)
v_cmp_eq_u32 vcc, 0x80808080, v5
s_cbranch_vccnz F_lsma
F_loma:
s_waitcnt lgkmcnt(0)
v_readfirstlane_b32 s38, v5
s_lshl_b32 s37, s50, 8
s_add_u32 s37, s37, 11524304
v_mov_b32 v5, 1
s_mov_b64 exec, 1
s_cmp_lg_u32 s38, 0
s_cbranch_scc1 F_asa
buffer_store_dword v5, off, s[24:27], s37
F_ada:
s_mov_b64 exec, -1
F_ara:
s_branch F_jm
F_arrb:
s_mul_i32 s29, s50, 12
s_add_u32 s29, s29, s51
s_cmp_lt_u32 s29, 24
s_cselect_b32 s39, 2, 3
s_cmp_lt_u32 s51, 20
s_cselect_b32 s39, 2, s39
s_mov_b64 exec, 1
v_mov_b32 v4, 160556
v_mov_b32 v5, 1
s_waitcnt vmcnt(0)
ds_add_rtn_u32 v5, v4, v5
s_add_u32 s36, s39, 0x8080807f
s_waitcnt lgkmcnt(0)
v_cmp_ne_u32 vcc, s36, v5
s_mov_b64 exec, -1
s_cbranch_vccnz F_arb
v_mov_b32 v4, 160552
F_lsnb:
ds_read_b32 v5, v4
s_cmp_eq_u32 s49, 0
s_cbranch_scc1 F_lonb
s_sub_u32 s49, s49, 1
s_waitcnt lgkmcnt(0)
v_cmp_eq_u32 vcc, 0x80808080, v5
s_cbranch_vccnz F_lsnb
F_lonb:
s_waitcnt lgkmcnt(0)
v_readfirstlane_b32 s36, v5
s_lshl_b32 s37, s50, 8
s_add_u32 s37, s37, 11524100
v_mov_b32 v5, 1
s_mov_b64 exec, 1
buffer_atomic_add v5, off, s[24:27], s37 sc0 sc1
s_waitcnt vmcnt(0)
v_cmp_ne_u32 vcc, 31, v5
s_mov_b64 exec, -1
s_cbranch_vccnz F_arb
s_lshl_b32 s37, s50, 2
s_add_u32 s37, s37, 11526176
v_lshlrev_b32 v4, 7, v2
v_mov_b32 v5, s36
s_mov_b64 exec, 0xff
buffer_store_dword v5, v4, s[24:27], s37 offen sc1
s_mov_b64 exec, -1
v_mov_b32 v4, 160532
F_lsmb:
ds_read_b32 v5, v4
s_cmp_eq_u32 s49, 0
s_cbranch_scc1 F_lomb
s_sub_u32 s49, s49, 1
s_waitcnt lgkmcnt(0)
v_cmp_eq_u32 vcc, 0x80808080, v5
s_cbranch_vccnz F_lsmb
F_lomb:
s_waitcnt lgkmcnt(0)
v_readfirstlane_b32 s38, v5
s_lshl_b32 s37, s50, 8
s_add_u32 s37, s37, 11524308
v_mov_b32 v5, 1
s_mov_b64 exec, 1
s_cmp_lg_u32 s38, 0
s_cbranch_scc1 F_asb
buffer_store_dword v5, off, s[24:27], s37
F_adb:
s_mov_b64 exec, -1
F_arb:
F_jm:
s_branch M_entry
F_end:
s_endpgm
F_ays:
buffer_store_dword v7, off, s[24:27], s38 sc1
s_branch F_ary
F_thru:
s_mov_b64 exec, 1
buffer_store_dword v12, off, s[24:27], s35 offset:128 sc1
s_mov_b64 exec, -1
F_fp1:
buffer_load_dword v14, v13, s[24:27], s48 offen sc1
buffer_load_dword v17, v13, s[24:27], s48 offen offset:128 sc1
s_cmp_eq_u32 s49, 0
s_cbranch_scc1 F_redo
s_sub_u32 s49, s49, 1
s_waitcnt vmcnt(0)
v_cmp_ne_u32 vcc, v12, v14
s_cbranch_vccz F_fast
v_and_b32 v16, 0xfff, v17
v_cmp_ne_u32 vcc, v15, v16
s_cbranch_vccnz F_fp1
v_cmp_ne_u32 vcc, v12, v17
s_cbranch_vccz F_fast
F_redo:
v_add_u32 v11, 65536, v3
s_sub_u32 s37, s55, 8960
ds_read_b128 v[20:23], v11 offset:0
s_waitcnt lgkmcnt(0)
buffer_store_dwordx4 v[20:23], v3, s[24:27], s37 offen sc1
s_add_u32 s37, s37, 1024
s_nop 0
ds_read_b128 v[20:23], v11 offset:1024
s_waitcnt lgkmcnt(0)
buffer_store_dwordx4 v[20:23], v3, s[24:27], s37 offen sc1
s_add_u32 s37, s37, 1024
s_nop 0
ds_read_b128 v[20:23], v11 offset:2048
s_waitcnt lgkmcnt(0)
buffer_store_dwordx4 v[20:23], v3, s[24:27], s37 offen sc1
s_add_u32 s37, s37, 1024
s_nop 0
ds_read_b128 v[20:23], v11 offset:3072
s_waitcnt lgkmcnt(0)
buffer_store_dwordx4 v[20:23], v3, s[24:27], s37 offen sc1
s_add_u32 s37, s37, 1024
s_nop 0
ds_read_b128 v[20:23], v11 offset:4096
s_waitcnt lgkmcnt(0)
buffer_store_dwordx4 v[20:23], v3, s[24:27], s37 offen sc1
s_add_u32 s37, s37, 1024
s_nop 0
ds_read_b128 v[20:23], v11 offset:5120
s_waitcnt lgkmcnt(0)
buffer_store_dwordx4 v[20:23], v3, s[24:27], s37 offen sc1
s_add_u32 s37, s37, 1024
s_nop 0
ds_read_b128 v[20:23], v11 offset:6144
s_waitcnt lgkmcnt(0)
buffer_store_dwordx4 v[20:23], v3, s[24:27], s37 offen sc1
s_add_u32 s37, s37, 1024
s_nop 0
ds_read_b128 v[20:23], v11 offset:7168
s_waitcnt lgkmcnt(0)
buffer_store_dwordx4 v[20:23], v3, s[24:27], s37 offen sc1
s_add_u32 s37, s37, 1024
s_nop 0
ds_read_b128 v[20:23], v11 offset:8192
s_waitcnt lgkmcnt(0)
buffer_store_dwordx4 v[20:23], v3, s[24:27], s37 offen sc1
s_add_u32 s37, s37, 1024
s_nop 0
ds_read_b128 v[20:23], v11 offset:9216
s_waitcnt lgkmcnt(0)
buffer_store_dwordx4 v[20:23], v3, s[24:27], s37 offen sc1
s_add_u32 s37, s37, 1024
s_nop 0
s_waitcnt vmcnt(0)
s_mov_b64 exec, 1
buffer_store_dword v12, off, s[24:27], s35 offset:256 sc1
s_mov_b64 exec, -1
F_fp2:
buffer_load_dword v14, v13, s[24:27], s48 offen offset:256 sc1
s_cmp_eq_u32 s49, 0
s_cbranch_scc1 F_r2
s_sub_u32 s49, s49, 1
s_waitcnt vmcnt(0)
v_and_b32 v14, 0xfff, v14
v_cmp_ne_u32 vcc, v15, v14
s_cbranch_vccnz F_fp2
F_r2:
s_waitcnt vmcnt(0)
v_mov_b32 v14, 1
s_branch F_rback
F_asa:
buffer_store_dword v5, off, s[24:27], s37 sc1
s_branch F_ada
F_asb:
buffer_store_dword v5, off, s[24:27], s37 sc1
s_branch F_adb
F_last:
M_entry:
s_load_dwordx2 s[48:49], s[0:1], 104
s_load_dwordx2 s[50:51], s[0:1], 0
s_load_dwordx2 s[52:53], s[0:1], 88
v_lshrrev_b32 v1, 6, v0
v_and_b32 v0, 63, v0
v_lshlrev_b32 v4, 4, v0
v_readfirstlane_b32 s18, v1
s_and_b32 s16, s2, 7
s_lshr_b32 s3, s2, 3
s_and_b32 s17, s3, 7
s_lshr_b32 s3, s3, 3
s_lshl_b32 s16, s16, 2
s_add_u32 s16, s16, s3
s_and_b32 s3, s16, 1
s_lshl_b32 s3, s3, 3
s_add_u32 s3, s3, s17
s_mov_b32 s82, 0x80808080
v_lshlrev_b32 v3, 2, v0
v_add_u32 v3, 160512, v3
s_and_b32 s56, s18, 3
s_lshl_b32 s56, s56, 3
s_lshl_b32 s56, 1, s56
v_cmp_eq_u32 vcc, 0, v0
v_add_u32 v250, 256, v3
v_mov_b32 v252, 160512
v_mov_b32 v251, s56
v_cndmask_b32 v250, v250, v252, vcc
s_mov_b32 s22, 400000
s_cmp_ge_u32 s18, 4
s_cbranch_scc1 M_loader
ds_add_u32 v250, v251 offset:36
v_and_b32 v32, 15, v0
v_lshrrev_b32 v33, 4, v0
s_lshl_b32 s56, s16, 2
s_add_u32 s56, s56, s18
s_lshl_b32 s57, s56, 4
v_add_u32 v34, s57, v32
s_mul_i32 s58, s17, 160
v_mul_u32_u24 v29, 1280, v34
v_lshl_add_u32 v29, v33, 3, v29
v_add_u32 v29, s58, v29
s_mul_i32 s58, s17, 10240
s_mul_i32 s59, s16, 81920
s_add_u32 s58, s58, s59
s_lshl_b32 s59, s18, 5
s_add_u32 s58, s58, s59
s_add_u32 s58, s58, 3145728
v_lshrrev_b32 v35, 1, v0
v_lshlrev_b32 v35, 7, v35
v_and_b32 v36, 1, v0
v_lshl_add_u32 v35, v36, 4, v35
v_lshlrev_b32 v38, 6, v34
v_lshl_add_u32 v11, v33, 4, v38
s_mov_b32 s62, 40370176
s_mul_i32 s59, s18, 2560
s_add_u32 m0, s59, 149504
s_mov_b32 s80, s58
s_waitcnt lgkmcnt(0)
s_mov_b32 s4, s48
s_and_b32 s5, s49, 0xffff
s_mov_b32 s6, 0x10000000
s_mov_b32 s7, 0x00020000
s_mov_b32 s8, s50
s_and_b32 s9, s51, 0xffff
s_mov_b32 s10, 0x280000
s_mov_b32 s11, 0x00020000
buffer_load_dwordx2 v[128:129], v29, s[8:11], 0 offen offset:0
buffer_load_dwordx2 v[130:131], v29, s[8:11], 0 offen offset:32
buffer_load_dwordx2 v[132:133], v29, s[8:11], 0 offen offset:64
buffer_load_dwordx2 v[134:135], v29, s[8:11], 0 offen offset:96
buffer_load_dwordx2 v[136:137], v29, s[8:11], 0 offen offset:128
s_mov_b32 s12, s52
s_and_b32 s13, s53, 0xffff
s_mov_b32 s14, 0x280000
s_mov_b32 s15, 0x00020000
v_mov_b32 v252, 160520
s_mov_b32 s20, 0
s_mov_b32 s63, 1
s_mov_b32 s60, 0
s_mov_b32 s61, 0
s_mov_b32 s21, 0
s_lshr_b32 s49, s16, 1
s_lshl_b32 s49, s49, 8
s_add_u32 s49, s49, 11513856
s_lshl_b32 s48, s18, 4
s_add_u32 s48, s48, s3
s_lshl_b32 s48, s48, 2
s_add_u32 s23, s48, s49
s_mov_b32 s24, 0
s_mov_b32 s25, 4096
s_mov_b32 s26, 8192
s_mov_b32 s27, 12288
s_mov_b32 s28, 16384
s_mov_b32 s29, 20480
s_mov_b32 s30, 24576
s_mov_b32 s31, 28672
s_mov_b32 s32, 32768
s_mov_b32 s33, 36864
s_mov_b32 s34, 40960
s_mov_b32 s35, 45056
s_mov_b32 s44, 0xffff
s_mov_b32 s45, 0xffff
v_add_u32 v5, 0x10000, v4
v_add_u32 v6, 0x20000, v4
s_mul_i32 s48, s56, 20480
v_add_u32 v7, s48, v4
s_lshl_b32 s50, s17, 11
v_add_u32 v8, s50, v7
s_lshr_b32 s51, s17, 1
s_add_u32 s51, s51, 16
s_lshl_b32 s51, s51, 10
s_and_b32 s52, s17, 1
s_lshl_b32 s53, s52, 9
s_add_u32 s53, s53, s51
v_lshrrev_b32 v36, 1, v33
v_lshlrev_b32 v37, 8, v36
v_lshl_add_u32 v37, v32, 4, v37
s_add_u32 s48, s48, s53
v_add_u32 v9, s48, v37
v_and_b32 v39, 1, v33
v_lshl_add_u32 v39, v39, 2, v38
s_lshl_b32 s48, s17, 3
v_add_u32 v10, s48, v39
s_mov_b32 s58, 159744
v_and_b32 v40, 31, v0
v_lshrrev_b32 v41, 5, v0
s_lshr_b32 s48, s16, 1
s_lshl_b32 s48, s48, 7
s_lshl_b32 s54, s18, 5
s_add_u32 s48, s48, s54
v_add_u32 v42, s48, v40
v_lshlrev_b32 v12, 6, v42
v_lshl_add_u32 v12, v41, 5, v12
v_lshrrev_b32 v43, 4, v42
v_lshlrev_b32 v44, 8, v41
v_lshl_add_u32 v44, v32, 4, v44
v_mul_u32_u24 v24, 20480, v43
v_add_u32 v24, v24, v44
v_mul_u32_u24 v25, 49152, v43
v_add_u32 v25, v25, v44
s_lshl_b32 s48, s3, 10
s_add_u32 s48, s48, 34078720
v_add_u32 v25, s48, v25
s_mul_i32 s48, s56, 49152
s_add_u32 s48, s48, 34078720
v_add_u32 v26, s48, v4
v_lshlrev_b32 v27, 4, v33
v_add_u32 v27, s58, v27
v_lshlrev_b32 v28, 4, v41
s_add_u32 s48, s58, 320
v_add_u32 v28, s48, v28
v_and_b32 v45, 7, v0
v_bfe_u32 v46, v0, 3, 1
v_and_b32 v47, 15, v0
v_lshlrev_b32 v48, 2, v45
s_and_b32 s48, s16, 1
s_lshl_b32 s48, s48, 5
s_add_u32 s48, s48, s49
s_lshl_b32 s54, s18, 6
s_add_u32 s55, s48, s54
v_add_u32 v13, s55, v48
v_bfe_u32 v49, v45, 1, 1
v_lshlrev_b32 v49, 1, v49
v_subrev_u32 v49, 1, v49
v_mul_i32_i24 v49, v49, v46
v_add_u32 v49, s18, v49
v_max_i32 v49, 0, v49
v_min_i32 v49, 3, v49
v_lshl_add_u32 v49, v49, 6, v48
v_add_u32 v14, s48, v49
s_lshr_b32 s54, s18, 1
s_lshl_b32 s55, s54, 5
s_and_b32 s59, s18, 1
s_lshl_b32 s59, s59, 7
s_add_u32 s55, s55, s59
s_add_u32 s55, s55, s49
v_lshl_add_u32 v49, v46, 6, v48
v_add_u32 v15, s55, v49
s_and_b32 s59, s16, 1
s_lshl_b32 s59, s59, 1
s_add_u32 s59, s59, s54
s_lshl_b32 s59, s59, 6
s_add_u32 s55, s59, s49
v_lshlrev_b32 v49, 2, v47
v_add_u32 v16, s55, v49
s_cmp_eq_u32 s18, 3
s_cselect_b32 s54, 1, 0
s_cmp_eq_u32 s18, 0
s_cselect_b32 s47, 1, s54
s_lshr_b32 s48, s16, 2
s_mul_i32 s48, s48, 20480
s_and_b32 s55, s16, 3
s_lshl_b32 s55, s55, 1
s_add_u32 s55, s55, s54
s_lshl_b32 s55, s55, 7
s_add_u32 s48, s48, s55
s_add_u32 s48, s48, 40763392
v_and_b32 v51, 1, v32
v_lshl_add_u32 v51, v33, 1, v51
v_lshlrev_b32 v51, 4, v51
v_add_u32 v51, s48, v51
v_add_u32 v52, 3145728, v7
s_lshl_b32 s55, s18, 4
v_add_u32 v53, s55, v32
v_add_u32 v54, -1, v53
v_cmp_gt_u32 vcc, 64, v54
s_nop 1
v_cndmask_b32 v17, v51, v52, vcc
v_add_u32 v54, 1, v53
v_cmp_gt_u32 vcc, 64, v54
s_nop 1
v_cndmask_b32 v18, v51, v52, vcc
v_add_u32 v54, -2, v53
v_cmp_gt_u32 vcc, 64, v54
s_nop 1
v_cndmask_b32 v19, v51, v52, vcc
v_add_u32 v54, 2, v53
v_cmp_gt_u32 vcc, 64, v54
s_nop 1
v_cndmask_b32 v20, v51, v52, vcc
v_subrev_u32 v54, 20, v0
v_cmp_gt_u32 vcc, 40, v54
v_lshrrev_b32 v55, 3, v54
v_and_b32 v56, 7, v54
v_cmp_gt_u32 s[50:51], 20, v0
v_lshrrev_b32 v57, 2, v0
v_and_b32 v58, 3, v0
v_lshlrev_b32 v58, 1, v58
v_add_u32 v58, s54, v58
v_cndmask_b32 v57, 0, v57, s[50:51]
v_mov_b32 v59, s54
v_cndmask_b32 v58, v59, v58, s[50:51]
v_cndmask_b32 v55, v57, v55, vcc
v_cndmask_b32 v56, v58, v56, vcc
v_add_u32 v57, 2, v59
v_cndmask_b32 v59, v59, v57, vcc
v_lshl_add_u32 v57, v59, 2, v55
v_add_u32 v58, 16, v59
v_cmp_gt_u32 vcc, 4, v55
s_nop 1
v_cndmask_b32 v57, v58, v57, vcc
v_lshlrev_b32 v57, 10, v57
v_lshl_add_u32 v57, v56, 4, v57
v_add_u32 v23, s48, v57
s_lshr_b32 s48, s17, 2
s_add_u32 s48, s48, 1
s_sub_u32 s49, 0, s48
s_bitcmp1_b32 s17, 1
s_cselect_b32 s48, s49, s48
s_cselect_b32 s54, 1, 0
s_cselect_b32 s49, -1, 1
s_add_u32 s49, s49, s16
s_cmp_gt_u32 s49, 31
s_cselect_b32 s46, 1, 0
s_and_b32 s49, s49, 31
s_lshr_b32 s55, s49, 2
s_mul_i32 s55, s55, 20480
s_and_b32 s49, s49, 3
s_lshl_b32 s49, s49, 1
s_add_u32 s49, s49, s54
s_lshl_b32 s49, s49, 7
s_add_u32 s55, s55, s49
s_add_u32 s55, s55, 40763392
v_add_u32 v54, s48, v53
v_cmp_gt_u32 vcc, 64, v54
v_lshrrev_b32 v55, 4, v54
v_and_b32 v56, 15, v54
v_and_b32 v57, 1, v54
s_mov_b64 s[36:37], vcc
s_not_b64 s[40:41], vcc
s_and_b64 s[38:39], vcc, s[44:45]
s_andn2_b64 s[42:43], s[44:45], vcc
s_mul_i32 s49, s16, 81920
s_add_u32 s49, s49, 3145728
v_mul_u32_u24 v55, 20480, v55
v_lshl_add_u32 v55, v56, 4, v55
v_add_u32 v55, s49, v55
s_lshl_b32 s50, s17, 11
v_lshl_add_u32 v56, v33, 8, v55
v_lshl_add_u32 v58, v33, 1, v57
v_lshlrev_b32 v58, 4, v58
v_add_u32 v58, s55, v58
v_cndmask_b32 v56, v58, v56, vcc
v_add_u32 v21, s50, v56
s_lshr_b32 s51, s17, 1
s_add_u32 s51, s51, 16
s_lshl_b32 s51, s51, 10
s_lshl_b32 s50, s52, 1
v_add_u32 v59, s50, v36
v_lshl_add_u32 v56, v59, 8, v55
v_lshl_add_u32 v58, v59, 1, v57
v_lshlrev_b32 v58, 4, v58
v_add_u32 v58, s55, v58
v_cndmask_b32 v56, v58, v56, vcc
v_add_u32 v22, s51, v56
v_bfe_u32 v54, v0, 2, 2
v_lshl_add_u32 v54, v33, 2, v54
v_lshlrev_b32 v54, 5, v54
v_and_b32 v55, 3, v0
v_lshl_add_u32 v54, v55, 3, v54
s_mul_i32 s48, s18, 2560
s_add_u32 s48, s48, 149504
v_add_u32 v54, s48, v54
v_mov_b32 v2, 160532
M_lsm:
ds_read_b32 v3, v2
s_cmp_eq_u32 s22, 0
s_cbranch_scc1 M_lom
s_sub_u32 s22, s22, 1
s_waitcnt lgkmcnt(0)
v_cmp_eq_u32 vcc, s82, v3
s_cbranch_vccnz M_lsm
M_lom:
s_waitcnt lgkmcnt(0)
v_readfirstlane_b32 s19, v3
v_mov_b32 v2, 160552
M_lsn:
ds_read_b32 v3, v2
s_cmp_eq_u32 s22, 0
s_cbranch_scc1 M_lon
s_sub_u32 s22, s22, 1
s_waitcnt lgkmcnt(0)
v_cmp_eq_u32 vcc, s82, v3
s_cbranch_vccnz M_lsn
M_lon:
s_waitcnt lgkmcnt(0)
v_readfirstlane_b32 s50, v3
s_cmp_lg_u32 s19, 0
s_cbranch_scc1 M_slowadj
M_xdone:
s_waitcnt vmcnt(0)
v_lshlrev_b32 v100, 16, v128
v_and_b32 v101, 0xffff0000, v128
v_lshlrev_b32 v102, 16, v129
v_and_b32 v103, 0xffff0000, v129
v_lshlrev_b32 v104, 16, v130
v_and_b32 v105, 0xffff0000, v130
v_lshlrev_b32 v106, 16, v131
v_and_b32 v107, 0xffff0000, v131
v_lshlrev_b32 v108, 16, v132
v_and_b32 v109, 0xffff0000, v132
v_lshlrev_b32 v110, 16, v133
v_and_b32 v111, 0xffff0000, v133
v_lshlrev_b32 v112, 16, v134
v_and_b32 v113, 0xffff0000, v134
v_lshlrev_b32 v114, 16, v135
v_and_b32 v115, 0xffff0000, v135
v_lshlrev_b32 v116, 16, v136
v_and_b32 v117, 0xffff0000, v136
v_lshlrev_b32 v118, 16, v137
v_and_b32 v119, 0xffff0000, v137
s_and_b32 s52, s2, 7
s_lshl_b32 s51, s52, 7
s_lshl_b32 s52, s17, 10
s_add_u32 s51, s51, s52
s_add_u32 s51, s51, 11530240
v_min_u32 v42, 19, v0
v_lshlrev_b32 v42, 2, v42
v_mov_b32 v2, 160536
M_ls2:
ds_read_b32 v3, v2
s_cmp_eq_u32 s22, 0
s_cbranch_scc1 M_lo2
s_sub_u32 s22, s22, 1
s_waitcnt lgkmcnt(0)
v_cmp_eq_u32 vcc, s82, v3
s_cbranch_vccnz M_ls2
M_lo2:
s_waitcnt lgkmcnt(0)
buffer_load_dwordx4 v[232:235], v11, s[4:7], s62 offen sc1
s_waitcnt vmcnt(0)
v_add_f32 v1, v232, v234
v_add_f32 v2, v233, v235
s_nop 1
v_permlane16_swap_b32 v1, v2
v_add_f32 v1, v1, v2
v_mov_b32 v2, v1
s_nop 1
v_permlane32_swap_b32 v1, v2
v_add_f32 v1, v1, v2
v_mov_b32 v2, v1
s_nop 1
v_permlane16_swap_b32 v1, v2
v_mul_f32 v32, 0x3acccccd, v1
v_mul_f32 v2, 0x3acccccd, v2
v_fma_f32 v2, -v32, v32, v2
v_max_f32 v2, 0, v2
v_add_f32 v1, 0x3727c5ac, v2
v_rsq_f32 v34, v1
s_nop 0
v_mul_f32 v2, v32, v34
v_sub_f32 v2, 0, v2
v_pk_fma_f32 v[80:81], v[100:101], v[34:35], v[2:3] op_sel_hi:[1,0,0]
v_pk_fma_f32 v[82:83], v[102:103], v[34:35], v[2:3] op_sel_hi:[1,0,0]
v_pk_fma_f32 v[84:85], v[104:105], v[34:35], v[2:3] op_sel_hi:[1,0,0]
v_pk_fma_f32 v[86:87], v[106:107], v[34:35], v[2:3] op_sel_hi:[1,0,0]
v_pk_fma_f32 v[88:89], v[108:109], v[34:35], v[2:3] op_sel_hi:[1,0,0]
v_pk_fma_f32 v[90:91], v[110:111], v[34:35], v[2:3] op_sel_hi:[1,0,0]
v_pk_fma_f32 v[92:93], v[112:113], v[34:35], v[2:3] op_sel_hi:[1,0,0]
v_pk_fma_f32 v[94:95], v[114:115], v[34:35], v[2:3] op_sel_hi:[1,0,0]
v_pk_fma_f32 v[96:97], v[116:117], v[34:35], v[2:3] op_sel_hi:[1,0,0]
v_pk_fma_f32 v[98:99], v[118:119], v[34:35], v[2:3] op_sel_hi:[1,0,0]
M_p3:
buffer_load_dword v1, v42, s[4:7], s51 offen sc1
s_cmp_eq_u32 s22, 0
s_cbranch_scc1 M_p3o
s_sub_u32 s22, s22, 1
s_waitcnt vmcnt(0)
v_cmp_ne_u32 vcc, 1, v1
s_cbranch_vccnz M_p3
M_p3o:
buffer_load_dwordx4 v35, s[4:7], s80 offen sc1 lds
s_add_u32 m0, m0, 1024
s_add_u32 s80, s80, 4096
buffer_load_dwordx4 v35, s[4:7], s80 offen sc1 lds
s_add_u32 m0, m0, 1024
s_add_u32 s80, s80, 4096
s_mov_b32 exec_hi, 0
buffer_load_dwordx4 v35, s[4:7], s80 offen sc1 lds
s_add_u32 m0, m0, 1024
s_add_u32 s80, s80, 4096
s_mov_b64 exec, -1
s_waitcnt vmcnt(0)
ds_read_b64_tr_b16 v[240:241], v54 offset:0
ds_read_b64_tr_b16 v[242:243], v54 offset:512
ds_read_b64_tr_b16 v[244:245], v54 offset:1024
ds_read_b64_tr_b16 v[246:247], v54 offset:1536
ds_read_b64_tr_b16 v[248:249], v54 offset:2048
s_waitcnt lgkmcnt(4)
v_lshlrev_b32 v60, 16, v240
v_and_b32 v61, 0xffff0000, v240
v_lshlrev_b32 v62, 16, v241
v_and_b32 v63, 0xffff0000, v241
v_pk_fma_f32 v[80:81], v[80:81], v[60:61], v[100:101]
v_pk_fma_f32 v[82:83], v[82:83], v[62:63], v[102:103]
s_waitcnt lgkmcnt(3)
v_lshlrev_b32 v64, 16, v242
v_and_b32 v65, 0xffff0000, v242
v_lshlrev_b32 v66, 16, v243
v_and_b32 v67, 0xffff0000, v243
v_pk_fma_f32 v[84:85], v[84:85], v[64:65], v[104:105]
v_pk_fma_f32 v[86:87], v[86:87], v[66:67], v[106:107]
s_waitcnt lgkmcnt(2)
v_lshlrev_b32 v68, 16, v244
v_and_b32 v69, 0xffff0000, v244
v_lshlrev_b32 v70, 16, v245
v_and_b32 v71, 0xffff0000, v245
v_pk_fma_f32 v[88:89], v[88:89], v[68:69], v[108:109]
v_pk_fma_f32 v[90:91], v[90:91], v[70:71], v[110:111]
s_waitcnt lgkmcnt(1)
v_lshlrev_b32 v72, 16, v246
v_and_b32 v73, 0xffff0000, v246
v_lshlrev_b32 v74, 16, v247
v_and_b32 v75, 0xffff0000, v247
v_pk_fma_f32 v[92:93], v[92:93], v[72:73], v[112:113]
v_pk_fma_f32 v[94:95], v[94:95], v[74:75], v[114:115]
s_waitcnt lgkmcnt(0)
ds_add_u32 v250, v251 offset:16
v_lshlrev_b32 v76, 16, v248
v_and_b32 v77, 0xffff0000, v248
v_lshlrev_b32 v78, 16, v249
v_and_b32 v79, 0xffff0000, v249
v_pk_fma_f32 v[96:97], v[96:97], v[76:77], v[116:117]
v_pk_fma_f32 v[98:99], v[98:99], v[78:79], v[118:119]
s_branch M_gate
M_layer:
v_mov_b32 v240, 0
v_mov_b32 v241, 0
v_mov_b32 v242, 0x3f803f80
v_dot2c_f32_bf16 v240, v128, v242
v_dot2c_f32_bf16 v241, v128, v128
v_dot2c_f32_bf16 v240, v129, v242
v_dot2c_f32_bf16 v241, v129, v129
v_dot2c_f32_bf16 v240, v130, v242
v_dot2c_f32_bf16 v241, v130, v130
v_dot2c_f32_bf16 v240, v131, v242
v_dot2c_f32_bf16 v241, v131, v131
v_dot2c_f32_bf16 v240, v132, v242
v_dot2c_f32_bf16 v241, v132, v132
v_dot2c_f32_bf16 v240, v133, v242
v_dot2c_f32_bf16 v241, v133, v133
v_dot2c_f32_bf16 v240, v134, v242
v_dot2c_f32_bf16 v241, v134, v134
v_dot2c_f32_bf16 v240, v135, v242
v_dot2c_f32_bf16 v241, v135, v135
v_dot2c_f32_bf16 v240, v136, v242
v_dot2c_f32_bf16 v241, v136, v136
v_dot2c_f32_bf16 v240, v137, v242
v_dot2c_f32_bf16 v241, v137, v137
s_nop 2
v_permlane16_swap_b32 v240, v241
v_add_f32 v240, v240, v241
v_mov_b32 v241, v240
s_nop 1
v_permlane32_swap_b32 v240, v241
v_add_f32 v243, v240, v241
s_add_u32 s48, s62, 0
s_mov_b32 exec_hi, 0
s_cmp_lg_u32 s19, 0
s_cbranch_scc1 M_slow_1
buffer_store_dword v243, v10, s[4:7], s48 offen
M_back_2:
s_mov_b64 exec, -1
v_lshlrev_b32 v100, 16, v128
v_and_b32 v101, 0xffff0000, v128
v_lshlrev_b32 v102, 16, v129
v_and_b32 v103, 0xffff0000, v129
v_lshlrev_b32 v104, 16, v130
v_and_b32 v105, 0xffff0000, v130
v_lshlrev_b32 v106, 16, v131
v_and_b32 v107, 0xffff0000, v131
v_lshlrev_b32 v108, 16, v132
v_and_b32 v109, 0xffff0000, v132
v_lshlrev_b32 v110, 16, v133
v_and_b32 v111, 0xffff0000, v133
v_lshlrev_b32 v112, 16, v134
v_and_b32 v113, 0xffff0000, v134
v_lshlrev_b32 v114, 16, v135
v_and_b32 v115, 0xffff0000, v135
v_lshlrev_b32 v116, 16, v136
v_and_b32 v117, 0xffff0000, v136
v_lshlrev_b32 v118, 16, v137
v_and_b32 v119, 0xffff0000, v137
s_cmp_lg_u32 s19, 0
s_cselect_b32 s52, 0xff000000, 0
s_cselect_b32 s60, 24117248, 0
s_add_u32 s61, s61, s52
v_mov_b32 v1, s52
v_mov_b32 v3, 557056
s_mov_b32 s53, 40370176
v_add_u32 v24, s52, v24
v_add_u32 v25, s52, v25
v_add_u32 v26, s52, v26
v_add_u32 v23, 557056, v23
v_add_u32 v250, 4, v250
v_add_u32 v252, 4, v252
v_cmp_le_u32 vcc, s53, v17
s_nop 1
v_cndmask_b32 v246, v1, v3, vcc
v_add_u32 v17, v17, v246
v_cmp_le_u32 vcc, s53, v18
s_nop 1
v_cndmask_b32 v246, v1, v3, vcc
v_add_u32 v18, v18, v246
v_cmp_le_u32 vcc, s53, v19
s_nop 1
v_cndmask_b32 v246, v1, v3, vcc
v_add_u32 v19, v19, v246
v_cmp_le_u32 vcc, s53, v20
s_nop 1
v_cndmask_b32 v246, v1, v3, vcc
v_add_u32 v20, v20, v246
v_cmp_le_u32 vcc, s53, v21
s_nop 1
v_cndmask_b32 v246, v1, v3, vcc
v_add_u32 v21, v21, v246
v_cmp_le_u32 vcc, s53, v22
s_nop 1
v_cndmask_b32 v246, v1, v3, vcc
v_add_u32 v22, v22, v246
M_poll_3:
buffer_load_dwordx4 v[232:235], v11, s[4:7], s48 offen offset:0 sc1
s_cmp_eq_u32 s22, 0
s_cbranch_scc1 M_pout_4
s_sub_u32 s22, s22, 1
s_waitcnt vmcnt(0)
v_max3_u32 v1, v232, v233, v234
v_max_u32 v1, v1, v235
v_cmp_eq_u32 vcc, -1, v1
s_cbranch_vccnz M_poll_3
M_pout_4:
s_waitcnt vmcnt(0)
v_add_f32 v1, v232, v234
v_add_f32 v3, v233, v235
s_nop 1
v_permlane16_swap_b32 v1, v3
v_add_f32 v1, v1, v3
v_mov_b32 v3, v1
s_nop 1
v_permlane32_swap_b32 v1, v3
v_add_f32 v1, v1, v3
v_mov_b32 v3, v1
s_nop 1
v_permlane16_swap_b32 v1, v3
v_mul_f32 v32, 0x3acccccd, v1
v_mul_f32 v3, 0x3acccccd, v3
v_fma_f32 v3, -v32, v32, v3
v_max_f32 v3, 0, v3
v_add_f32 v1, 0x3727c5ac, v3
v_rsq_f32 v34, v1
s_nop 0
v_mul_f32 v2, v32, v34
v_sub_f32 v2, 0, v2
v_pk_fma_f32 v[80:81], v[100:101], v[34:35], v[2:3] op_sel_hi:[1,0,0]
v_pk_fma_f32 v[80:81], v[80:81], v[60:61], v[100:101]
v_pk_fma_f32 v[82:83], v[102:103], v[34:35], v[2:3] op_sel_hi:[1,0,0]
v_pk_fma_f32 v[82:83], v[82:83], v[62:63], v[102:103]
v_pk_fma_f32 v[84:85], v[104:105], v[34:35], v[2:3] op_sel_hi:[1,0,0]
v_pk_fma_f32 v[84:85], v[84:85], v[64:65], v[104:105]
v_pk_fma_f32 v[86:87], v[106:107], v[34:35], v[2:3] op_sel_hi:[1,0,0]
v_pk_fma_f32 v[86:87], v[86:87], v[66:67], v[106:107]
v_pk_fma_f32 v[88:89], v[108:109], v[34:35], v[2:3] op_sel_hi:[1,0,0]
v_pk_fma_f32 v[88:89], v[88:89], v[68:69], v[108:109]
v_pk_fma_f32 v[90:91], v[110:111], v[34:35], v[2:3] op_sel_hi:[1,0,0]
v_pk_fma_f32 v[90:91], v[90:91], v[70:71], v[110:111]
v_pk_fma_f32 v[92:93], v[112:113], v[34:35], v[2:3] op_sel_hi:[1,0,0]
v_pk_fma_f32 v[92:93], v[92:93], v[72:73], v[112:113]
v_pk_fma_f32 v[94:95], v[114:115], v[34:35], v[2:3] op_sel_hi:[1,0,0]
v_pk_fma_f32 v[94:95], v[94:95], v[74:75], v[114:115]
v_pk_fma_f32 v[96:97], v[116:117], v[34:35], v[2:3] op_sel_hi:[1,0,0]
v_pk_fma_f32 v[96:97], v[96:97], v[76:77], v[116:117]
v_pk_fma_f32 v[98:99], v[118:119], v[34:35], v[2:3] op_sel_hi:[1,0,0]
v_pk_fma_f32 v[98:99], v[98:99], v[78:79], v[118:119]
M_gate:
v_cvt_pk_bf16_f32 v128, v80, v81
v_cvt_pk_bf16_f32 v129, v82, v83
v_cvt_pk_bf16_f32 v130, v84, v85
v_cvt_pk_bf16_f32 v131, v86, v87
v_cvt_pk_bf16_f32 v132, v88, v89
v_cvt_pk_bf16_f32 v133, v90, v91
v_cvt_pk_bf16_f32 v134, v92, v93
v_cvt_pk_bf16_f32 v135, v94, v95
v_cvt_pk_bf16_f32 v136, v96, v97
v_cvt_pk_bf16_f32 v137, v98, v99
v_mov_b32 v140, v136
v_mov_b32 v141, v137
v_mov_b32 v142, v136
v_mov_b32 v143, v137
s_nop 0
v_permlane16_swap_b32 v140, v142
v_permlane16_swap_b32 v141, v143
s_cmp_lg_u32 s19, 0
s_cbranch_scc1 M_slow_5
buffer_store_dwordx4 v[128:131], v8, s[4:7], s60 offen
buffer_store_dwordx4 v[132:135], v8, s[4:7], s60 offen offset:1024
s_mov_b64 exec, s[44:45]
buffer_store_dwordx4 v[140:143], v9, s[4:7], s60 offen
s_mov_b64 exec, -1
M_back_6:
v_mov_b32 v240, 0
v_mov_b32 v241, 0
v_mov_b32 v242, 0x3f803f80
v_dot2c_f32_bf16 v240, v128, v242
v_dot2c_f32_bf16 v241, v128, v128
v_dot2c_f32_bf16 v240, v129, v242
v_dot2c_f32_bf16 v241, v129, v129
v_dot2c_f32_bf16 v240, v130, v242
v_dot2c_f32_bf16 v241, v130, v130
v_dot2c_f32_bf16 v240, v131, v242
v_dot2c_f32_bf16 v241, v131, v131
v_dot2c_f32_bf16 v240, v132, v242
v_dot2c_f32_bf16 v241, v132, v132
v_dot2c_f32_bf16 v240, v133, v242
v_dot2c_f32_bf16 v241, v133, v133
v_dot2c_f32_bf16 v240, v134, v242
v_dot2c_f32_bf16 v241, v134, v134
v_dot2c_f32_bf16 v240, v135, v242
v_dot2c_f32_bf16 v241, v135, v135
v_dot2c_f32_bf16 v240, v136, v242
v_dot2c_f32_bf16 v241, v136, v136
v_dot2c_f32_bf16 v240, v137, v242
v_dot2c_f32_bf16 v241, v137, v137
s_nop 2
v_permlane16_swap_b32 v240, v241
v_add_f32 v240, v240, v241
v_mov_b32 v241, v240
s_nop 1
v_permlane32_swap_b32 v240, v241
v_add_f32 v243, v240, v241
s_add_u32 s48, s62, 131072
s_mov_b32 exec_hi, 0
s_cmp_lg_u32 s19, 0
s_cbranch_scc1 M_slow_7
buffer_store_dword v243, v10, s[4:7], s48 offen
M_back_8:
s_mov_b64 exec, -1
v_add_u32 v31, s60, v7
v_mov_b32 v1, 160528
M_yw:
ds_read_b32 v3, v1
s_cmp_eq_u32 s22, 0
s_cbranch_scc1 M_ywo
s_sub_u32 s22, s22, 1
s_waitcnt lgkmcnt(0)
v_cmp_ne_u32 vcc, 0x81818181, v3
s_cbranch_vccnz M_yw
M_ywo:
s_add_u32 s50, s21, 1
v_mov_b32 v1, s50
s_mov_b64 exec, 1
s_cmp_lg_u32 s19, 0
s_cbranch_scc1 M_slow_9
s_waitcnt vmcnt(1)
buffer_store_dword v1, off, s[4:7], s23
M_back_10:
s_mov_b64 exec, -1
v_lshlrev_b32 v80, 16, v128
v_and_b32 v81, 0xffff0000, v128
v_lshlrev_b32 v82, 16, v129
v_and_b32 v83, 0xffff0000, v129
v_lshlrev_b32 v84, 16, v130
v_and_b32 v85, 0xffff0000, v130
v_lshlrev_b32 v86, 16, v131
v_and_b32 v87, 0xffff0000, v131
v_lshlrev_b32 v88, 16, v132
v_and_b32 v89, 0xffff0000, v132
v_lshlrev_b32 v90, 16, v133
v_and_b32 v91, 0xffff0000, v133
v_lshlrev_b32 v92, 16, v134
v_and_b32 v93, 0xffff0000, v134
v_lshlrev_b32 v94, 16, v135
v_and_b32 v95, 0xffff0000, v135
v_lshlrev_b32 v96, 16, v136
v_and_b32 v97, 0xffff0000, v136
v_lshlrev_b32 v98, 16, v137
v_and_b32 v99, 0xffff0000, v137
M_poll_11:
buffer_load_dword v1, v13, s[4:7], 0 offen sc1
s_cmp_eq_u32 s22, 0
s_cbranch_scc1 M_pout_12
s_sub_u32 s22, s22, 1
s_waitcnt vmcnt(0)
v_cmp_gt_u32 vcc, s50, v1
s_cbranch_vccnz M_poll_11
M_pout_12:
buffer_load_dwordx4 v[192:195], v31, s[4:7], s24 offen offset:0 sc1
buffer_load_dwordx4 v[196:199], v31, s[4:7], s24 offen offset:1024 sc1
buffer_load_dwordx4 v[200:203], v31, s[4:7], s24 offen offset:2048 sc1
buffer_load_dwordx4 v[204:207], v31, s[4:7], s24 offen offset:3072 sc1
buffer_load_dwordx4 v[208:211], v31, s[4:7], s25 offen offset:0 sc1
buffer_load_dwordx4 v[212:215], v31, s[4:7], s25 offen offset:1024 sc1
buffer_load_dwordx4 v[216:219], v31, s[4:7], s25 offen offset:2048 sc1
buffer_load_dwordx4 v[220:223], v31, s[4:7], s25 offen offset:3072 sc1
buffer_load_dwordx4 v[224:227], v31, s[4:7], s26 offen offset:0 sc1
ds_read_b32 v253, v252
s_waitcnt lgkmcnt(0)
v_subrev_u32 v253, 0x1010101, v253
v_and_b32 v253, s82, v253
v_cmp_ne_u32 vcc, s82, v253
s_cbranch_vccnz M_lsp_13
M_lspo_14:
ds_read_b128 v[152:155], v4 offset:0
ds_read_b128 v[156:159], v4 offset:1024
ds_read_b128 v[160:163], v4 offset:2048
ds_read_b128 v[164:167], v4 offset:3072
ds_read_b128 v[168:171], v4 offset:4096
ds_read_b128 v[172:175], v4 offset:5120
ds_read_b128 v[176:179], v4 offset:6144
ds_read_b128 v[180:183], v4 offset:7168
ds_read_b128 v[184:187], v4 offset:8192
ds_read_b128 v[188:191], v4 offset:9216
s_waitcnt vmcnt(8) lgkmcnt(5)
v_mfma_f32_16x16x32_bf16 v[100:103], v[152:155], v[192:195], 0
ds_read_b128 v[152:155], v4 offset:10240
v_mfma_f32_16x16x32_bf16 v[104:107], v[156:159], v[192:195], 0
ds_read_b128 v[156:159], v4 offset:11264
buffer_load_dwordx4 v[228:231], v31, s[4:7], s26 offen offset:1024 sc1
v_mfma_f32_16x16x32_bf16 v[108:111], v[160:163], v[192:195], 0
ds_read_b128 v[160:163], v4 offset:12288
v_mfma_f32_16x16x32_bf16 v[112:115], v[164:167], v[192:195], 0
ds_read_b128 v[164:167], v4 offset:13312
v_mfma_f32_16x16x32_bf16 v[116:119], v[168:171], v[192:195], 0
ds_read_b128 v[168:171], v4 offset:14336
s_waitcnt vmcnt(8) lgkmcnt(5)
v_mfma_f32_16x16x32_bf16 v[100:103], v[172:175], v[196:199], v[100:103]
ds_read_b128 v[172:175], v4 offset:15360
v_mfma_f32_16x16x32_bf16 v[104:107], v[176:179], v[196:199], v[104:107]
ds_read_b128 v[176:179], v4 offset:16384
buffer_load_dwordx4 v[192:195], v31, s[4:7], s26 offen offset:2048 sc1
v_mfma_f32_16x16x32_bf16 v[108:111], v[180:183], v[196:199], v[108:111]
ds_read_b128 v[180:183], v4 offset:17408
v_mfma_f32_16x16x32_bf16 v[112:115], v[184:187], v[196:199], v[112:115]
ds_read_b128 v[184:187], v4 offset:18432
v_mfma_f32_16x16x32_bf16 v[116:119], v[188:191], v[196:199], v[116:119]
ds_read_b128 v[188:191], v4 offset:19456
s_waitcnt vmcnt(8) lgkmcnt(5)
v_mfma_f32_16x16x32_bf16 v[100:103], v[152:155], v[200:203], v[100:103]
ds_read_b128 v[152:155], v4 offset:20480
v_mfma_f32_16x16x32_bf16 v[104:107], v[156:159], v[200:203], v[104:107]
ds_read_b128 v[156:159], v4 offset:21504
buffer_load_dwordx4 v[196:199], v31, s[4:7], s26 offen offset:3072 sc1
v_mfma_f32_16x16x32_bf16 v[108:111], v[160:163], v[200:203], v[108:111]
ds_read_b128 v[160:163], v4 offset:22528
v_mfma_f32_16x16x32_bf16 v[112:115], v[164:167], v[200:203], v[112:115]
ds_read_b128 v[164:167], v4 offset:23552
v_mfma_f32_16x16x32_bf16 v[116:119], v[168:171], v[200:203], v[116:119]
ds_read_b128 v[168:171], v4 offset:24576
s_waitcnt vmcnt(8) lgkmcnt(5)
v_mfma_f32_16x16x32_bf16 v[100:103], v[172:175], v[204:207], v[100:103]
ds_read_b128 v[172:175], v4 offset:25600
v_mfma_f32_16x16x32_bf16 v[104:107], v[176:179], v[204:207], v[104:107]
ds_read_b128 v[176:179], v4 offset:26624
buffer_load_dwordx4 v[200:203], v31, s[4:7], s27 offen offset:0 sc1
v_mfma_f32_16x16x32_bf16 v[108:111], v[180:183], v[204:207], v[108:111]
ds_read_b128 v[180:183], v4 offset:27648
ds_add_u32 v250, v251
v_mfma_f32_16x16x32_bf16 v[112:115], v[184:187], v[204:207], v[112:115]
ds_read_b128 v[184:187], v4 offset:28672
v_mfma_f32_16x16x32_bf16 v[116:119], v[188:191], v[204:207], v[116:119]
ds_read_b128 v[188:191], v4 offset:29696
s_waitcnt vmcnt(8) lgkmcnt(6)
v_mfma_f32_16x16x32_bf16 v[100:103], v[152:155], v[208:211], v[100:103]
ds_read_b128 v[152:155], v4 offset:30720
v_mfma_f32_16x16x32_bf16 v[104:107], v[156:159], v[208:211], v[104:107]
ds_read_b128 v[156:159], v4 offset:31744
buffer_load_dwordx4 v[204:207], v31, s[4:7], s27 offen offset:1024 sc1
v_mfma_f32_16x16x32_bf16 v[108:111], v[160:163], v[208:211], v[108:111]
ds_read_b128 v[160:163], v4 offset:32768
v_mfma_f32_16x16x32_bf16 v[112:115], v[164:167], v[208:211], v[112:115]
ds_read_b128 v[164:167], v4 offset:33792
v_mfma_f32_16x16x32_bf16 v[116:119], v[168:171], v[208:211], v[116:119]
ds_read_b128 v[168:171], v4 offset:34816
s_waitcnt vmcnt(8) lgkmcnt(5)
v_mfma_f32_16x16x32_bf16 v[100:103], v[172:175], v[212:215], v[100:103]
ds_read_b128 v[172:175], v4 offset:35840
v_mfma_f32_16x16x32_bf16 v[104:107], v[176:179], v[212:215], v[104:107]
ds_read_b128 v[176:179], v4 offset:36864
buffer_load_dwordx4 v[208:211], v31, s[4:7], s27 offen offset:2048 sc1
v_mfma_f32_16x16x32_bf16 v[108:111], v[180:183], v[212:215], v[108:111]
ds_read_b128 v[180:183], v4 offset:37888
v_mfma_f32_16x16x32_bf16 v[112:115], v[184:187], v[212:215], v[112:115]
ds_read_b128 v[184:187], v4 offset:38912
v_mfma_f32_16x16x32_bf16 v[116:119], v[188:191], v[212:215], v[116:119]
ds_read_b128 v[188:191], v4 offset:39936
s_waitcnt vmcnt(8) lgkmcnt(5)
v_mfma_f32_16x16x32_bf16 v[100:103], v[152:155], v[216:219], v[100:103]
ds_read_b128 v[152:155], v4 offset:40960
v_mfma_f32_16x16x32_bf16 v[104:107], v[156:159], v[216:219], v[104:107]
ds_read_b128 v[156:159], v4 offset:41984
buffer_load_dwordx4 v[212:215], v31, s[4:7], s27 offen offset:3072 sc1
v_mfma_f32_16x16x32_bf16 v[108:111], v[160:163], v[216:219], v[108:111]
ds_read_b128 v[160:163], v4 offset:43008
v_mfma_f32_16x16x32_bf16 v[112:115], v[164:167], v[216:219], v[112:115]
ds_read_b128 v[164:167], v4 offset:44032
v_mfma_f32_16x16x32_bf16 v[116:119], v[168:171], v[216:219], v[116:119]
ds_read_b128 v[168:171], v4 offset:45056
s_waitcnt vmcnt(8) lgkmcnt(5)
v_mfma_f32_16x16x32_bf16 v[100:103], v[172:175], v[220:223], v[100:103]
ds_read_b128 v[172:175], v4 offset:46080
v_mfma_f32_16x16x32_bf16 v[104:107], v[176:179], v[220:223], v[104:107]
ds_read_b128 v[176:179], v4 offset:47104
buffer_load_dwordx4 v[216:219], v31, s[4:7], s28 offen offset:0 sc1
v_mfma_f32_16x16x32_bf16 v[108:111], v[180:183], v[220:223], v[108:111]
ds_read_b128 v[180:183], v4 offset:48128
ds_add_u32 v250, v251
v_mfma_f32_16x16x32_bf16 v[112:115], v[184:187], v[220:223], v[112:115]
ds_read_b128 v[184:187], v4 offset:49152
v_mfma_f32_16x16x32_bf16 v[116:119], v[188:191], v[220:223], v[116:119]
ds_read_b128 v[188:191], v4 offset:50176
s_waitcnt vmcnt(8) lgkmcnt(6)
v_mfma_f32_16x16x32_bf16 v[100:103], v[152:155], v[224:227], v[100:103]
ds_read_b128 v[152:155], v4 offset:51200
v_mfma_f32_16x16x32_bf16 v[104:107], v[156:159], v[224:227], v[104:107]
ds_read_b128 v[156:159], v4 offset:52224
buffer_load_dwordx4 v[220:223], v31, s[4:7], s28 offen offset:1024 sc1
v_mfma_f32_16x16x32_bf16 v[108:111], v[160:163], v[224:227], v[108:111]
ds_read_b128 v[160:163], v4 offset:53248
v_mfma_f32_16x16x32_bf16 v[112:115], v[164:167], v[224:227], v[112:115]
ds_read_b128 v[164:167], v4 offset:54272
v_mfma_f32_16x16x32_bf16 v[116:119], v[168:171], v[224:227], v[116:119]
ds_read_b128 v[168:171], v4 offset:55296
s_waitcnt vmcnt(8) lgkmcnt(5)
v_mfma_f32_16x16x32_bf16 v[100:103], v[172:175], v[228:231], v[100:103]
ds_read_b128 v[172:175], v4 offset:56320
v_mfma_f32_16x16x32_bf16 v[104:107], v[176:179], v[228:231], v[104:107]
ds_read_b128 v[176:179], v4 offset:57344
buffer_load_dwordx4 v[224:227], v31, s[4:7], s28 offen offset:2048 sc1
v_mfma_f32_16x16x32_bf16 v[108:111], v[180:183], v[228:231], v[108:111]
ds_read_b128 v[180:183], v4 offset:58368
v_mfma_f32_16x16x32_bf16 v[112:115], v[184:187], v[228:231], v[112:115]
ds_read_b128 v[184:187], v4 offset:59392
v_mfma_f32_16x16x32_bf16 v[116:119], v[188:191], v[228:231], v[116:119]
ds_read_b128 v[188:191], v4 offset:60416
s_waitcnt vmcnt(8) lgkmcnt(5)
v_mfma_f32_16x16x32_bf16 v[100:103], v[152:155], v[192:195], v[100:103]
ds_read_b128 v[152:155], v4 offset:61440
v_mfma_f32_16x16x32_bf16 v[104:107], v[156:159], v[192:195], v[104:107]
ds_read_b128 v[156:159], v4 offset:62464
buffer_load_dwordx4 v[228:231], v31, s[4:7], s28 offen offset:3072 sc1
v_mfma_f32_16x16x32_bf16 v[108:111], v[160:163], v[192:195], v[108:111]
ds_read_b128 v[160:163], v4 offset:63488
v_mfma_f32_16x16x32_bf16 v[112:115], v[164:167], v[192:195], v[112:115]
ds_read_b128 v[164:167], v4 offset:64512
v_mfma_f32_16x16x32_bf16 v[116:119], v[168:171], v[192:195], v[116:119]
ds_read_b128 v[168:171], v5 offset:0
s_waitcnt vmcnt(8) lgkmcnt(5)
buffer_load_dwordx4 v[232:235], v11, s[4:7], s48 offen offset:0 sc1
v_mfma_f32_16x16x32_bf16 v[100:103], v[172:175], v[196:199], v[100:103]
ds_read_b128 v[172:175], v5 offset:1024
v_mfma_f32_16x16x32_bf16 v[104:107], v[176:179], v[196:199], v[104:107]
ds_read_b128 v[176:179], v5 offset:2048
v_mfma_f32_16x16x32_bf16 v[108:111], v[180:183], v[196:199], v[108:111]
ds_read_b128 v[180:183], v5 offset:3072
ds_add_u32 v250, v251
v_mfma_f32_16x16x32_bf16 v[112:115], v[184:187], v[196:199], v[112:115]
ds_read_b128 v[184:187], v5 offset:4096
v_mfma_f32_16x16x32_bf16 v[116:119], v[188:191], v[196:199], v[116:119]
ds_read_b128 v[188:191], v5 offset:5120
s_waitcnt vmcnt(8) lgkmcnt(6)
v_mfma_f32_16x16x32_bf16 v[100:103], v[152:155], v[200:203], v[100:103]
ds_read_b128 v[152:155], v5 offset:6144
v_mfma_f32_16x16x32_bf16 v[104:107], v[156:159], v[200:203], v[104:107]
ds_read_b128 v[156:159], v5 offset:7168
v_mfma_f32_16x16x32_bf16 v[108:111], v[160:163], v[200:203], v[108:111]
ds_read_b128 v[160:163], v5 offset:8192
v_mfma_f32_16x16x32_bf16 v[112:115], v[164:167], v[200:203], v[112:115]
ds_read_b128 v[164:167], v5 offset:9216
v_mfma_f32_16x16x32_bf16 v[116:119], v[168:171], v[200:203], v[116:119]
ds_read_b128 v[168:171], v5 offset:10240
s_waitcnt vmcnt(7) lgkmcnt(5)
v_mfma_f32_16x16x32_bf16 v[100:103], v[172:175], v[204:207], v[100:103]
ds_read_b128 v[172:175], v5 offset:11264
v_mfma_f32_16x16x32_bf16 v[104:107], v[176:179], v[204:207], v[104:107]
ds_read_b128 v[176:179], v5 offset:12288
v_mfma_f32_16x16x32_bf16 v[108:111], v[180:183], v[204:207], v[108:111]
ds_read_b128 v[180:183], v5 offset:13312
v_mfma_f32_16x16x32_bf16 v[112:115], v[184:187], v[204:207], v[112:115]
ds_read_b128 v[184:187], v5 offset:14336
v_mfma_f32_16x16x32_bf16 v[116:119], v[188:191], v[204:207], v[116:119]
ds_read_b128 v[188:191], v5 offset:15360
s_waitcnt vmcnt(6) lgkmcnt(5)
v_mfma_f32_16x16x32_bf16 v[100:103], v[152:155], v[208:211], v[100:103]
ds_read_b128 v[152:155], v5 offset:16384
v_mfma_f32_16x16x32_bf16 v[104:107], v[156:159], v[208:211], v[104:107]
ds_read_b128 v[156:159], v5 offset:17408
v_mfma_f32_16x16x32_bf16 v[108:111], v[160:163], v[208:211], v[108:111]
ds_read_b128 v[160:163], v5 offset:18432
v_mfma_f32_16x16x32_bf16 v[112:115], v[164:167], v[208:211], v[112:115]
ds_read_b128 v[164:167], v5 offset:19456
v_mfma_f32_16x16x32_bf16 v[116:119], v[168:171], v[208:211], v[116:119]
ds_read_b128 v[168:171], v5 offset:20480
s_waitcnt vmcnt(5) lgkmcnt(5)
v_mfma_f32_16x16x32_bf16 v[100:103], v[172:175], v[212:215], v[100:103]
ds_read_b128 v[172:175], v5 offset:21504
v_mfma_f32_16x16x32_bf16 v[104:107], v[176:179], v[212:215], v[104:107]
ds_read_b128 v[176:179], v5 offset:22528
v_mfma_f32_16x16x32_bf16 v[108:111], v[180:183], v[212:215], v[108:111]
ds_read_b128 v[180:183], v5 offset:23552
ds_add_u32 v250, v251
v_mfma_f32_16x16x32_bf16 v[112:115], v[184:187], v[212:215], v[112:115]
ds_read_b128 v[184:187], v5 offset:24576
v_mfma_f32_16x16x32_bf16 v[116:119], v[188:191], v[212:215], v[116:119]
ds_read_b128 v[188:191], v5 offset:25600
s_waitcnt vmcnt(4) lgkmcnt(6)
v_mfma_f32_16x16x32_bf16 v[100:103], v[152:155], v[216:219], v[100:103]
ds_read_b128 v[152:155], v5 offset:26624
v_mfma_f32_16x16x32_bf16 v[104:107], v[156:159], v[216:219], v[104:107]
ds_read_b128 v[156:159], v5 offset:27648
v_mfma_f32_16x16x32_bf16 v[108:111], v[160:163], v[216:219], v[108:111]
ds_read_b128 v[160:163], v5 offset:28672
v_mfma_f32_16x16x32_bf16 v[112:115], v[164:167], v[216:219], v[112:115]
ds_read_b128 v[164:167], v5 offset:29696
v_mfma_f32_16x16x32_bf16 v[116:119], v[168:171], v[216:219], v[116:119]
ds_read_b128 v[168:171], v5 offset:30720
s_waitcnt vmcnt(3) lgkmcnt(5)
v_mfma_f32_16x16x32_bf16 v[100:103], v[172:175], v[220:223], v[100:103]
ds_read_b128 v[172:175], v5 offset:31744
v_mfma_f32_16x16x32_bf16 v[104:107], v[176:179], v[220:223], v[104:107]
ds_read_b128 v[176:179], v5 offset:32768
v_mfma_f32_16x16x32_bf16 v[108:111], v[180:183], v[220:223], v[108:111]
ds_read_b128 v[180:183], v5 offset:33792
v_mfma_f32_16x16x32_bf16 v[112:115], v[184:187], v[220:223], v[112:115]
ds_read_b128 v[184:187], v5 offset:34816
v_mfma_f32_16x16x32_bf16 v[116:119], v[188:191], v[220:223], v[116:119]
ds_read_b128 v[188:191], v5 offset:35840
s_waitcnt vmcnt(2) lgkmcnt(5)
v_mfma_f32_16x16x32_bf16 v[100:103], v[152:155], v[224:227], v[100:103]
v_mfma_f32_16x16x32_bf16 v[104:107], v[156:159], v[224:227], v[104:107]
v_mfma_f32_16x16x32_bf16 v[108:111], v[160:163], v[224:227], v[108:111]
v_mfma_f32_16x16x32_bf16 v[112:115], v[164:167], v[224:227], v[112:115]
v_mfma_f32_16x16x32_bf16 v[116:119], v[168:171], v[224:227], v[116:119]
s_waitcnt vmcnt(0) lgkmcnt(0)
v_mfma_f32_16x16x32_bf16 v[100:103], v[172:175], v[228:231], v[100:103]
v_mfma_f32_16x16x32_bf16 v[104:107], v[176:179], v[228:231], v[104:107]
v_mfma_f32_16x16x32_bf16 v[108:111], v[180:183], v[228:231], v[108:111]
ds_add_u32 v250, v251
v_mfma_f32_16x16x32_bf16 v[112:115], v[184:187], v[228:231], v[112:115]
v_mfma_f32_16x16x32_bf16 v[116:119], v[188:191], v[228:231], v[116:119]
ds_read_b128 v[152:155], v27 offset:0
ds_read_b128 v[156:159], v27 offset:64
ds_read_b128 v[160:163], v27 offset:128
ds_read_b128 v[164:167], v27 offset:192
ds_read_b128 v[168:171], v27 offset:256
v_max3_u32 v1, v232, v233, v234
v_max_u32 v1, v1, v235
v_cmp_eq_u32 vcc, -1, v1
s_cbranch_vccnz M_sp_15
M_spo_16:
v_add_f32 v1, v232, v234
v_add_f32 v3, v233, v235
s_nop 1
v_permlane16_swap_b32 v1, v3
v_add_f32 v1, v1, v3
v_mov_b32 v3, v1
s_nop 1
v_permlane32_swap_b32 v1, v3
v_add_f32 v1, v1, v3
v_mov_b32 v3, v1
s_nop 1
v_permlane16_swap_b32 v1, v3
v_mul_f32 v32, 0x3acccccd, v1
v_mul_f32 v3, 0x3acccccd, v3
v_fma_f32 v3, -v32, v32, v3
v_max_f32 v3, 0, v3
v_add_f32 v1, 0x3727c5ac, v3
v_rsq_f32 v34, v1
s_nop 0
v_mul_f32 v3, v3, v34
v_mul_f32 v3, v3, v34
v_add_f32 v3, 0x3727c5ac, v3
v_rsq_f32 v3, v3
s_nop 0
v_mul_f32 v3, v3, v34
v_mul_f32 v36, 0xc0135761, v3
v_mul_f32 v1, v3, v3
v_mul_f32 v1, v1, v3
v_mul_f32 v38, 0xbdd2d3e8, v1
v_rcp_f32 v30, v3
v_sub_f32 v2, 0, v32
s_waitcnt lgkmcnt(0)
v_pk_fma_f32 v[100:101], v[152:153], v[2:3], v[100:101] op_sel_hi:[1,0,1]
v_pk_fma_f32 v[102:103], v[154:155], v[2:3], v[102:103] op_sel_hi:[1,0,1]
v_pk_mul_f32 v[240:241], v[100:101], v[100:101]
v_pk_mul_f32 v[244:245], v[102:103], v[102:103]
v_pk_fma_f32 v[240:241], v[240:241], v[38:39], v[36:37] op_sel_hi:[1,0,0]
v_pk_fma_f32 v[244:245], v[244:245], v[38:39], v[36:37] op_sel_hi:[1,0,0]
v_pk_mul_f32 v[240:241], v[240:241], v[100:101]
v_pk_mul_f32 v[244:245], v[244:245], v[102:103]
v_exp_f32 v240, v240
v_exp_f32 v241, v241
v_exp_f32 v244, v244
v_exp_f32 v245, v245
v_pk_fma_f32 v[240:241], v[240:241], v[30:31], v[30:31] op_sel_hi:[1,0,0]
v_pk_fma_f32 v[244:245], v[244:245], v[30:31], v[30:31] op_sel_hi:[1,0,0]
v_rcp_f32 v240, v240
v_rcp_f32 v241, v241
v_rcp_f32 v244, v244
v_rcp_f32 v245, v245
v_pk_mul_f32 v[240:241], v[240:241], v[100:101]
v_pk_mul_f32 v[244:245], v[244:245], v[102:103]
v_cvt_pk_bf16_f32 v128, v240, v241
v_cvt_pk_bf16_f32 v129, v244, v245
v_pk_fma_f32 v[104:105], v[156:157], v[2:3], v[104:105] op_sel_hi:[1,0,1]
v_pk_fma_f32 v[106:107], v[158:159], v[2:3], v[106:107] op_sel_hi:[1,0,1]
v_pk_mul_f32 v[240:241], v[104:105], v[104:105]
v_pk_mul_f32 v[244:245], v[106:107], v[106:107]
v_pk_fma_f32 v[240:241], v[240:241], v[38:39], v[36:37] op_sel_hi:[1,0,0]
v_pk_fma_f32 v[244:245], v[244:245], v[38:39], v[36:37] op_sel_hi:[1,0,0]
v_pk_mul_f32 v[240:241], v[240:241], v[104:105]
v_pk_mul_f32 v[244:245], v[244:245], v[106:107]
v_exp_f32 v240, v240
v_exp_f32 v241, v241
v_exp_f32 v244, v244
v_exp_f32 v245, v245
v_pk_fma_f32 v[240:241], v[240:241], v[30:31], v[30:31] op_sel_hi:[1,0,0]
v_pk_fma_f32 v[244:245], v[244:245], v[30:31], v[30:31] op_sel_hi:[1,0,0]
v_rcp_f32 v240, v240
v_rcp_f32 v241, v241
v_rcp_f32 v244, v244
v_rcp_f32 v245, v245
v_pk_mul_f32 v[240:241], v[240:241], v[104:105]
v_pk_mul_f32 v[244:245], v[244:245], v[106:107]
v_cvt_pk_bf16_f32 v130, v240, v241
v_cvt_pk_bf16_f32 v131, v244, v245
v_pk_fma_f32 v[108:109], v[160:161], v[2:3], v[108:109] op_sel_hi:[1,0,1]
v_pk_fma_f32 v[110:111], v[162:163], v[2:3], v[110:111] op_sel_hi:[1,0,1]
v_pk_mul_f32 v[240:241], v[108:109], v[108:109]
v_pk_mul_f32 v[244:245], v[110:111], v[110:111]
v_pk_fma_f32 v[240:241], v[240:241], v[38:39], v[36:37] op_sel_hi:[1,0,0]
v_pk_fma_f32 v[244:245], v[244:245], v[38:39], v[36:37] op_sel_hi:[1,0,0]
v_pk_mul_f32 v[240:241], v[240:241], v[108:109]
v_pk_mul_f32 v[244:245], v[244:245], v[110:111]
v_exp_f32 v240, v240
v_exp_f32 v241, v241
v_exp_f32 v244, v244
v_exp_f32 v245, v245
v_pk_fma_f32 v[240:241], v[240:241], v[30:31], v[30:31] op_sel_hi:[1,0,0]
v_pk_fma_f32 v[244:245], v[244:245], v[30:31], v[30:31] op_sel_hi:[1,0,0]
v_rcp_f32 v240, v240
v_rcp_f32 v241, v241
v_rcp_f32 v244, v244
v_rcp_f32 v245, v245
v_pk_mul_f32 v[240:241], v[240:241], v[108:109]
v_pk_mul_f32 v[244:245], v[244:245], v[110:111]
v_cvt_pk_bf16_f32 v132, v240, v241
v_cvt_pk_bf16_f32 v133, v244, v245
v_pk_fma_f32 v[112:113], v[164:165], v[2:3], v[112:113] op_sel_hi:[1,0,1]
v_pk_fma_f32 v[114:115], v[166:167], v[2:3], v[114:115] op_sel_hi:[1,0,1]
v_pk_mul_f32 v[240:241], v[112:113], v[112:113]
v_pk_mul_f32 v[244:245], v[114:115], v[114:115]
v_pk_fma_f32 v[240:241], v[240:241], v[38:39], v[36:37] op_sel_hi:[1,0,0]
v_pk_fma_f32 v[244:245], v[244:245], v[38:39], v[36:37] op_sel_hi:[1,0,0]
v_pk_mul_f32 v[240:241], v[240:241], v[112:113]
v_pk_mul_f32 v[244:245], v[244:245], v[114:115]
v_exp_f32 v240, v240
v_exp_f32 v241, v241
v_exp_f32 v244, v244
v_exp_f32 v245, v245
v_pk_fma_f32 v[240:241], v[240:241], v[30:31], v[30:31] op_sel_hi:[1,0,0]
v_pk_fma_f32 v[244:245], v[244:245], v[30:31], v[30:31] op_sel_hi:[1,0,0]
v_rcp_f32 v240, v240
v_rcp_f32 v241, v241
v_rcp_f32 v244, v244
v_rcp_f32 v245, v245
v_pk_mul_f32 v[240:241], v[240:241], v[112:113]
v_pk_mul_f32 v[244:245], v[244:245], v[114:115]
v_cvt_pk_bf16_f32 v134, v240, v241
v_cvt_pk_bf16_f32 v135, v244, v245
v_pk_fma_f32 v[116:117], v[168:169], v[2:3], v[116:117] op_sel_hi:[1,0,1]
v_pk_fma_f32 v[118:119], v[170:171], v[2:3], v[118:119] op_sel_hi:[1,0,1]
v_pk_mul_f32 v[240:241], v[116:117], v[116:117]
v_pk_mul_f32 v[244:245], v[118:119], v[118:119]
v_pk_fma_f32 v[240:241], v[240:241], v[38:39], v[36:37] op_sel_hi:[1,0,0]
v_pk_fma_f32 v[244:245], v[244:245], v[38:39], v[36:37] op_sel_hi:[1,0,0]
v_pk_mul_f32 v[240:241], v[240:241], v[116:117]
v_pk_mul_f32 v[244:245], v[244:245], v[118:119]
v_exp_f32 v240, v240
v_exp_f32 v241, v241
v_exp_f32 v244, v244
v_exp_f32 v245, v245
v_pk_fma_f32 v[240:241], v[240:241], v[30:31], v[30:31] op_sel_hi:[1,0,0]
v_pk_fma_f32 v[244:245], v[244:245], v[30:31], v[30:31] op_sel_hi:[1,0,0]
v_rcp_f32 v240, v240
v_rcp_f32 v241, v241
v_rcp_f32 v244, v244
v_rcp_f32 v245, v245
v_pk_mul_f32 v[240:241], v[240:241], v[116:117]
v_pk_mul_f32 v[244:245], v[244:245], v[118:119]
v_cvt_pk_bf16_f32 v136, v240, v241
v_cvt_pk_bf16_f32 v137, v244, v245
v_mov_b32 v140, v136
v_mov_b32 v141, v137
v_mov_b32 v142, v136
v_mov_b32 v143, v137
s_nop 0
v_permlane16_swap_b32 v140, v142
v_permlane16_swap_b32 v141, v143
s_cmp_lg_u32 s19, 0
s_cbranch_scc1 M_slow_17
s_mov_b64 exec, s[36:37]
buffer_store_dwordx4 v[128:131], v21, s[4:7], 0 offen
buffer_store_dwordx4 v[132:135], v21, s[4:7], 0 offen offset:1024
s_mov_b64 exec, s[38:39]
buffer_store_dwordx4 v[140:143], v22, s[4:7], 0 offen
M_back_18:
s_cmp_eq_u64 s[40:41], 0
s_cbranch_scc1 M_nohalo
s_mov_b64 exec, s[40:41]
s_cmp_eq_u32 s46, 0
s_cbranch_scc1 M_hnz
s_nop 1
v_mov_b32 v128, 0
v_mov_b32 v129, 0
v_mov_b32 v130, 0
v_mov_b32 v131, 0
v_mov_b32 v132, 0
v_mov_b32 v133, 0
v_mov_b32 v134, 0
v_mov_b32 v135, 0
v_mov_b32 v140, 0
v_mov_b32 v141, 0
v_mov_b32 v142, 0
v_mov_b32 v143, 0
M_hnz:
buffer_store_dwordx4 v[128:131], v21, s[4:7], 0 offen sc1
buffer_store_dwordx4 v[132:135], v21, s[4:7], 0 offen offset:1024 sc1
s_mov_b64 exec, s[42:43]
buffer_store_dwordx4 v[140:143], v22, s[4:7], 0 offen sc1
s_mov_b64 exec, -1
s_waitcnt vmcnt(3)
s_branch M_hpub
M_nohalo:
s_mov_b64 exec, -1
s_waitcnt vmcnt(0)
M_hpub:
s_add_u32 s50, s21, 2
v_mov_b32 v1, s50
s_mov_b64 exec, 1
s_cmp_lg_u32 s19, 0
s_cbranch_scc1 M_slow_19
buffer_store_dword v1, off, s[4:7], s23
M_back_20:
s_mov_b64 exec, -1
v_mul_f32 v2, v32, v34
v_sub_f32 v2, 0, v2
v_pk_fma_f32 v[100:101], v[80:81], v[34:35], v[2:3] op_sel_hi:[1,0,0]
v_pk_fma_f32 v[102:103], v[82:83], v[34:35], v[2:3] op_sel_hi:[1,0,0]
v_pk_fma_f32 v[104:105], v[84:85], v[34:35], v[2:3] op_sel_hi:[1,0,0]
v_pk_fma_f32 v[106:107], v[86:87], v[34:35], v[2:3] op_sel_hi:[1,0,0]
v_pk_fma_f32 v[108:109], v[88:89], v[34:35], v[2:3] op_sel_hi:[1,0,0]
v_pk_fma_f32 v[110:111], v[90:91], v[34:35], v[2:3] op_sel_hi:[1,0,0]
v_pk_fma_f32 v[112:113], v[92:93], v[34:35], v[2:3] op_sel_hi:[1,0,0]
v_pk_fma_f32 v[114:115], v[94:95], v[34:35], v[2:3] op_sel_hi:[1,0,0]
v_pk_fma_f32 v[116:117], v[96:97], v[34:35], v[2:3] op_sel_hi:[1,0,0]
v_pk_fma_f32 v[118:119], v[98:99], v[34:35], v[2:3] op_sel_hi:[1,0,0]
M_poll_21:
buffer_load_dword v1, v14, s[4:7], 0 offen sc1
s_cmp_eq_u32 s22, 0
s_cbranch_scc1 M_pout_22
s_sub_u32 s22, s22, 1
s_waitcnt vmcnt(0)
v_cmp_gt_u32 vcc, s50, v1
s_cbranch_vccnz M_poll_21
M_pout_22:
s_cmp_eq_u32 s47, 0
s_cbranch_scc1 M_nohp
M_poll_23:
buffer_load_dwordx4 v[232:235], v23, s[4:7], 0 offen offset:0 sc1
s_cmp_eq_u32 s22, 0
s_cbranch_scc1 M_pout_24
s_sub_u32 s22, s22, 1
s_waitcnt vmcnt(0)
v_max3_u32 v1, v232, v233, v234
v_max_u32 v1, v1, v235
v_cmp_eq_u32 vcc, -1, v1
s_cbranch_vccnz M_poll_23
M_pout_24:
s_waitcnt vmcnt(0)
M_nohp:
buffer_load_dwordx4 v[192:195], v17, s[4:7], s24 offen offset:0 sc1
buffer_load_dwordx4 v[196:199], v17, s[4:7], s24 offen offset:1024 sc1
buffer_load_dwordx4 v[200:203], v17, s[4:7], s24 offen offset:2048 sc1
buffer_load_dwordx4 v[204:207], v17, s[4:7], s24 offen offset:3072 sc1
buffer_load_dwordx4 v[208:211], v18, s[4:7], s25 offen offset:0 sc1
buffer_load_dwordx4 v[212:215], v18, s[4:7], s25 offen offset:1024 sc1
buffer_load_dwordx4 v[216:219], v18, s[4:7], s25 offen offset:2048 sc1
buffer_load_dwordx4 v[220:223], v18, s[4:7], s25 offen offset:3072 sc1
buffer_load_dwordx4 v[224:227], v19, s[4:7], s26 offen offset:0 sc1
ds_read_b32 v253, v252
s_waitcnt lgkmcnt(0)
v_subrev_u32 v253, 0x2020202, v253
v_and_b32 v253, s82, v253
v_cmp_ne_u32 vcc, s82, v253
s_cbranch_vccnz M_lsp_25
M_lspo_26:
ds_read_b128 v[152:155], v5 offset:36864
ds_read_b128 v[156:159], v5 offset:37888
ds_read_b128 v[160:163], v5 offset:38912
ds_read_b128 v[164:167], v5 offset:39936
ds_read_b128 v[168:171], v5 offset:40960
ds_read_b128 v[172:175], v5 offset:41984
ds_read_b128 v[176:179], v5 offset:43008
ds_read_b128 v[180:183], v5 offset:44032
ds_read_b128 v[184:187], v5 offset:45056
ds_read_b128 v[188:191], v5 offset:46080
s_waitcnt vmcnt(8) lgkmcnt(5)
v_mfma_f32_16x16x32_bf16 v[100:103], v[152:155], v[192:195], v[100:103]
ds_read_b128 v[152:155], v5 offset:47104
v_mfma_f32_16x16x32_bf16 v[104:107], v[156:159], v[192:195], v[104:107]
ds_read_b128 v[156:159], v5 offset:48128
buffer_load_dwordx4 v[228:231], v19, s[4:7], s26 offen offset:1024 sc1
v_mfma_f32_16x16x32_bf16 v[108:111], v[160:163], v[192:195], v[108:111]
ds_read_b128 v[160:163], v5 offset:49152
v_mfma_f32_16x16x32_bf16 v[112:115], v[164:167], v[192:195], v[112:115]
ds_read_b128 v[164:167], v5 offset:50176
v_mfma_f32_16x16x32_bf16 v[116:119], v[168:171], v[192:195], v[116:119]
ds_read_b128 v[168:171], v5 offset:51200
s_waitcnt vmcnt(8) lgkmcnt(5)
v_mfma_f32_16x16x32_bf16 v[100:103], v[172:175], v[196:199], v[100:103]
ds_read_b128 v[172:175], v5 offset:52224
v_mfma_f32_16x16x32_bf16 v[104:107], v[176:179], v[196:199], v[104:107]
ds_read_b128 v[176:179], v5 offset:53248
buffer_load_dwordx4 v[192:195], v19, s[4:7], s26 offen offset:2048 sc1
v_mfma_f32_16x16x32_bf16 v[108:111], v[180:183], v[196:199], v[108:111]
ds_read_b128 v[180:183], v5 offset:54272
v_mfma_f32_16x16x32_bf16 v[112:115], v[184:187], v[196:199], v[112:115]
ds_read_b128 v[184:187], v5 offset:55296
v_mfma_f32_16x16x32_bf16 v[116:119], v[188:191], v[196:199], v[116:119]
ds_read_b128 v[188:191], v5 offset:56320
s_waitcnt vmcnt(8) lgkmcnt(5)
v_mfma_f32_16x16x32_bf16 v[100:103], v[152:155], v[200:203], v[100:103]
ds_read_b128 v[152:155], v5 offset:57344
v_mfma_f32_16x16x32_bf16 v[104:107], v[156:159], v[200:203], v[104:107]
ds_read_b128 v[156:159], v5 offset:58368
buffer_load_dwordx4 v[196:199], v19, s[4:7], s26 offen offset:3072 sc1
v_mfma_f32_16x16x32_bf16 v[108:111], v[160:163], v[200:203], v[108:111]
ds_read_b128 v[160:163], v5 offset:59392
v_mfma_f32_16x16x32_bf16 v[112:115], v[164:167], v[200:203], v[112:115]
ds_read_b128 v[164:167], v5 offset:60416
v_mfma_f32_16x16x32_bf16 v[116:119], v[168:171], v[200:203], v[116:119]
ds_read_b128 v[168:171], v5 offset:61440
s_waitcnt vmcnt(8) lgkmcnt(5)
v_mfma_f32_16x16x32_bf16 v[100:103], v[172:175], v[204:207], v[100:103]
ds_read_b128 v[172:175], v5 offset:62464
v_mfma_f32_16x16x32_bf16 v[104:107], v[176:179], v[204:207], v[104:107]
ds_read_b128 v[176:179], v5 offset:63488
buffer_load_dwordx4 v[200:203], v20, s[4:7], s27 offen offset:0 sc1
v_mfma_f32_16x16x32_bf16 v[108:111], v[180:183], v[204:207], v[108:111]
ds_read_b128 v[180:183], v5 offset:64512
v_mfma_f32_16x16x32_bf16 v[112:115], v[184:187], v[204:207], v[112:115]
ds_read_b128 v[184:187], v6 offset:0
v_mfma_f32_16x16x32_bf16 v[116:119], v[188:191], v[204:207], v[116:119]
ds_read_b128 v[188:191], v6 offset:1024
s_waitcnt vmcnt(8) lgkmcnt(5)
v_mfma_f32_16x16x32_bf16 v[100:103], v[152:155], v[208:211], v[100:103]
ds_read_b128 v[152:155], v6 offset:2048
v_mfma_f32_16x16x32_bf16 v[104:107], v[156:159], v[208:211], v[104:107]
ds_read_b128 v[156:159], v6 offset:3072
buffer_load_dwordx4 v[204:207], v20, s[4:7], s27 offen offset:1024 sc1
v_mfma_f32_16x16x32_bf16 v[108:111], v[160:163], v[208:211], v[108:111]
ds_read_b128 v[160:163], v6 offset:4096
v_mfma_f32_16x16x32_bf16 v[112:115], v[164:167], v[208:211], v[112:115]
ds_read_b128 v[164:167], v6 offset:5120
v_mfma_f32_16x16x32_bf16 v[116:119], v[168:171], v[208:211], v[116:119]
ds_read_b128 v[168:171], v6 offset:6144
s_waitcnt vmcnt(8) lgkmcnt(5)
v_mfma_f32_16x16x32_bf16 v[100:103], v[172:175], v[212:215], v[100:103]
ds_read_b128 v[172:175], v6 offset:7168
v_mfma_f32_16x16x32_bf16 v[104:107], v[176:179], v[212:215], v[104:107]
ds_read_b128 v[176:179], v6 offset:8192
buffer_load_dwordx4 v[208:211], v20, s[4:7], s27 offen offset:2048 sc1
v_mfma_f32_16x16x32_bf16 v[108:111], v[180:183], v[212:215], v[108:111]
ds_read_b128 v[180:183], v6 offset:9216
v_mfma_f32_16x16x32_bf16 v[112:115], v[184:187], v[212:215], v[112:115]
ds_read_b128 v[184:187], v6 offset:10240
v_mfma_f32_16x16x32_bf16 v[116:119], v[188:191], v[212:215], v[116:119]
ds_read_b128 v[188:191], v6 offset:11264
s_waitcnt vmcnt(8) lgkmcnt(5)
v_mfma_f32_16x16x32_bf16 v[100:103], v[152:155], v[216:219], v[100:103]
ds_read_b128 v[152:155], v6 offset:12288
v_mfma_f32_16x16x32_bf16 v[104:107], v[156:159], v[216:219], v[104:107]
ds_read_b128 v[156:159], v6 offset:13312
buffer_load_dwordx4 v[212:215], v20, s[4:7], s27 offen offset:3072 sc1
v_mfma_f32_16x16x32_bf16 v[108:111], v[160:163], v[216:219], v[108:111]
ds_read_b128 v[160:163], v6 offset:14336
v_mfma_f32_16x16x32_bf16 v[112:115], v[164:167], v[216:219], v[112:115]
ds_read_b128 v[164:167], v6 offset:15360
v_mfma_f32_16x16x32_bf16 v[116:119], v[168:171], v[216:219], v[116:119]
ds_read_b128 v[168:171], v6 offset:16384
s_waitcnt vmcnt(8) lgkmcnt(5)
v_mfma_f32_16x16x32_bf16 v[100:103], v[172:175], v[220:223], v[100:103]
ds_read_b128 v[172:175], v6 offset:17408
v_mfma_f32_16x16x32_bf16 v[104:107], v[176:179], v[220:223], v[104:107]
ds_read_b128 v[176:179], v6 offset:18432
buffer_load_dwordx4 v[216:219], v17, s[4:7], s28 offen offset:0 sc1
v_mfma_f32_16x16x32_bf16 v[108:111], v[180:183], v[220:223], v[108:111]
ds_read_b128 v[180:183], v6 offset:19456
v_mfma_f32_16x16x32_bf16 v[112:115], v[184:187], v[220:223], v[112:115]
ds_read_b128 v[184:187], v6 offset:20480
v_mfma_f32_16x16x32_bf16 v[116:119], v[188:191], v[220:223], v[116:119]
ds_read_b128 v[188:191], v6 offset:21504
s_waitcnt vmcnt(8) lgkmcnt(5)
v_mfma_f32_16x16x32_bf16 v[100:103], v[152:155], v[224:227], v[100:103]
ds_read_b32 v253, v252
ds_read_b128 v[152:155], v6 offset:22528
v_mfma_f32_16x16x32_bf16 v[104:107], v[156:159], v[224:227], v[104:107]
ds_read_b128 v[156:159], v6 offset:23552
buffer_load_dwordx4 v[220:223], v18, s[4:7], s28 offen offset:1024 sc1
v_mfma_f32_16x16x32_bf16 v[108:111], v[160:163], v[224:227], v[108:111]
ds_read_b128 v[160:163], v6 offset:24576
v_mfma_f32_16x16x32_bf16 v[112:115], v[164:167], v[224:227], v[112:115]
ds_read_b128 v[164:167], v6 offset:25600
v_mfma_f32_16x16x32_bf16 v[116:119], v[168:171], v[224:227], v[116:119]
ds_read_b128 v[168:171], v6 offset:26624
s_waitcnt vmcnt(8) lgkmcnt(5)
v_subrev_u32 v253, 0x3030303, v253
v_and_b32 v253, s82, v253
v_cmp_ne_u32 vcc, s82, v253
s_cbranch_vccnz M_lsp_27
M_lspo_28:
v_mfma_f32_16x16x32_bf16 v[100:103], v[172:175], v[228:231], v[100:103]
ds_read_b128 v[172:175], v6 offset:27648
v_mfma_f32_16x16x32_bf16 v[104:107], v[176:179], v[228:231], v[104:107]
ds_read_b128 v[176:179], v4 offset:0
buffer_load_dwordx4 v[224:227], v19, s[4:7], s28 offen offset:2048 sc1
v_mfma_f32_16x16x32_bf16 v[108:111], v[180:183], v[228:231], v[108:111]
ds_read_b128 v[180:183], v4 offset:1024
v_mfma_f32_16x16x32_bf16 v[112:115], v[184:187], v[228:231], v[112:115]
ds_read_b128 v[184:187], v4 offset:2048
v_mfma_f32_16x16x32_bf16 v[116:119], v[188:191], v[228:231], v[116:119]
ds_read_b128 v[188:191], v4 offset:3072
s_waitcnt vmcnt(8) lgkmcnt(5)
v_mfma_f32_16x16x32_bf16 v[100:103], v[152:155], v[192:195], v[100:103]
ds_read_b128 v[152:155], v4 offset:4096
v_mfma_f32_16x16x32_bf16 v[104:107], v[156:159], v[192:195], v[104:107]
ds_read_b128 v[156:159], v4 offset:5120
buffer_load_dwordx4 v[228:231], v20, s[4:7], s28 offen offset:3072 sc1
v_mfma_f32_16x16x32_bf16 v[108:111], v[160:163], v[192:195], v[108:111]
ds_read_b128 v[160:163], v4 offset:6144
v_mfma_f32_16x16x32_bf16 v[112:115], v[164:167], v[192:195], v[112:115]
ds_read_b128 v[164:167], v4 offset:7168
v_mfma_f32_16x16x32_bf16 v[116:119], v[168:171], v[192:195], v[116:119]
ds_read_b128 v[168:171], v4 offset:8192
s_waitcnt vmcnt(8) lgkmcnt(5)
v_mfma_f32_16x16x32_bf16 v[100:103], v[172:175], v[196:199], v[100:103]
ds_read_b128 v[172:175], v4 offset:9216
v_mfma_f32_16x16x32_bf16 v[104:107], v[176:179], v[196:199], v[104:107]
ds_read_b128 v[176:179], v4 offset:10240
v_mfma_f32_16x16x32_bf16 v[108:111], v[180:183], v[196:199], v[108:111]
ds_read_b128 v[180:183], v4 offset:11264
v_mfma_f32_16x16x32_bf16 v[112:115], v[184:187], v[196:199], v[112:115]
ds_read_b128 v[184:187], v4 offset:12288
v_mfma_f32_16x16x32_bf16 v[116:119], v[188:191], v[196:199], v[116:119]
ds_read_b128 v[188:191], v4 offset:13312
s_waitcnt vmcnt(7) lgkmcnt(5)
v_mfma_f32_16x16x32_bf16 v[100:103], v[152:155], v[200:203], v[100:103]
ds_read_b128 v[152:155], v4 offset:14336
v_mfma_f32_16x16x32_bf16 v[104:107], v[156:159], v[200:203], v[104:107]
ds_read_b128 v[156:159], v4 offset:15360
v_mfma_f32_16x16x32_bf16 v[108:111], v[160:163], v[200:203], v[108:111]
ds_read_b128 v[160:163], v4 offset:16384
v_mfma_f32_16x16x32_bf16 v[112:115], v[164:167], v[200:203], v[112:115]
ds_read_b128 v[164:167], v4 offset:17408
v_mfma_f32_16x16x32_bf16 v[116:119], v[168:171], v[200:203], v[116:119]
ds_read_b128 v[168:171], v4 offset:18432
s_waitcnt vmcnt(6) lgkmcnt(5)
v_mfma_f32_16x16x32_bf16 v[100:103], v[172:175], v[204:207], v[100:103]
ds_read_b128 v[172:175], v4 offset:19456
v_mfma_f32_16x16x32_bf16 v[104:107], v[176:179], v[204:207], v[104:107]
ds_read_b128 v[176:179], v4 offset:20480
v_mfma_f32_16x16x32_bf16 v[108:111], v[180:183], v[204:207], v[108:111]
ds_read_b128 v[180:183], v4 offset:21504
v_mfma_f32_16x16x32_bf16 v[112:115], v[184:187], v[204:207], v[112:115]
ds_read_b128 v[184:187], v4 offset:22528
v_mfma_f32_16x16x32_bf16 v[116:119], v[188:191], v[204:207], v[116:119]
ds_read_b128 v[188:191], v4 offset:23552
s_waitcnt vmcnt(5) lgkmcnt(5)
v_mfma_f32_16x16x32_bf16 v[100:103], v[152:155], v[208:211], v[100:103]
ds_read_b128 v[152:155], v4 offset:24576
v_mfma_f32_16x16x32_bf16 v[104:107], v[156:159], v[208:211], v[104:107]
ds_read_b128 v[156:159], v4 offset:25600
v_mfma_f32_16x16x32_bf16 v[108:111], v[160:163], v[208:211], v[108:111]
ds_read_b128 v[160:163], v4 offset:26624
v_mfma_f32_16x16x32_bf16 v[112:115], v[164:167], v[208:211], v[112:115]
ds_read_b128 v[164:167], v4 offset:27648
v_mfma_f32_16x16x32_bf16 v[116:119], v[168:171], v[208:211], v[116:119]
ds_read_b128 v[168:171], v4 offset:28672
s_waitcnt vmcnt(4) lgkmcnt(5)
v_mfma_f32_16x16x32_bf16 v[100:103], v[172:175], v[212:215], v[100:103]
ds_read_b128 v[172:175], v4 offset:29696
v_mfma_f32_16x16x32_bf16 v[104:107], v[176:179], v[212:215], v[104:107]
ds_read_b128 v[176:179], v4 offset:30720
v_mfma_f32_16x16x32_bf16 v[108:111], v[180:183], v[212:215], v[108:111]
ds_read_b128 v[180:183], v4 offset:31744
v_mfma_f32_16x16x32_bf16 v[112:115], v[184:187], v[212:215], v[112:115]
ds_read_b128 v[184:187], v4 offset:32768
v_mfma_f32_16x16x32_bf16 v[116:119], v[188:191], v[212:215], v[116:119]
ds_read_b128 v[188:191], v4 offset:33792
s_waitcnt vmcnt(3) lgkmcnt(5)
v_mfma_f32_16x16x32_bf16 v[100:103], v[152:155], v[216:219], v[100:103]
ds_read_b128 v[152:155], v4 offset:34816
v_mfma_f32_16x16x32_bf16 v[104:107], v[156:159], v[216:219], v[104:107]
ds_read_b128 v[156:159], v4 offset:35840
v_mfma_f32_16x16x32_bf16 v[108:111], v[160:163], v[216:219], v[108:111]
ds_read_b128 v[160:163], v4 offset:36864
v_mfma_f32_16x16x32_bf16 v[112:115], v[164:167], v[216:219], v[112:115]
ds_read_b128 v[164:167], v4 offset:37888
v_mfma_f32_16x16x32_bf16 v[116:119], v[168:171], v[216:219], v[116:119]
ds_read_b128 v[168:171], v4 offset:38912
s_waitcnt vmcnt(2) lgkmcnt(5)
v_mfma_f32_16x16x32_bf16 v[100:103], v[172:175], v[220:223], v[100:103]
ds_read_b128 v[172:175], v4 offset:39936
v_mfma_f32_16x16x32_bf16 v[104:107], v[176:179], v[220:223], v[104:107]
ds_read_b128 v[176:179], v4 offset:40960
v_mfma_f32_16x16x32_bf16 v[108:111], v[180:183], v[220:223], v[108:111]
ds_read_b128 v[180:183], v4 offset:41984
v_mfma_f32_16x16x32_bf16 v[112:115], v[184:187], v[220:223], v[112:115]
ds_read_b128 v[184:187], v4 offset:43008
v_mfma_f32_16x16x32_bf16 v[116:119], v[188:191], v[220:223], v[116:119]
ds_read_b128 v[188:191], v4 offset:44032
s_waitcnt vmcnt(1) lgkmcnt(5)
v_mfma_f32_16x16x32_bf16 v[100:103], v[152:155], v[224:227], v[100:103]
v_mfma_f32_16x16x32_bf16 v[104:107], v[156:159], v[224:227], v[104:107]
v_mfma_f32_16x16x32_bf16 v[108:111], v[160:163], v[224:227], v[108:111]
v_mfma_f32_16x16x32_bf16 v[112:115], v[164:167], v[224:227], v[112:115]
v_mfma_f32_16x16x32_bf16 v[116:119], v[168:171], v[224:227], v[116:119]
s_waitcnt vmcnt(0) lgkmcnt(0)
v_mfma_f32_16x16x32_bf16 v[100:103], v[172:175], v[228:231], v[100:103]
v_mfma_f32_16x16x32_bf16 v[104:107], v[176:179], v[228:231], v[104:107]
v_mfma_f32_16x16x32_bf16 v[108:111], v[180:183], v[228:231], v[108:111]
ds_add_u32 v250, v251
v_mfma_f32_16x16x32_bf16 v[112:115], v[184:187], v[228:231], v[112:115]
v_mfma_f32_16x16x32_bf16 v[116:119], v[188:191], v[228:231], v[116:119]
s_nop 3
v_cvt_pk_bf16_f32 v128, v100, v101
v_cvt_pk_bf16_f32 v129, v102, v103
v_cvt_pk_bf16_f32 v130, v104, v105
v_cvt_pk_bf16_f32 v131, v106, v107
v_cvt_pk_bf16_f32 v132, v108, v109
v_cvt_pk_bf16_f32 v133, v110, v111
v_cvt_pk_bf16_f32 v134, v112, v113
v_cvt_pk_bf16_f32 v135, v114, v115
v_cvt_pk_bf16_f32 v136, v116, v117
v_cvt_pk_bf16_f32 v137, v118, v119
v_mov_b32 v140, v136
v_mov_b32 v141, v137
v_mov_b32 v142, v136
v_mov_b32 v143, v137
s_nop 0
v_permlane16_swap_b32 v140, v142
v_permlane16_swap_b32 v141, v143
s_cmp_lg_u32 s19, 0
s_cbranch_scc1 M_slow_29
buffer_store_dwordx4 v[128:131], v8, s[4:7], s61 offen
buffer_store_dwordx4 v[132:135], v8, s[4:7], s61 offen offset:1024
s_mov_b64 exec, s[44:45]
buffer_store_dwordx4 v[140:143], v9, s[4:7], s61 offen
s_mov_b64 exec, -1
M_back_30:
v_mov_b32 v240, 0
v_mov_b32 v241, 0
v_mov_b32 v242, 0x3f803f80
v_dot2c_f32_bf16 v240, v128, v242
v_dot2c_f32_bf16 v241, v128, v128
v_dot2c_f32_bf16 v240, v129, v242
v_dot2c_f32_bf16 v241, v129, v129
v_dot2c_f32_bf16 v240, v130, v242
v_dot2c_f32_bf16 v241, v130, v130
v_dot2c_f32_bf16 v240, v131, v242
v_dot2c_f32_bf16 v241, v131, v131
v_dot2c_f32_bf16 v240, v132, v242
v_dot2c_f32_bf16 v241, v132, v132
v_dot2c_f32_bf16 v240, v133, v242
v_dot2c_f32_bf16 v241, v133, v133
v_dot2c_f32_bf16 v240, v134, v242
v_dot2c_f32_bf16 v241, v134, v134
v_dot2c_f32_bf16 v240, v135, v242
v_dot2c_f32_bf16 v241, v135, v135
v_dot2c_f32_bf16 v240, v136, v242
v_dot2c_f32_bf16 v241, v136, v136
v_dot2c_f32_bf16 v240, v137, v242
v_dot2c_f32_bf16 v241, v137, v137
s_nop 2
v_permlane16_swap_b32 v240, v241
v_add_f32 v240, v240, v241
v_mov_b32 v241, v240
s_nop 1
v_permlane32_swap_b32 v240, v241
v_add_f32 v243, v240, v241
s_add_u32 s48, s62, 262144
s_mov_b32 exec_hi, 0
s_cmp_lg_u32 s19, 0
s_cbranch_scc1 M_slow_31
buffer_store_dword v243, v10, s[4:7], s48 offen
M_back_32:
s_mov_b64 exec, -1
s_add_u32 s50, s21, 3
v_mov_b32 v1, s50
s_mov_b64 exec, 1
s_cmp_lg_u32 s19, 0
s_cbranch_scc1 M_slow_33
s_waitcnt vmcnt(1)
buffer_store_dword v1, off, s[4:7], s23
M_back_34:
s_mov_b64 exec, -1
v_lshlrev_b32 v40, 16, v128
v_and_b32 v41, 0xffff0000, v128
v_lshlrev_b32 v42, 16, v129
v_and_b32 v43, 0xffff0000, v129
v_lshlrev_b32 v44, 16, v130
v_and_b32 v45, 0xffff0000, v130
v_lshlrev_b32 v46, 16, v131
v_and_b32 v47, 0xffff0000, v131
v_lshlrev_b32 v48, 16, v132
v_and_b32 v49, 0xffff0000, v132
v_lshlrev_b32 v50, 16, v133
v_and_b32 v51, 0xffff0000, v133
v_lshlrev_b32 v52, 16, v134
v_and_b32 v53, 0xffff0000, v134
v_lshlrev_b32 v54, 16, v135
v_and_b32 v55, 0xffff0000, v135
v_lshlrev_b32 v56, 16, v136
v_and_b32 v57, 0xffff0000, v136
v_lshlrev_b32 v58, 16, v137
v_and_b32 v59, 0xffff0000, v137
v_pk_add_f32 v[40:41], v[40:41], v[80:81]
v_pk_add_f32 v[42:43], v[42:43], v[82:83]
v_pk_add_f32 v[44:45], v[44:45], v[84:85]
v_pk_add_f32 v[46:47], v[46:47], v[86:87]
v_pk_add_f32 v[48:49], v[48:49], v[88:89]
v_pk_add_f32 v[50:51], v[50:51], v[90:91]
v_pk_add_f32 v[52:53], v[52:53], v[92:93]
v_pk_add_f32 v[54:55], v[54:55], v[94:95]
v_pk_add_f32 v[56:57], v[56:57], v[96:97]
v_pk_add_f32 v[58:59], v[58:59], v[98:99]
M_poll_35:
buffer_load_dword v1, v15, s[4:7], 0 offen sc1
s_cmp_eq_u32 s22, 0
s_cbranch_scc1 M_pout_36
s_sub_u32 s22, s22, 1
s_waitcnt vmcnt(0)
v_cmp_gt_u32 vcc, s50, v1
s_cbranch_vccnz M_poll_35
M_pout_36:
buffer_load_dwordx4 v[192:195], v24, s[4:7], s24 offen offset:0 sc1
buffer_load_dwordx4 v[196:199], v24, s[4:7], s24 offen offset:512 sc1
buffer_load_dwordx4 v[200:203], v24, s[4:7], s24 offen offset:1024 sc1
buffer_load_dwordx4 v[204:207], v24, s[4:7], s24 offen offset:1536 sc1
buffer_load_dwordx4 v[208:211], v24, s[4:7], s24 offen offset:2048 sc1
buffer_load_dwordx4 v[212:215], v24, s[4:7], s24 offen offset:2560 sc1
buffer_load_dwordx4 v[216:219], v24, s[4:7], s24 offen offset:3072 sc1
buffer_load_dwordx4 v[220:223], v24, s[4:7], s24 offen offset:3584 sc1
buffer_load_dwordx4 v[224:227], v24, s[4:7], s25 offen offset:0 sc1
buffer_load_dwordx4 v[228:231], v24, s[4:7], s25 offen offset:512 sc1
buffer_load_dwordx4 v[176:179], v24, s[4:7], s25 offen offset:1024 sc1
buffer_load_dwordx4 v[180:183], v24, s[4:7], s25 offen offset:1536 sc1
buffer_load_dwordx4 v[184:187], v24, s[4:7], s25 offen offset:2048 sc1
buffer_load_dwordx4 v[188:191], v24, s[4:7], s25 offen offset:2560 sc1
buffer_load_dwordx4 v[144:147], v24, s[4:7], s25 offen offset:3072 sc1
ds_read_b32 v253, v252
s_waitcnt lgkmcnt(0)
v_subrev_u32 v253, 0x4040404, v253
v_and_b32 v253, s82, v253
v_cmp_ne_u32 vcc, s82, v253
s_cbranch_vccnz M_lsp_37
M_lspo_38:
ds_read_b128 v[152:155], v4 offset:45056
ds_read_b128 v[156:159], v4 offset:46080
ds_read_b128 v[160:163], v4 offset:47104
ds_read_b128 v[164:167], v4 offset:48128
ds_read_b128 v[168:171], v4 offset:49152
ds_read_b128 v[172:175], v4 offset:50176
s_waitcnt vmcnt(14) lgkmcnt(3)
v_mfma_f32_32x32x16_bf16 v[80:95], v[152:155], v[192:195], 0
ds_read_b128 v[152:155], v4 offset:51200
v_mfma_f32_32x32x16_bf16 v[96:111], v[156:159], v[192:195], 0
ds_read_b128 v[156:159], v4 offset:52224
buffer_load_dwordx4 v[148:151], v24, s[4:7], s25 offen offset:3584 sc1
v_mfma_f32_32x32x16_bf16 v[112:127], v[160:163], v[192:195], 0
ds_read_b128 v[160:163], v4 offset:53248
s_waitcnt vmcnt(14) lgkmcnt(3)
v_mfma_f32_32x32x16_bf16 v[80:95], v[164:167], v[196:199], v[80:95]
ds_read_b128 v[164:167], v4 offset:54272
v_mfma_f32_32x32x16_bf16 v[96:111], v[168:171], v[196:199], v[96:111]
ds_read_b128 v[168:171], v4 offset:55296
buffer_load_dwordx4 v[192:195], v24, s[4:7], s26 offen offset:0 sc1
v_mfma_f32_32x32x16_bf16 v[112:127], v[172:175], v[196:199], v[112:127]
ds_read_b128 v[172:175], v4 offset:56320
s_waitcnt vmcnt(14) lgkmcnt(3)
v_mfma_f32_32x32x16_bf16 v[80:95], v[152:155], v[200:203], v[80:95]
ds_read_b128 v[152:155], v4 offset:57344
v_mfma_f32_32x32x16_bf16 v[96:111], v[156:159], v[200:203], v[96:111]
ds_read_b128 v[156:159], v4 offset:58368
buffer_load_dwordx4 v[196:199], v24, s[4:7], s26 offen offset:512 sc1
v_mfma_f32_32x32x16_bf16 v[112:127], v[160:163], v[200:203], v[112:127]
ds_read_b128 v[160:163], v4 offset:59392
s_waitcnt vmcnt(14) lgkmcnt(3)
v_mfma_f32_32x32x16_bf16 v[80:95], v[164:167], v[204:207], v[80:95]
ds_read_b128 v[164:167], v4 offset:60416
v_mfma_f32_32x32x16_bf16 v[96:111], v[168:171], v[204:207], v[96:111]
ds_read_b128 v[168:171], v4 offset:61440
buffer_load_dwordx4 v[200:203], v24, s[4:7], s26 offen offset:1024 sc1
v_mfma_f32_32x32x16_bf16 v[112:127], v[172:175], v[204:207], v[112:127]
ds_read_b128 v[172:175], v4 offset:62464
s_waitcnt vmcnt(14) lgkmcnt(3)
v_mfma_f32_32x32x16_bf16 v[80:95], v[152:155], v[208:211], v[80:95]
ds_read_b128 v[152:155], v4 offset:63488
v_mfma_f32_32x32x16_bf16 v[96:111], v[156:159], v[208:211], v[96:111]
ds_read_b128 v[156:159], v4 offset:64512
buffer_load_dwordx4 v[204:207], v24, s[4:7], s26 offen offset:1536 sc1
v_mfma_f32_32x32x16_bf16 v[112:127], v[160:163], v[208:211], v[112:127]
ds_read_b128 v[160:163], v5 offset:0
s_waitcnt vmcnt(14) lgkmcnt(3)
v_mfma_f32_32x32x16_bf16 v[80:95], v[164:167], v[212:215], v[80:95]
ds_read_b128 v[164:167], v5 offset:1024
v_mfma_f32_32x32x16_bf16 v[96:111], v[168:171], v[212:215], v[96:111]
ds_read_b128 v[168:171], v5 offset:2048
buffer_load_dwordx4 v[208:211], v24, s[4:7], s26 offen offset:2048 sc1
v_mfma_f32_32x32x16_bf16 v[112:127], v[172:175], v[212:215], v[112:127]
ds_read_b128 v[172:175], v5 offset:3072
s_waitcnt vmcnt(14) lgkmcnt(3)
v_mfma_f32_32x32x16_bf16 v[80:95], v[152:155], v[216:219], v[80:95]
ds_read_b128 v[152:155], v5 offset:4096
v_mfma_f32_32x32x16_bf16 v[96:111], v[156:159], v[216:219], v[96:111]
ds_read_b128 v[156:159], v5 offset:5120
buffer_load_dwordx4 v[212:215], v24, s[4:7], s26 offen offset:2560 sc1
v_mfma_f32_32x32x16_bf16 v[112:127], v[160:163], v[216:219], v[112:127]
ds_read_b128 v[160:163], v5 offset:6144
ds_add_u32 v250, v251
s_waitcnt vmcnt(14) lgkmcnt(4)
v_mfma_f32_32x32x16_bf16 v[80:95], v[164:167], v[220:223], v[80:95]
ds_read_b128 v[164:167], v5 offset:7168
v_mfma_f32_32x32x16_bf16 v[96:111], v[168:171], v[220:223], v[96:111]
ds_read_b128 v[168:171], v5 offset:8192
buffer_load_dwordx4 v[216:219], v24, s[4:7], s26 offen offset:3072 sc1
v_mfma_f32_32x32x16_bf16 v[112:127], v[172:175], v[220:223], v[112:127]
ds_read_b128 v[172:175], v5 offset:9216
s_waitcnt vmcnt(14) lgkmcnt(4)
v_mfma_f32_32x32x16_bf16 v[80:95], v[152:155], v[224:227], v[80:95]
ds_read_b128 v[152:155], v5 offset:10240
v_mfma_f32_32x32x16_bf16 v[96:111], v[156:159], v[224:227], v[96:111]
ds_read_b128 v[156:159], v5 offset:11264
buffer_load_dwordx4 v[220:223], v24, s[4:7], s26 offen offset:3584 sc1
v_mfma_f32_32x32x16_bf16 v[112:127], v[160:163], v[224:227], v[112:127]
ds_read_b128 v[160:163], v5 offset:12288
s_waitcnt vmcnt(14) lgkmcnt(3)
v_mfma_f32_32x32x16_bf16 v[80:95], v[164:167], v[228:231], v[80:95]
ds_read_b128 v[164:167], v5 offset:13312
v_mfma_f32_32x32x16_bf16 v[96:111], v[168:171], v[228:231], v[96:111]
ds_read_b128 v[168:171], v5 offset:14336
buffer_load_dwordx4 v[224:227], v24, s[4:7], s27 offen offset:0 sc1
v_mfma_f32_32x32x16_bf16 v[112:127], v[172:175], v[228:231], v[112:127]
ds_read_b128 v[172:175], v5 offset:15360
s_waitcnt vmcnt(14) lgkmcnt(3)
v_mfma_f32_32x32x16_bf16 v[80:95], v[152:155], v[176:179], v[80:95]
ds_read_b128 v[152:155], v5 offset:16384
v_mfma_f32_32x32x16_bf16 v[96:111], v[156:159], v[176:179], v[96:111]
ds_read_b128 v[156:159], v5 offset:17408
buffer_load_dwordx4 v[228:231], v24, s[4:7], s27 offen offset:512 sc1
v_mfma_f32_32x32x16_bf16 v[112:127], v[160:163], v[176:179], v[112:127]
ds_read_b128 v[160:163], v5 offset:18432
s_waitcnt vmcnt(14) lgkmcnt(3)
v_mfma_f32_32x32x16_bf16 v[80:95], v[164:167], v[180:183], v[80:95]
ds_read_b128 v[164:167], v5 offset:19456
v_mfma_f32_32x32x16_bf16 v[96:111], v[168:171], v[180:183], v[96:111]
ds_read_b128 v[168:171], v5 offset:20480
buffer_load_dwordx4 v[176:179], v24, s[4:7], s27 offen offset:1024 sc1
v_mfma_f32_32x32x16_bf16 v[112:127], v[172:175], v[180:183], v[112:127]
ds_read_b128 v[172:175], v5 offset:21504
s_waitcnt vmcnt(14) lgkmcnt(3)
buffer_load_dwordx4 v[232:235], v12, s[4:7], s48 offen offset:0 sc1
buffer_load_dwordx4 v[236:239], v12, s[4:7], s48 offen offset:16 sc1
v_mfma_f32_32x32x16_bf16 v[80:95], v[152:155], v[184:187], v[80:95]
ds_read_b128 v[152:155], v5 offset:22528
v_mfma_f32_32x32x16_bf16 v[96:111], v[156:159], v[184:187], v[96:111]
ds_read_b128 v[156:159], v5 offset:23552
buffer_load_dwordx4 v[180:183], v24, s[4:7], s27 offen offset:1536 sc1
v_mfma_f32_32x32x16_bf16 v[112:127], v[160:163], v[184:187], v[112:127]
ds_read_b128 v[160:163], v5 offset:24576
s_waitcnt vmcnt(16) lgkmcnt(3)
v_mfma_f32_32x32x16_bf16 v[80:95], v[164:167], v[188:191], v[80:95]
ds_read_b128 v[164:167], v5 offset:25600
v_mfma_f32_32x32x16_bf16 v[96:111], v[168:171], v[188:191], v[96:111]
ds_read_b128 v[168:171], v5 offset:26624
buffer_load_dwordx4 v[184:187], v24, s[4:7], s27 offen offset:2048 sc1
v_mfma_f32_32x32x16_bf16 v[112:127], v[172:175], v[188:191], v[112:127]
ds_read_b128 v[172:175], v5 offset:27648
ds_add_u32 v250, v251
s_waitcnt vmcnt(16) lgkmcnt(4)
v_mfma_f32_32x32x16_bf16 v[80:95], v[152:155], v[144:147], v[80:95]
ds_read_b128 v[152:155], v5 offset:28672
v_mfma_f32_32x32x16_bf16 v[96:111], v[156:159], v[144:147], v[96:111]
ds_read_b128 v[156:159], v5 offset:29696
buffer_load_dwordx4 v[188:191], v24, s[4:7], s27 offen offset:2560 sc1
v_mfma_f32_32x32x16_bf16 v[112:127], v[160:163], v[144:147], v[112:127]
ds_read_b128 v[160:163], v5 offset:30720
s_waitcnt vmcnt(3) lgkmcnt(4)
v_max3_u32 v1, v232, v233, v234
v_max3_u32 v1, v1, v235, v236
v_max3_u32 v1, v1, v237, v238
v_max_u32 v1, v1, v239
v_cmp_eq_u32 vcc, -1, v1
s_cbranch_vccnz M_sp_39
M_spo_40:
v_mfma_f32_32x32x16_bf16 v[80:95], v[164:167], v[148:151], v[80:95]
ds_read_b32 v253, v252
ds_read_b128 v[164:167], v5 offset:31744
v_add_f32 v1, v232, v234
v_add_f32 v3, v233, v235
v_add_f32 v232, v236, v238
v_add_f32 v233, v237, v239
v_add_f32 v1, v1, v232
v_add_f32 v3, v3, v233
v_mov_b32 v232, v1
v_mov_b32 v233, v3
s_nop 0
v_permlane32_swap_b32 v1, v232
v_permlane32_swap_b32 v3, v233
v_add_f32 v1, v1, v232
v_add_f32 v3, v3, v233
v_mul_f32 v32, 0x3acccccd, v1
v_mul_f32 v3, 0x3acccccd, v3
v_mfma_f32_32x32x16_bf16 v[96:111], v[168:171], v[148:151], v[96:111]
ds_read_b128 v[168:171], v5 offset:32768
buffer_load_dwordx4 v[144:147], v24, s[4:7], s27 offen offset:3072 sc1
v_fma_f32 v3, -v32, v32, v3
v_max_f32 v3, 0, v3
v_add_f32 v1, 0x3727c5ac, v3
v_rsq_f32 v34, v1
s_nop 0
v_mul_f32 v36, 0xc0135761, v34
v_mul_f32 v1, v34, v34
v_mul_f32 v1, v1, v34
v_mul_f32 v38, 0xbdd2d3e8, v1
v_rcp_f32 v30, v34
v_sub_f32 v2, 0, v32
ds_read_b128 v[232:235], v28 offset:0
v_mfma_f32_32x32x16_bf16 v[112:127], v[172:175], v[148:151], v[112:127]
ds_read_b128 v[172:175], v5 offset:33792
ds_read_b128 v[236:239], v28 offset:32
s_waitcnt lgkmcnt(5)
v_subrev_u32 v253, 0x5050505, v253
v_and_b32 v253, s82, v253
v_cmp_ne_u32 vcc, s82, v253
s_cbranch_vccnz M_lsp_41
M_lspo_42:
v_mfma_f32_32x32x16_bf16 v[80:95], v[152:155], v[192:195], v[80:95]
ds_read_b128 v[152:155], v5 offset:34816
v_mfma_f32_32x32x16_bf16 v[96:111], v[156:159], v[192:195], v[96:111]
ds_read_b128 v[156:159], v5 offset:35840
buffer_load_dwordx4 v[148:151], v24, s[4:7], s27 offen offset:3584 sc1
v_mfma_f32_32x32x16_bf16 v[112:127], v[160:163], v[192:195], v[112:127]
ds_read_b128 v[160:163], v5 offset:36864
s_waitcnt lgkmcnt(4)
v_mfma_f32_32x32x16_bf16 v[80:95], v[164:167], v[196:199], v[80:95]
ds_read_b128 v[164:167], v5 offset:37888
v_mfma_f32_32x32x16_bf16 v[96:111], v[168:171], v[196:199], v[96:111]
ds_read_b128 v[168:171], v5 offset:38912
buffer_load_dwordx4 v[192:195], v24, s[4:7], s28 offen offset:0 sc1
v_mfma_f32_32x32x16_bf16 v[112:127], v[172:175], v[196:199], v[112:127]
ds_read_b128 v[172:175], v5 offset:39936
s_waitcnt lgkmcnt(3)
v_mfma_f32_32x32x16_bf16 v[80:95], v[152:155], v[200:203], v[80:95]
ds_read_b128 v[152:155], v5 offset:40960
v_mfma_f32_32x32x16_bf16 v[96:111], v[156:159], v[200:203], v[96:111]
ds_read_b128 v[156:159], v5 offset:41984
buffer_load_dwordx4 v[196:199], v24, s[4:7], s28 offen offset:512 sc1
v_mfma_f32_32x32x16_bf16 v[112:127], v[160:163], v[200:203], v[112:127]
ds_read_b128 v[160:163], v5 offset:43008
s_waitcnt lgkmcnt(3)
v_mfma_f32_32x32x16_bf16 v[80:95], v[164:167], v[204:207], v[80:95]
ds_read_b128 v[164:167], v5 offset:44032
v_mfma_f32_32x32x16_bf16 v[96:111], v[168:171], v[204:207], v[96:111]
ds_read_b128 v[168:171], v5 offset:45056
buffer_load_dwordx4 v[200:203], v24, s[4:7], s28 offen offset:1024 sc1
v_mfma_f32_32x32x16_bf16 v[112:127], v[172:175], v[204:207], v[112:127]
ds_read_b128 v[172:175], v5 offset:46080
ds_add_u32 v250, v251
s_waitcnt lgkmcnt(4)
v_mfma_f32_32x32x16_bf16 v[80:95], v[152:155], v[208:211], v[80:95]
ds_read_b128 v[152:155], v5 offset:47104
v_mfma_f32_32x32x16_bf16 v[96:111], v[156:159], v[208:211], v[96:111]
ds_read_b128 v[156:159], v5 offset:48128
buffer_load_dwordx4 v[204:207], v24, s[4:7], s28 offen offset:1536 sc1
v_mfma_f32_32x32x16_bf16 v[112:127], v[160:163], v[208:211], v[112:127]
ds_read_b128 v[160:163], v5 offset:49152
s_waitcnt lgkmcnt(4)
v_mfma_f32_32x32x16_bf16 v[80:95], v[164:167], v[212:215], v[80:95]
ds_read_b128 v[164:167], v5 offset:50176
v_mfma_f32_32x32x16_bf16 v[96:111], v[168:171], v[212:215], v[96:111]
ds_read_b128 v[168:171], v5 offset:51200
buffer_load_dwordx4 v[208:211], v24, s[4:7], s28 offen offset:2048 sc1
v_mfma_f32_32x32x16_bf16 v[112:127], v[172:175], v[212:215], v[112:127]
ds_read_b128 v[172:175], v5 offset:52224
s_waitcnt lgkmcnt(3)
v_mfma_f32_32x32x16_bf16 v[80:95], v[152:155], v[216:219], v[80:95]
ds_read_b128 v[152:155], v5 offset:53248
v_mfma_f32_32x32x16_bf16 v[96:111], v[156:159], v[216:219], v[96:111]
ds_read_b128 v[156:159], v5 offset:54272
buffer_load_dwordx4 v[212:215], v24, s[4:7], s28 offen offset:2560 sc1
v_mfma_f32_32x32x16_bf16 v[112:127], v[160:163], v[216:219], v[112:127]
ds_read_b128 v[160:163], v5 offset:55296
s_waitcnt lgkmcnt(3)
v_mfma_f32_32x32x16_bf16 v[80:95], v[164:167], v[220:223], v[80:95]
ds_read_b128 v[164:167], v5 offset:56320
v_mfma_f32_32x32x16_bf16 v[96:111], v[168:171], v[220:223], v[96:111]
ds_read_b128 v[168:171], v5 offset:57344
buffer_load_dwordx4 v[216:219], v24, s[4:7], s28 offen offset:3072 sc1
v_mfma_f32_32x32x16_bf16 v[112:127], v[172:175], v[220:223], v[112:127]
ds_read_b128 v[172:175], v5 offset:58368
s_waitcnt lgkmcnt(3)
v_mfma_f32_32x32x16_bf16 v[80:95], v[152:155], v[224:227], v[80:95]
ds_read_b128 v[152:155], v5 offset:59392
v_mfma_f32_32x32x16_bf16 v[80:95], v[156:159], v[228:231], v[80:95]
ds_read_b128 v[156:159], v5 offset:60416
buffer_load_dwordx4 v[220:223], v24, s[4:7], s28 offen offset:3584 sc1
v_mfma_f32_32x32x16_bf16 v[80:95], v[160:163], v[176:179], v[80:95]
ds_read_b128 v[160:163], v5 offset:61440
s_waitcnt vmcnt(10) lgkmcnt(3)
v_mfma_f32_32x32x16_bf16 v[80:95], v[164:167], v[180:183], v[80:95]
ds_read_b32 v253, v252
ds_read_b128 v[164:167], v5 offset:62464
v_mfma_f32_32x32x16_bf16 v[80:95], v[168:171], v[184:187], v[80:95]
ds_read_b128 v[168:171], v5 offset:63488
v_mfma_f32_32x32x16_bf16 v[80:95], v[172:175], v[188:191], v[80:95]
ds_read_b128 v[172:175], v5 offset:64512
s_waitcnt vmcnt(7) lgkmcnt(3)
v_subrev_u32 v253, 0x6060606, v253
v_and_b32 v253, s82, v253
v_cmp_ne_u32 vcc, s82, v253
s_cbranch_vccnz M_lsp_43
M_lspo_44:
v_mfma_f32_32x32x16_bf16 v[80:95], v[152:155], v[144:147], v[80:95]
ds_read_b128 v[152:155], v6 offset:0
v_mfma_f32_32x32x16_bf16 v[80:95], v[156:159], v[148:151], v[80:95]
ds_read_b128 v[156:159], v6 offset:1024
v_mfma_f32_32x32x16_bf16 v[80:95], v[160:163], v[192:195], v[80:95]
ds_read_b128 v[160:163], v6 offset:2048
ds_add_u32 v250, v251
s_waitcnt vmcnt(4) lgkmcnt(4)
v_mfma_f32_32x32x16_bf16 v[80:95], v[164:167], v[196:199], v[80:95]
ds_read_b128 v[164:167], v6 offset:3072
v_mfma_f32_32x32x16_bf16 v[80:95], v[168:171], v[200:203], v[80:95]
ds_read_b128 v[168:171], v6 offset:4096
v_mfma_f32_32x32x16_bf16 v[80:95], v[172:175], v[204:207], v[80:95]
ds_read_b128 v[172:175], v6 offset:5120
s_waitcnt vmcnt(1) lgkmcnt(4)
v_mfma_f32_32x32x16_bf16 v[80:95], v[152:155], v[208:211], v[80:95]
ds_read_b128 v[152:155], v6 offset:6144
v_mfma_f32_32x32x16_bf16 v[80:95], v[156:159], v[212:215], v[80:95]
ds_read_b128 v[156:159], v6 offset:7168
v_mfma_f32_32x32x16_bf16 v[80:95], v[160:163], v[216:219], v[80:95]
ds_read_b128 v[160:163], v6 offset:8192
s_waitcnt vmcnt(0) lgkmcnt(3)
v_mfma_f32_32x32x16_bf16 v[80:95], v[164:167], v[220:223], v[80:95]
ds_read_b128 v[164:167], v6 offset:9216
v_mfma_f32_32x32x16_bf16 v[96:111], v[168:171], v[224:227], v[96:111]
ds_read_b128 v[168:171], v6 offset:10240
v_mfma_f32_32x32x16_bf16 v[96:111], v[172:175], v[228:231], v[96:111]
ds_read_b128 v[172:175], v6 offset:11264
s_waitcnt lgkmcnt(3)
v_mfma_f32_32x32x16_bf16 v[96:111], v[152:155], v[176:179], v[96:111]
ds_read_b128 v[152:155], v6 offset:12288
v_mfma_f32_32x32x16_bf16 v[96:111], v[156:159], v[180:183], v[96:111]
ds_read_b128 v[156:159], v6 offset:13312
v_mfma_f32_32x32x16_bf16 v[96:111], v[160:163], v[184:187], v[96:111]
ds_read_b128 v[160:163], v6 offset:14336
v_pk_fma_f32 v[80:81], v[232:233], v[2:3], v[80:81] op_sel_hi:[1,0,1]
v_pk_fma_f32 v[82:83], v[234:235], v[2:3], v[82:83] op_sel_hi:[1,0,1]
ds_read_b128 v[232:235], v28 offset:64
v_pk_mul_f32 v[240:241], v[80:81], v[80:81]
v_pk_mul_f32 v[244:245], v[82:83], v[82:83]
v_pk_fma_f32 v[240:241], v[240:241], v[38:39], v[36:37] op_sel_hi:[1,0,0]
v_pk_fma_f32 v[244:245], v[244:245], v[38:39], v[36:37] op_sel_hi:[1,0,0]
v_pk_mul_f32 v[240:241], v[240:241], v[80:81]
s_waitcnt lgkmcnt(4)
v_mfma_f32_32x32x16_bf16 v[96:111], v[164:167], v[188:191], v[96:111]
ds_read_b128 v[164:167], v6 offset:15360
v_pk_mul_f32 v[244:245], v[244:245], v[82:83]
v_exp_f32 v240, v240
v_exp_f32 v241, v241
v_exp_f32 v244, v244
v_exp_f32 v245, v245
v_pk_fma_f32 v[240:241], v[240:241], v[30:31], v[30:31] op_sel_hi:[1,0,0]
v_pk_fma_f32 v[244:245], v[244:245], v[30:31], v[30:31] op_sel_hi:[1,0,0]
v_rcp_f32 v240, v240
v_mfma_f32_32x32x16_bf16 v[96:111], v[168:171], v[144:147], v[96:111]
ds_read_b128 v[168:171], v6 offset:16384
v_rcp_f32 v241, v241
v_rcp_f32 v244, v244
v_rcp_f32 v245, v245
v_pk_mul_f32 v[240:241], v[240:241], v[80:81]
v_pk_mul_f32 v[244:245], v[244:245], v[82:83]
v_cvt_pk_bf16_f32 v128, v240, v241
v_cvt_pk_bf16_f32 v129, v244, v245
v_pk_fma_f32 v[84:85], v[236:237], v[2:3], v[84:85] op_sel_hi:[1,0,1]
v_mfma_f32_32x32x16_bf16 v[96:111], v[172:175], v[148:151], v[96:111]
ds_read_b128 v[172:175], v6 offset:17408
v_pk_fma_f32 v[86:87], v[238:239], v[2:3], v[86:87] op_sel_hi:[1,0,1]
ds_read_b128 v[236:239], v28 offset:96
v_pk_mul_f32 v[240:241], v[84:85], v[84:85]
v_pk_mul_f32 v[244:245], v[86:87], v[86:87]
v_pk_fma_f32 v[240:241], v[240:241], v[38:39], v[36:37] op_sel_hi:[1,0,0]
v_pk_fma_f32 v[244:245], v[244:245], v[38:39], v[36:37] op_sel_hi:[1,0,0]
v_pk_mul_f32 v[240:241], v[240:241], v[84:85]
v_pk_mul_f32 v[244:245], v[244:245], v[86:87]
s_waitcnt lgkmcnt(5)
v_mfma_f32_32x32x16_bf16 v[96:111], v[152:155], v[192:195], v[96:111]
ds_read_b128 v[152:155], v6 offset:18432
v_exp_f32 v240, v240
v_exp_f32 v241, v241
v_exp_f32 v244, v244
v_exp_f32 v245, v245
v_pk_fma_f32 v[240:241], v[240:241], v[30:31], v[30:31] op_sel_hi:[1,0,0]
v_pk_fma_f32 v[244:245], v[244:245], v[30:31], v[30:31] op_sel_hi:[1,0,0]
v_rcp_f32 v240, v240
v_rcp_f32 v241, v241
v_mfma_f32_32x32x16_bf16 v[96:111], v[156:159], v[196:199], v[96:111]
ds_read_b128 v[156:159], v6 offset:19456
v_rcp_f32 v244, v244
v_rcp_f32 v245, v245
v_pk_mul_f32 v[240:241], v[240:241], v[84:85]
v_pk_mul_f32 v[244:245], v[244:245], v[86:87]
v_cvt_pk_bf16_f32 v130, v240, v241
v_cvt_pk_bf16_f32 v131, v244, v245
s_waitcnt lgkmcnt(6)
v_pk_fma_f32 v[88:89], v[232:233], v[2:3], v[88:89] op_sel_hi:[1,0,1]
v_pk_fma_f32 v[90:91], v[234:235], v[2:3], v[90:91] op_sel_hi:[1,0,1]
ds_read_b128 v[232:235], v28 offset:128
v_mfma_f32_32x32x16_bf16 v[96:111], v[160:163], v[200:203], v[96:111]
ds_read_b128 v[160:163], v6 offset:20480
v_pk_mul_f32 v[240:241], v[88:89], v[88:89]
v_pk_mul_f32 v[244:245], v[90:91], v[90:91]
v_pk_fma_f32 v[240:241], v[240:241], v[38:39], v[36:37] op_sel_hi:[1,0,0]
v_pk_fma_f32 v[244:245], v[244:245], v[38:39], v[36:37] op_sel_hi:[1,0,0]
v_pk_mul_f32 v[240:241], v[240:241], v[88:89]
v_pk_mul_f32 v[244:245], v[244:245], v[90:91]
v_exp_f32 v240, v240
v_exp_f32 v241, v241
s_waitcnt lgkmcnt(5)
v_mfma_f32_32x32x16_bf16 v[96:111], v[164:167], v[204:207], v[96:111]
ds_read_b128 v[164:167], v6 offset:21504
v_exp_f32 v244, v244
v_exp_f32 v245, v245
v_pk_fma_f32 v[240:241], v[240:241], v[30:31], v[30:31] op_sel_hi:[1,0,0]
v_pk_fma_f32 v[244:245], v[244:245], v[30:31], v[30:31] op_sel_hi:[1,0,0]
v_rcp_f32 v240, v240
v_rcp_f32 v241, v241
v_rcp_f32 v244, v244
v_rcp_f32 v245, v245
v_mfma_f32_32x32x16_bf16 v[96:111], v[168:171], v[208:211], v[96:111]
ds_read_b128 v[168:171], v6 offset:22528
v_pk_mul_f32 v[240:241], v[240:241], v[88:89]
v_pk_mul_f32 v[244:245], v[244:245], v[90:91]
v_cvt_pk_bf16_f32 v132, v240, v241
v_cvt_pk_bf16_f32 v133, v244, v245
s_waitcnt lgkmcnt(6)
v_pk_fma_f32 v[92:93], v[236:237], v[2:3], v[92:93] op_sel_hi:[1,0,1]
v_pk_fma_f32 v[94:95], v[238:239], v[2:3], v[94:95] op_sel_hi:[1,0,1]
ds_read_b128 v[236:239], v28 offset:160
v_pk_mul_f32 v[240:241], v[92:93], v[92:93]
v_pk_mul_f32 v[244:245], v[94:95], v[94:95]
v_mfma_f32_32x32x16_bf16 v[96:111], v[172:175], v[212:215], v[96:111]
ds_read_b128 v[172:175], v6 offset:23552
ds_add_u32 v250, v251
v_pk_fma_f32 v[240:241], v[240:241], v[38:39], v[36:37] op_sel_hi:[1,0,0]
v_pk_fma_f32 v[244:245], v[244:245], v[38:39], v[36:37] op_sel_hi:[1,0,0]
v_pk_mul_f32 v[240:241], v[240:241], v[92:93]
v_pk_mul_f32 v[244:245], v[244:245], v[94:95]
v_exp_f32 v240, v240
v_exp_f32 v241, v241
v_exp_f32 v244, v244
s_waitcnt lgkmcnt(5)
v_mfma_f32_32x32x16_bf16 v[96:111], v[152:155], v[216:219], v[96:111]
ds_read_b128 v[152:155], v6 offset:24576
v_exp_f32 v245, v245
v_pk_fma_f32 v[240:241], v[240:241], v[30:31], v[30:31] op_sel_hi:[1,0,0]
v_pk_fma_f32 v[244:245], v[244:245], v[30:31], v[30:31] op_sel_hi:[1,0,0]
v_rcp_f32 v240, v240
v_rcp_f32 v241, v241
v_rcp_f32 v244, v244
v_rcp_f32 v245, v245
v_pk_mul_f32 v[240:241], v[240:241], v[92:93]
v_mfma_f32_32x32x16_bf16 v[96:111], v[156:159], v[220:223], v[96:111]
ds_read_b128 v[156:159], v6 offset:25600
v_pk_mul_f32 v[244:245], v[244:245], v[94:95]
v_cvt_pk_bf16_f32 v134, v240, v241
v_cvt_pk_bf16_f32 v135, v244, v245
buffer_store_dwordx4 v[128:131], v25, s[4:7], s24 offen offset:0 sc1
buffer_store_dwordx4 v[132:135], v25, s[4:7], s24 offen offset:512 sc1
v_mfma_f32_32x32x16_bf16 v[112:127], v[160:163], v[224:227], v[112:127]
ds_read_b128 v[160:163], v6 offset:26624
s_waitcnt lgkmcnt(4)
v_mfma_f32_32x32x16_bf16 v[112:127], v[164:167], v[228:231], v[112:127]
ds_read_b128 v[164:167], v6 offset:27648
v_mfma_f32_32x32x16_bf16 v[112:127], v[168:171], v[176:179], v[112:127]
ds_read_b128 v[168:171], v4 offset:0
v_mfma_f32_32x32x16_bf16 v[112:127], v[172:175], v[180:183], v[112:127]
ds_read_b128 v[172:175], v4 offset:1024
s_waitcnt lgkmcnt(3)
v_mfma_f32_32x32x16_bf16 v[112:127], v[152:155], v[184:187], v[112:127]
ds_read_b128 v[152:155], v4 offset:2048
v_pk_fma_f32 v[96:97], v[232:233], v[2:3], v[96:97] op_sel_hi:[1,0,1]
v_pk_fma_f32 v[98:99], v[234:235], v[2:3], v[98:99] op_sel_hi:[1,0,1]
ds_read_b128 v[232:235], v28 offset:192
v_pk_mul_f32 v[240:241], v[96:97], v[96:97]
v_pk_mul_f32 v[244:245], v[98:99], v[98:99]
v_pk_fma_f32 v[240:241], v[240:241], v[38:39], v[36:37] op_sel_hi:[1,0,0]
v_pk_fma_f32 v[244:245], v[244:245], v[38:39], v[36:37] op_sel_hi:[1,0,0]
v_pk_mul_f32 v[240:241], v[240:241], v[96:97]
v_mfma_f32_32x32x16_bf16 v[112:127], v[156:159], v[188:191], v[112:127]
ds_read_b128 v[156:159], v4 offset:3072
v_pk_mul_f32 v[244:245], v[244:245], v[98:99]
v_exp_f32 v240, v240
v_exp_f32 v241, v241
v_exp_f32 v244, v244
v_exp_f32 v245, v245
v_pk_fma_f32 v[240:241], v[240:241], v[30:31], v[30:31] op_sel_hi:[1,0,0]
v_pk_fma_f32 v[244:245], v[244:245], v[30:31], v[30:31] op_sel_hi:[1,0,0]
v_rcp_f32 v240, v240
v_mfma_f32_32x32x16_bf16 v[112:127], v[160:163], v[144:147], v[112:127]
ds_read_b128 v[160:163], v4 offset:4096
v_rcp_f32 v241, v241
v_rcp_f32 v244, v244
v_rcp_f32 v245, v245
v_pk_mul_f32 v[240:241], v[240:241], v[96:97]
v_pk_mul_f32 v[244:245], v[244:245], v[98:99]
v_cvt_pk_bf16_f32 v136, v240, v241
v_cvt_pk_bf16_f32 v137, v244, v245
v_pk_fma_f32 v[100:101], v[236:237], v[2:3], v[100:101] op_sel_hi:[1,0,1]
s_waitcnt lgkmcnt(4)
v_mfma_f32_32x32x16_bf16 v[112:127], v[164:167], v[148:151], v[112:127]
ds_read_b128 v[164:167], v4 offset:5120
v_pk_fma_f32 v[102:103], v[238:239], v[2:3], v[102:103] op_sel_hi:[1,0,1]
ds_read_b128 v[236:239], v28 offset:224
v_pk_mul_f32 v[240:241], v[100:101], v[100:101]
v_pk_mul_f32 v[244:245], v[102:103], v[102:103]
v_pk_fma_f32 v[240:241], v[240:241], v[38:39], v[36:37] op_sel_hi:[1,0,0]
v_pk_fma_f32 v[244:245], v[244:245], v[38:39], v[36:37] op_sel_hi:[1,0,0]
v_pk_mul_f32 v[240:241], v[240:241], v[100:101]
v_pk_mul_f32 v[244:245], v[244:245], v[102:103]
v_mfma_f32_32x32x16_bf16 v[112:127], v[168:171], v[192:195], v[112:127]
ds_read_b128 v[168:171], v4 offset:6144
v_exp_f32 v240, v240
v_exp_f32 v241, v241
v_exp_f32 v244, v244
v_exp_f32 v245, v245
v_pk_fma_f32 v[240:241], v[240:241], v[30:31], v[30:31] op_sel_hi:[1,0,0]
v_pk_fma_f32 v[244:245], v[244:245], v[30:31], v[30:31] op_sel_hi:[1,0,0]
v_rcp_f32 v240, v240
v_rcp_f32 v241, v241
v_mfma_f32_32x32x16_bf16 v[112:127], v[172:175], v[196:199], v[112:127]
ds_read_b128 v[172:175], v4 offset:7168
v_rcp_f32 v244, v244
v_rcp_f32 v245, v245
v_pk_mul_f32 v[240:241], v[240:241], v[100:101]
v_pk_mul_f32 v[244:245], v[244:245], v[102:103]
v_cvt_pk_bf16_f32 v138, v240, v241
v_cvt_pk_bf16_f32 v139, v244, v245
s_add_u32 s50, s21, 4
v_mov_b32 v1, s50
s_mov_b64 exec, 1
s_cmp_lg_u32 s19, 0
s_cbranch_scc1 M_slow_45
s_waitcnt vmcnt(0)
buffer_store_dword v1, off, s[4:7], s23
M_back_46:
s_mov_b64 exec, -1
s_waitcnt lgkmcnt(4)
v_mfma_f32_32x32x16_bf16 v[112:127], v[152:155], v[200:203], v[112:127]
v_pk_fma_f32 v[104:105], v[232:233], v[2:3], v[104:105] op_sel_hi:[1,0,1]
v_pk_fma_f32 v[106:107], v[234:235], v[2:3], v[106:107] op_sel_hi:[1,0,1]
ds_read_b128 v[232:235], v28 offset:256
v_pk_mul_f32 v[240:241], v[104:105], v[104:105]
v_pk_mul_f32 v[244:245], v[106:107], v[106:107]
v_pk_fma_f32 v[240:241], v[240:241], v[38:39], v[36:37] op_sel_hi:[1,0,0]
v_pk_fma_f32 v[244:245], v[244:245], v[38:39], v[36:37] op_sel_hi:[1,0,0]
v_pk_mul_f32 v[240:241], v[240:241], v[104:105]
v_mfma_f32_32x32x16_bf16 v[112:127], v[156:159], v[204:207], v[112:127]
v_pk_mul_f32 v[244:245], v[244:245], v[106:107]
v_exp_f32 v240, v240
v_exp_f32 v241, v241
v_exp_f32 v244, v244
v_exp_f32 v245, v245
v_pk_fma_f32 v[240:241], v[240:241], v[30:31], v[30:31] op_sel_hi:[1,0,0]
v_pk_fma_f32 v[244:245], v[244:245], v[30:31], v[30:31] op_sel_hi:[1,0,0]
v_rcp_f32 v240, v240
v_mfma_f32_32x32x16_bf16 v[112:127], v[160:163], v[208:211], v[112:127]
v_rcp_f32 v241, v241
v_rcp_f32 v244, v244
v_rcp_f32 v245, v245
v_pk_mul_f32 v[240:241], v[240:241], v[104:105]
v_pk_mul_f32 v[244:245], v[244:245], v[106:107]
v_cvt_pk_bf16_f32 v140, v240, v241
v_cvt_pk_bf16_f32 v141, v244, v245
s_waitcnt lgkmcnt(3)
v_pk_fma_f32 v[108:109], v[236:237], v[2:3], v[108:109] op_sel_hi:[1,0,1]
s_waitcnt lgkmcnt(1)
v_mfma_f32_32x32x16_bf16 v[112:127], v[164:167], v[212:215], v[112:127]
v_pk_fma_f32 v[110:111], v[238:239], v[2:3], v[110:111] op_sel_hi:[1,0,1]
ds_read_b128 v[236:239], v28 offset:288
v_pk_mul_f32 v[240:241], v[108:109], v[108:109]
v_pk_mul_f32 v[244:245], v[110:111], v[110:111]
v_pk_fma_f32 v[240:241], v[240:241], v[38:39], v[36:37] op_sel_hi:[1,0,0]
v_pk_fma_f32 v[244:245], v[244:245], v[38:39], v[36:37] op_sel_hi:[1,0,0]
v_pk_mul_f32 v[240:241], v[240:241], v[108:109]
v_pk_mul_f32 v[244:245], v[244:245], v[110:111]
v_mfma_f32_32x32x16_bf16 v[112:127], v[168:171], v[216:219], v[112:127]
v_exp_f32 v240, v240
v_exp_f32 v241, v241
v_exp_f32 v244, v244
v_exp_f32 v245, v245
v_pk_fma_f32 v[240:241], v[240:241], v[30:31], v[30:31] op_sel_hi:[1,0,0]
v_pk_fma_f32 v[244:245], v[244:245], v[30:31], v[30:31] op_sel_hi:[1,0,0]
v_rcp_f32 v240, v240
v_rcp_f32 v241, v241
v_mfma_f32_32x32x16_bf16 v[112:127], v[172:175], v[220:223], v[112:127]
ds_add_u32 v250, v251
v_rcp_f32 v244, v244
v_rcp_f32 v245, v245
v_pk_mul_f32 v[240:241], v[240:241], v[108:109]
v_pk_mul_f32 v[244:245], v[244:245], v[110:111]
v_cvt_pk_bf16_f32 v142, v240, v241
v_cvt_pk_bf16_f32 v143, v244, v245
buffer_load_dword v3, v16, s[4:7], 0 offen sc1
buffer_store_dwordx4 v[136:139], v25, s[4:7], s28 offen offset:0 sc1
buffer_store_dwordx4 v[140:143], v25, s[4:7], s28 offen offset:512 sc1
s_waitcnt lgkmcnt(2)
v_pk_fma_f32 v[112:113], v[232:233], v[2:3], v[112:113] op_sel_hi:[1,0,1]
v_pk_fma_f32 v[114:115], v[234:235], v[2:3], v[114:115] op_sel_hi:[1,0,1]
ds_read_b128 v[232:235], v28 offset:320
v_pk_mul_f32 v[240:241], v[112:113], v[112:113]
v_pk_mul_f32 v[244:245], v[114:115], v[114:115]
v_pk_fma_f32 v[240:241], v[240:241], v[38:39], v[36:37] op_sel_hi:[1,0,0]
v_pk_fma_f32 v[244:245], v[244:245], v[38:39], v[36:37] op_sel_hi:[1,0,0]
v_pk_mul_f32 v[240:241], v[240:241], v[112:113]
v_pk_mul_f32 v[244:245], v[244:245], v[114:115]
v_exp_f32 v240, v240
v_exp_f32 v241, v241
v_exp_f32 v244, v244
v_exp_f32 v245, v245
v_pk_fma_f32 v[240:241], v[240:241], v[30:31], v[30:31] op_sel_hi:[1,0,0]
v_pk_fma_f32 v[244:245], v[244:245], v[30:31], v[30:31] op_sel_hi:[1,0,0]
v_rcp_f32 v240, v240
v_rcp_f32 v241, v241
v_rcp_f32 v244, v244
v_rcp_f32 v245, v245
v_pk_mul_f32 v[240:241], v[240:241], v[112:113]
v_pk_mul_f32 v[244:245], v[244:245], v[114:115]
v_cvt_pk_bf16_f32 v128, v240, v241
v_cvt_pk_bf16_f32 v129, v244, v245
s_waitcnt lgkmcnt(2)
v_pk_fma_f32 v[116:117], v[236:237], v[2:3], v[116:117] op_sel_hi:[1,0,1]
v_pk_fma_f32 v[118:119], v[238:239], v[2:3], v[118:119] op_sel_hi:[1,0,1]
ds_read_b128 v[236:239], v28 offset:352
v_pk_mul_f32 v[240:241], v[116:117], v[116:117]
v_pk_mul_f32 v[244:245], v[118:119], v[118:119]
v_pk_fma_f32 v[240:241], v[240:241], v[38:39], v[36:37] op_sel_hi:[1,0,0]
v_pk_fma_f32 v[244:245], v[244:245], v[38:39], v[36:37] op_sel_hi:[1,0,0]
v_pk_mul_f32 v[240:241], v[240:241], v[116:117]
v_pk_mul_f32 v[244:245], v[244:245], v[118:119]
v_exp_f32 v240, v240
v_exp_f32 v241, v241
v_exp_f32 v244, v244
v_exp_f32 v245, v245
v_pk_fma_f32 v[240:241], v[240:241], v[30:31], v[30:31] op_sel_hi:[1,0,0]
v_pk_fma_f32 v[244:245], v[244:245], v[30:31], v[30:31] op_sel_hi:[1,0,0]
v_rcp_f32 v240, v240
v_rcp_f32 v241, v241
v_rcp_f32 v244, v244
v_rcp_f32 v245, v245
v_pk_mul_f32 v[240:241], v[240:241], v[116:117]
v_pk_mul_f32 v[244:245], v[244:245], v[118:119]
v_cvt_pk_bf16_f32 v130, v240, v241
v_cvt_pk_bf16_f32 v131, v244, v245
s_waitcnt lgkmcnt(1)
v_pk_fma_f32 v[120:121], v[232:233], v[2:3], v[120:121] op_sel_hi:[1,0,1]
v_pk_fma_f32 v[122:123], v[234:235], v[2:3], v[122:123] op_sel_hi:[1,0,1]
v_pk_mul_f32 v[240:241], v[120:121], v[120:121]
v_pk_mul_f32 v[244:245], v[122:123], v[122:123]
v_pk_fma_f32 v[240:241], v[240:241], v[38:39], v[36:37] op_sel_hi:[1,0,0]
v_pk_fma_f32 v[244:245], v[244:245], v[38:39], v[36:37] op_sel_hi:[1,0,0]
v_pk_mul_f32 v[240:241], v[240:241], v[120:121]
v_pk_mul_f32 v[244:245], v[244:245], v[122:123]
v_exp_f32 v240, v240
v_exp_f32 v241, v241
v_exp_f32 v244, v244
v_exp_f32 v245, v245
v_pk_fma_f32 v[240:241], v[240:241], v[30:31], v[30:31] op_sel_hi:[1,0,0]
v_pk_fma_f32 v[244:245], v[244:245], v[30:31], v[30:31] op_sel_hi:[1,0,0]
v_rcp_f32 v240, v240
v_rcp_f32 v241, v241
v_rcp_f32 v244, v244
v_rcp_f32 v245, v245
v_pk_mul_f32 v[240:241], v[240:241], v[120:121]
v_pk_mul_f32 v[244:245], v[244:245], v[122:123]
v_cvt_pk_bf16_f32 v132, v240, v241
s_waitcnt vmcnt(2)
s_add_u32 s51, s21, 4
v_cmp_gt_u32 vcc, s51, v3
s_cbranch_vccnz M_sp_47
M_spo_48:
buffer_load_dwordx4 v[192:195], v26, s[4:7], s24 offen offset:0 sc1
buffer_load_dwordx4 v[196:199], v26, s[4:7], s24 offen offset:1024 sc1
buffer_load_dwordx4 v[200:203], v26, s[4:7], s24 offen offset:2048 sc1
buffer_load_dwordx4 v[204:207], v26, s[4:7], s24 offen offset:3072 sc1
buffer_load_dwordx4 v[208:211], v26, s[4:7], s25 offen offset:0 sc1
buffer_load_dwordx4 v[212:215], v26, s[4:7], s25 offen offset:1024 sc1
buffer_load_dwordx4 v[216:219], v26, s[4:7], s25 offen offset:2048 sc1
buffer_load_dwordx4 v[220:223], v26, s[4:7], s25 offen offset:3072 sc1
v_cvt_pk_bf16_f32 v133, v244, v245
s_waitcnt lgkmcnt(0)
v_pk_fma_f32 v[124:125], v[236:237], v[2:3], v[124:125] op_sel_hi:[1,0,1]
v_pk_fma_f32 v[126:127], v[238:239], v[2:3], v[126:127] op_sel_hi:[1,0,1]
v_pk_mul_f32 v[240:241], v[124:125], v[124:125]
v_pk_mul_f32 v[244:245], v[126:127], v[126:127]
v_pk_fma_f32 v[240:241], v[240:241], v[38:39], v[36:37] op_sel_hi:[1,0,0]
v_pk_fma_f32 v[244:245], v[244:245], v[38:39], v[36:37] op_sel_hi:[1,0,0]
v_pk_mul_f32 v[240:241], v[240:241], v[124:125]
v_pk_mul_f32 v[244:245], v[244:245], v[126:127]
v_exp_f32 v240, v240
v_exp_f32 v241, v241
v_exp_f32 v244, v244
v_exp_f32 v245, v245
v_pk_fma_f32 v[240:241], v[240:241], v[30:31], v[30:31] op_sel_hi:[1,0,0]
v_pk_fma_f32 v[244:245], v[244:245], v[30:31], v[30:31] op_sel_hi:[1,0,0]
v_rcp_f32 v240, v240
v_rcp_f32 v241, v241
v_rcp_f32 v244, v244
v_rcp_f32 v245, v245
v_pk_mul_f32 v[240:241], v[240:241], v[124:125]
v_pk_mul_f32 v[244:245], v[244:245], v[126:127]
v_cvt_pk_bf16_f32 v134, v240, v241
v_cvt_pk_bf16_f32 v135, v244, v245
buffer_store_dwordx4 v[128:131], v25, s[4:7], s32 offen offset:0 sc1
buffer_store_dwordx4 v[132:135], v25, s[4:7], s32 offen offset:512 sc1
ds_read_b32 v253, v252
s_waitcnt lgkmcnt(0)
v_subrev_u32 v253, 0x7070707, v253
v_and_b32 v253, s82, v253
v_cmp_ne_u32 vcc, s82, v253
s_cbranch_vccnz M_lsp_49
M_lspo_50:
ds_read_b128 v[152:155], v4 offset:8192
ds_read_b128 v[156:159], v4 offset:9216
ds_read_b128 v[160:163], v4 offset:10240
ds_read_b128 v[164:167], v4 offset:11264
ds_read_b128 v[168:171], v4 offset:12288
ds_read_b128 v[172:175], v4 offset:13312
ds_read_b128 v[176:179], v4 offset:14336
ds_read_b128 v[180:183], v4 offset:15360
ds_read_b128 v[184:187], v4 offset:16384
ds_read_b128 v[188:191], v4 offset:17408
s_waitcnt vmcnt(9) lgkmcnt(5)
s_add_u32 s50, s21, 5
v_mov_b32 v1, s50
s_mov_b64 exec, 1
s_cmp_lg_u32 s19, 0
s_cbranch_scc1 M_slow_51
buffer_store_dword v1, off, s[4:7], s23
M_back_52:
s_mov_b64 exec, -1
v_mfma_f32_16x16x32_bf16 v[40:43], v[152:155], v[192:195], v[40:43]
ds_read_b128 v[152:155], v4 offset:18432
v_mfma_f32_16x16x32_bf16 v[44:47], v[156:159], v[192:195], v[44:47]
ds_read_b128 v[156:159], v4 offset:19456
buffer_load_dwordx4 v[224:227], v26, s[4:7], s26 offen offset:0 sc1
v_mfma_f32_16x16x32_bf16 v[48:51], v[160:163], v[192:195], v[48:51]
ds_read_b128 v[160:163], v4 offset:20480
v_mfma_f32_16x16x32_bf16 v[52:55], v[164:167], v[192:195], v[52:55]
ds_read_b128 v[164:167], v4 offset:21504
v_mfma_f32_16x16x32_bf16 v[56:59], v[168:171], v[192:195], v[56:59]
ds_read_b128 v[168:171], v4 offset:22528
s_waitcnt vmcnt(10) lgkmcnt(5)
v_mfma_f32_16x16x32_bf16 v[40:43], v[172:175], v[196:199], v[40:43]
ds_read_b128 v[172:175], v4 offset:23552
v_mfma_f32_16x16x32_bf16 v[44:47], v[176:179], v[196:199], v[44:47]
ds_read_b128 v[176:179], v4 offset:24576
buffer_load_dwordx4 v[192:195], v26, s[4:7], s26 offen offset:1024 sc1
v_mfma_f32_16x16x32_bf16 v[48:51], v[180:183], v[196:199], v[48:51]
ds_read_b128 v[180:183], v4 offset:25600
ds_add_u32 v250, v251
v_mfma_f32_16x16x32_bf16 v[52:55], v[184:187], v[196:199], v[52:55]
ds_read_b128 v[184:187], v4 offset:26624
v_mfma_f32_16x16x32_bf16 v[56:59], v[188:191], v[196:199], v[56:59]
ds_read_b128 v[188:191], v4 offset:27648
s_waitcnt vmcnt(10) lgkmcnt(6)
v_mfma_f32_16x16x32_bf16 v[40:43], v[152:155], v[200:203], v[40:43]
ds_read_b128 v[152:155], v4 offset:28672
v_mfma_f32_16x16x32_bf16 v[44:47], v[156:159], v[200:203], v[44:47]
ds_read_b128 v[156:159], v4 offset:29696
buffer_load_dwordx4 v[196:199], v26, s[4:7], s26 offen offset:2048 sc1
v_mfma_f32_16x16x32_bf16 v[48:51], v[160:163], v[200:203], v[48:51]
ds_read_b128 v[160:163], v4 offset:30720
v_mfma_f32_16x16x32_bf16 v[52:55], v[164:167], v[200:203], v[52:55]
ds_read_b128 v[164:167], v4 offset:31744
v_mfma_f32_16x16x32_bf16 v[56:59], v[168:171], v[200:203], v[56:59]
ds_read_b128 v[168:171], v4 offset:32768
s_waitcnt vmcnt(10) lgkmcnt(5)
v_mfma_f32_16x16x32_bf16 v[40:43], v[172:175], v[204:207], v[40:43]
ds_read_b128 v[172:175], v4 offset:33792
v_mfma_f32_16x16x32_bf16 v[44:47], v[176:179], v[204:207], v[44:47]
ds_read_b128 v[176:179], v4 offset:34816
buffer_load_dwordx4 v[200:203], v26, s[4:7], s26 offen offset:3072 sc1
v_mfma_f32_16x16x32_bf16 v[48:51], v[180:183], v[204:207], v[48:51]
ds_read_b128 v[180:183], v4 offset:35840
ds_add_u32 v250, v251
v_mfma_f32_16x16x32_bf16 v[52:55], v[184:187], v[204:207], v[52:55]
ds_read_b128 v[184:187], v4 offset:36864
v_mfma_f32_16x16x32_bf16 v[56:59], v[188:191], v[204:207], v[56:59]
ds_read_b128 v[188:191], v4 offset:37888
s_waitcnt vmcnt(10) lgkmcnt(6)
v_mfma_f32_16x16x32_bf16 v[40:43], v[152:155], v[208:211], v[40:43]
ds_read_b128 v[152:155], v4 offset:38912
v_mfma_f32_16x16x32_bf16 v[44:47], v[156:159], v[208:211], v[44:47]
ds_read_b128 v[156:159], v4 offset:39936
buffer_load_dwordx4 v[204:207], v26, s[4:7], s27 offen offset:0 sc1
v_mfma_f32_16x16x32_bf16 v[48:51], v[160:163], v[208:211], v[48:51]
ds_read_b128 v[160:163], v4 offset:40960
v_mfma_f32_16x16x32_bf16 v[52:55], v[164:167], v[208:211], v[52:55]
ds_read_b128 v[164:167], v4 offset:41984
v_mfma_f32_16x16x32_bf16 v[56:59], v[168:171], v[208:211], v[56:59]
ds_read_b128 v[168:171], v4 offset:43008
s_waitcnt vmcnt(10) lgkmcnt(5)
v_mfma_f32_16x16x32_bf16 v[40:43], v[172:175], v[212:215], v[40:43]
ds_read_b128 v[172:175], v4 offset:44032
v_mfma_f32_16x16x32_bf16 v[44:47], v[176:179], v[212:215], v[44:47]
ds_read_b128 v[176:179], v4 offset:45056
buffer_load_dwordx4 v[208:211], v26, s[4:7], s27 offen offset:1024 sc1
v_mfma_f32_16x16x32_bf16 v[48:51], v[180:183], v[212:215], v[48:51]
ds_read_b128 v[180:183], v4 offset:46080
ds_add_u32 v250, v251
v_mfma_f32_16x16x32_bf16 v[52:55], v[184:187], v[212:215], v[52:55]
ds_read_b128 v[184:187], v4 offset:47104
v_mfma_f32_16x16x32_bf16 v[56:59], v[188:191], v[212:215], v[56:59]
ds_read_b128 v[188:191], v4 offset:48128
s_waitcnt vmcnt(10) lgkmcnt(6)
v_mfma_f32_16x16x32_bf16 v[40:43], v[152:155], v[216:219], v[40:43]
ds_read_b128 v[152:155], v4 offset:49152
v_mfma_f32_16x16x32_bf16 v[44:47], v[156:159], v[216:219], v[44:47]
ds_read_b128 v[156:159], v4 offset:50176
buffer_load_dwordx4 v[212:215], v26, s[4:7], s27 offen offset:2048 sc1
v_mfma_f32_16x16x32_bf16 v[48:51], v[160:163], v[216:219], v[48:51]
ds_read_b128 v[160:163], v4 offset:51200
v_mfma_f32_16x16x32_bf16 v[52:55], v[164:167], v[216:219], v[52:55]
ds_read_b128 v[164:167], v4 offset:52224
v_mfma_f32_16x16x32_bf16 v[56:59], v[168:171], v[216:219], v[56:59]
ds_read_b128 v[168:171], v4 offset:53248
s_waitcnt vmcnt(10) lgkmcnt(5)
buffer_load_dword v3, v16, s[4:7], 0 offen sc1
v_mfma_f32_16x16x32_bf16 v[40:43], v[172:175], v[220:223], v[40:43]
ds_read_b128 v[172:175], v4 offset:54272
v_mfma_f32_16x16x32_bf16 v[44:47], v[176:179], v[220:223], v[44:47]
ds_read_b128 v[176:179], v4 offset:55296
buffer_load_dwordx4 v[216:219], v26, s[4:7], s27 offen offset:3072 sc1
v_mfma_f32_16x16x32_bf16 v[48:51], v[180:183], v[220:223], v[48:51]
ds_read_b128 v[180:183], v4 offset:56320
ds_add_u32 v250, v251
v_mfma_f32_16x16x32_bf16 v[52:55], v[184:187], v[220:223], v[52:55]
ds_read_b128 v[184:187], v4 offset:57344
v_mfma_f32_16x16x32_bf16 v[56:59], v[188:191], v[220:223], v[56:59]
ds_read_b128 v[188:191], v4 offset:58368
s_waitcnt vmcnt(1) lgkmcnt(6)
s_add_u32 s51, s21, 5
v_cmp_gt_u32 vcc, s51, v3
s_cbranch_vccnz M_sp_53
M_spo_54:
v_mfma_f32_16x16x32_bf16 v[40:43], v[152:155], v[224:227], v[40:43]
ds_read_b128 v[152:155], v4 offset:59392
v_mfma_f32_16x16x32_bf16 v[44:47], v[156:159], v[224:227], v[44:47]
ds_read_b128 v[156:159], v4 offset:60416
buffer_load_dwordx4 v[220:223], v26, s[4:7], s28 offen offset:0 sc1
v_mfma_f32_16x16x32_bf16 v[48:51], v[160:163], v[224:227], v[48:51]
ds_read_b128 v[160:163], v4 offset:61440
v_mfma_f32_16x16x32_bf16 v[52:55], v[164:167], v[224:227], v[52:55]
ds_read_b128 v[164:167], v4 offset:62464
v_mfma_f32_16x16x32_bf16 v[56:59], v[168:171], v[224:227], v[56:59]
ds_read_b128 v[168:171], v4 offset:63488
s_waitcnt lgkmcnt(5)
v_mfma_f32_16x16x32_bf16 v[40:43], v[172:175], v[192:195], v[40:43]
ds_read_b128 v[172:175], v4 offset:64512
v_mfma_f32_16x16x32_bf16 v[44:47], v[176:179], v[192:195], v[44:47]
ds_read_b128 v[176:179], v5 offset:0
buffer_load_dwordx4 v[224:227], v26, s[4:7], s28 offen offset:1024 sc1
v_mfma_f32_16x16x32_bf16 v[48:51], v[180:183], v[192:195], v[48:51]
ds_read_b128 v[180:183], v5 offset:1024
ds_add_u32 v250, v251
v_mfma_f32_16x16x32_bf16 v[52:55], v[184:187], v[192:195], v[52:55]
ds_read_b128 v[184:187], v5 offset:2048
v_mfma_f32_16x16x32_bf16 v[56:59], v[188:191], v[192:195], v[56:59]
ds_read_b128 v[188:191], v5 offset:3072
s_waitcnt lgkmcnt(6)
s_add_u32 s50, s21, 6
v_mov_b32 v1, s50
s_mov_b64 exec, 1
s_cmp_lg_u32 s19, 0
s_cbranch_scc1 M_slow_55
buffer_store_dword v1, off, s[4:7], s23
M_back_56:
s_mov_b64 exec, -1
v_mfma_f32_16x16x32_bf16 v[40:43], v[152:155], v[196:199], v[40:43]
ds_read_b128 v[152:155], v5 offset:4096
v_mfma_f32_16x16x32_bf16 v[44:47], v[156:159], v[196:199], v[44:47]
ds_read_b128 v[156:159], v5 offset:5120
buffer_load_dwordx4 v[192:195], v26, s[4:7], s28 offen offset:2048 sc1
v_mfma_f32_16x16x32_bf16 v[48:51], v[160:163], v[196:199], v[48:51]
ds_read_b128 v[160:163], v5 offset:6144
v_mfma_f32_16x16x32_bf16 v[52:55], v[164:167], v[196:199], v[52:55]
ds_read_b128 v[164:167], v5 offset:7168
v_mfma_f32_16x16x32_bf16 v[56:59], v[168:171], v[196:199], v[56:59]
ds_read_b128 v[168:171], v5 offset:8192
s_waitcnt lgkmcnt(5)
v_mfma_f32_16x16x32_bf16 v[40:43], v[172:175], v[200:203], v[40:43]
ds_read_b128 v[172:175], v5 offset:9216
v_mfma_f32_16x16x32_bf16 v[44:47], v[176:179], v[200:203], v[44:47]
ds_read_b128 v[176:179], v5 offset:10240
buffer_load_dwordx4 v[196:199], v26, s[4:7], s28 offen offset:3072 sc1
v_mfma_f32_16x16x32_bf16 v[48:51], v[180:183], v[200:203], v[48:51]
ds_read_b128 v[180:183], v5 offset:11264
ds_add_u32 v250, v251
v_mfma_f32_16x16x32_bf16 v[52:55], v[184:187], v[200:203], v[52:55]
ds_read_b128 v[184:187], v5 offset:12288
v_mfma_f32_16x16x32_bf16 v[56:59], v[188:191], v[200:203], v[56:59]
ds_read_b128 v[188:191], v5 offset:13312
s_waitcnt lgkmcnt(6)
v_mfma_f32_16x16x32_bf16 v[40:43], v[152:155], v[204:207], v[40:43]
ds_read_b128 v[152:155], v5 offset:14336
v_mfma_f32_16x16x32_bf16 v[44:47], v[156:159], v[204:207], v[44:47]
ds_read_b128 v[156:159], v5 offset:15360
buffer_load_dwordx4 v[200:203], v26, s[4:7], s29 offen offset:0 sc1
v_mfma_f32_16x16x32_bf16 v[48:51], v[160:163], v[204:207], v[48:51]
ds_read_b128 v[160:163], v5 offset:16384
v_mfma_f32_16x16x32_bf16 v[52:55], v[164:167], v[204:207], v[52:55]
ds_read_b128 v[164:167], v5 offset:17408
v_mfma_f32_16x16x32_bf16 v[56:59], v[168:171], v[204:207], v[56:59]
ds_read_b128 v[168:171], v5 offset:18432
s_waitcnt lgkmcnt(5)
v_mfma_f32_16x16x32_bf16 v[40:43], v[172:175], v[208:211], v[40:43]
ds_read_b32 v253, v252
ds_read_b128 v[172:175], v5 offset:19456
v_mfma_f32_16x16x32_bf16 v[44:47], v[176:179], v[208:211], v[44:47]
ds_read_b128 v[176:179], v5 offset:20480
buffer_load_dwordx4 v[204:207], v26, s[4:7], s29 offen offset:1024 sc1
v_mfma_f32_16x16x32_bf16 v[48:51], v[180:183], v[208:211], v[48:51]
ds_read_b128 v[180:183], v5 offset:21504
ds_add_u32 v250, v251
v_mfma_f32_16x16x32_bf16 v[52:55], v[184:187], v[208:211], v[52:55]
ds_read_b128 v[184:187], v5 offset:22528
v_mfma_f32_16x16x32_bf16 v[56:59], v[188:191], v[208:211], v[56:59]
ds_read_b128 v[188:191], v5 offset:23552
s_waitcnt lgkmcnt(6)
v_subrev_u32 v253, 0x8080808, v253
v_and_b32 v253, s82, v253
v_cmp_ne_u32 vcc, s82, v253
s_cbranch_vccnz M_lsp_57
M_lspo_58:
v_mfma_f32_16x16x32_bf16 v[40:43], v[152:155], v[212:215], v[40:43]
ds_read_b128 v[152:155], v5 offset:24576
v_mfma_f32_16x16x32_bf16 v[44:47], v[156:159], v[212:215], v[44:47]
ds_read_b128 v[156:159], v5 offset:25600
buffer_load_dwordx4 v[208:211], v26, s[4:7], s29 offen offset:2048 sc1
v_mfma_f32_16x16x32_bf16 v[48:51], v[160:163], v[212:215], v[48:51]
ds_read_b128 v[160:163], v5 offset:26624
v_mfma_f32_16x16x32_bf16 v[52:55], v[164:167], v[212:215], v[52:55]
ds_read_b128 v[164:167], v5 offset:27648
v_mfma_f32_16x16x32_bf16 v[56:59], v[168:171], v[212:215], v[56:59]
ds_read_b128 v[168:171], v5 offset:28672
s_waitcnt vmcnt(8) lgkmcnt(5)
v_mfma_f32_16x16x32_bf16 v[40:43], v[172:175], v[216:219], v[40:43]
ds_read_b128 v[172:175], v5 offset:29696
v_mfma_f32_16x16x32_bf16 v[44:47], v[176:179], v[216:219], v[44:47]
ds_read_b128 v[176:179], v5 offset:30720
buffer_load_dwordx4 v[212:215], v26, s[4:7], s29 offen offset:3072 sc1
v_mfma_f32_16x16x32_bf16 v[48:51], v[180:183], v[216:219], v[48:51]
ds_read_b128 v[180:183], v5 offset:31744
ds_add_u32 v250, v251
v_mfma_f32_16x16x32_bf16 v[52:55], v[184:187], v[216:219], v[52:55]
ds_read_b128 v[184:187], v5 offset:32768
v_mfma_f32_16x16x32_bf16 v[56:59], v[188:191], v[216:219], v[56:59]
ds_read_b128 v[188:191], v5 offset:33792
s_waitcnt vmcnt(8) lgkmcnt(6)
v_mfma_f32_16x16x32_bf16 v[40:43], v[152:155], v[220:223], v[40:43]
ds_read_b128 v[152:155], v5 offset:34816
v_mfma_f32_16x16x32_bf16 v[44:47], v[156:159], v[220:223], v[44:47]
ds_read_b128 v[156:159], v5 offset:35840
buffer_load_dwordx4 v[216:219], v26, s[4:7], s30 offen offset:0 sc1
v_mfma_f32_16x16x32_bf16 v[48:51], v[160:163], v[220:223], v[48:51]
ds_read_b128 v[160:163], v5 offset:36864
v_mfma_f32_16x16x32_bf16 v[52:55], v[164:167], v[220:223], v[52:55]
ds_read_b128 v[164:167], v5 offset:37888
v_mfma_f32_16x16x32_bf16 v[56:59], v[168:171], v[220:223], v[56:59]
ds_read_b128 v[168:171], v5 offset:38912
s_waitcnt vmcnt(8) lgkmcnt(5)
v_mfma_f32_16x16x32_bf16 v[40:43], v[172:175], v[224:227], v[40:43]
ds_read_b128 v[172:175], v5 offset:39936
v_mfma_f32_16x16x32_bf16 v[44:47], v[176:179], v[224:227], v[44:47]
ds_read_b128 v[176:179], v5 offset:40960
buffer_load_dwordx4 v[220:223], v26, s[4:7], s30 offen offset:1024 sc1
v_mfma_f32_16x16x32_bf16 v[48:51], v[180:183], v[224:227], v[48:51]
ds_read_b128 v[180:183], v5 offset:41984
ds_add_u32 v250, v251
v_mfma_f32_16x16x32_bf16 v[52:55], v[184:187], v[224:227], v[52:55]
ds_read_b128 v[184:187], v5 offset:43008
v_mfma_f32_16x16x32_bf16 v[56:59], v[188:191], v[224:227], v[56:59]
ds_read_b128 v[188:191], v5 offset:44032
s_waitcnt vmcnt(7) lgkmcnt(6)
v_mfma_f32_16x16x32_bf16 v[40:43], v[152:155], v[192:195], v[40:43]
ds_read_b128 v[152:155], v5 offset:45056
v_mfma_f32_16x16x32_bf16 v[44:47], v[156:159], v[192:195], v[44:47]
ds_read_b128 v[156:159], v5 offset:46080
buffer_load_dwordx4 v[224:227], v26, s[4:7], s30 offen offset:2048 sc1
v_mfma_f32_16x16x32_bf16 v[48:51], v[160:163], v[192:195], v[48:51]
ds_read_b128 v[160:163], v5 offset:47104
v_mfma_f32_16x16x32_bf16 v[52:55], v[164:167], v[192:195], v[52:55]
ds_read_b128 v[164:167], v5 offset:48128
v_mfma_f32_16x16x32_bf16 v[56:59], v[168:171], v[192:195], v[56:59]
ds_read_b128 v[168:171], v5 offset:49152
s_waitcnt vmcnt(7) lgkmcnt(5)
v_mfma_f32_16x16x32_bf16 v[40:43], v[172:175], v[196:199], v[40:43]
ds_read_b128 v[172:175], v5 offset:50176
v_mfma_f32_16x16x32_bf16 v[44:47], v[176:179], v[196:199], v[44:47]
ds_read_b128 v[176:179], v5 offset:51200
buffer_load_dwordx4 v[192:195], v26, s[4:7], s30 offen offset:3072 sc1
v_mfma_f32_16x16x32_bf16 v[48:51], v[180:183], v[196:199], v[48:51]
ds_read_b128 v[180:183], v5 offset:52224
v_mfma_f32_16x16x32_bf16 v[52:55], v[184:187], v[196:199], v[52:55]
ds_read_b128 v[184:187], v5 offset:53248
v_mfma_f32_16x16x32_bf16 v[56:59], v[188:191], v[196:199], v[56:59]
ds_read_b128 v[188:191], v5 offset:54272
s_waitcnt vmcnt(7) lgkmcnt(5)
v_mfma_f32_16x16x32_bf16 v[40:43], v[152:155], v[200:203], v[40:43]
ds_read_b128 v[152:155], v5 offset:55296
v_mfma_f32_16x16x32_bf16 v[44:47], v[156:159], v[200:203], v[44:47]
ds_read_b128 v[156:159], v5 offset:56320
buffer_load_dwordx4 v[196:199], v26, s[4:7], s31 offen offset:0 sc1
v_mfma_f32_16x16x32_bf16 v[48:51], v[160:163], v[200:203], v[48:51]
ds_read_b128 v[160:163], v5 offset:57344
v_mfma_f32_16x16x32_bf16 v[52:55], v[164:167], v[200:203], v[52:55]
ds_read_b128 v[164:167], v5 offset:58368
v_mfma_f32_16x16x32_bf16 v[56:59], v[168:171], v[200:203], v[56:59]
ds_read_b128 v[168:171], v5 offset:59392
s_waitcnt vmcnt(7) lgkmcnt(5)
v_mfma_f32_16x16x32_bf16 v[40:43], v[172:175], v[204:207], v[40:43]
ds_read_b32 v253, v252
ds_read_b128 v[172:175], v5 offset:60416
v_mfma_f32_16x16x32_bf16 v[44:47], v[176:179], v[204:207], v[44:47]
ds_read_b128 v[176:179], v5 offset:61440
buffer_load_dwordx4 v[200:203], v26, s[4:7], s31 offen offset:1024 sc1
v_mfma_f32_16x16x32_bf16 v[48:51], v[180:183], v[204:207], v[48:51]
ds_read_b128 v[180:183], v5 offset:62464
v_mfma_f32_16x16x32_bf16 v[52:55], v[184:187], v[204:207], v[52:55]
ds_read_b128 v[184:187], v5 offset:63488
v_mfma_f32_16x16x32_bf16 v[56:59], v[188:191], v[204:207], v[56:59]
ds_read_b128 v[188:191], v5 offset:64512
s_waitcnt vmcnt(7) lgkmcnt(5)
v_subrev_u32 v253, 0x9090909, v253
v_and_b32 v253, s82, v253
v_cmp_ne_u32 vcc, s82, v253
s_cbranch_vccnz M_lsp_59
M_lspo_60:
buffer_load_dword v3, v16, s[4:7], 0 offen sc1
v_mfma_f32_16x16x32_bf16 v[40:43], v[152:155], v[208:211], v[40:43]
ds_read_b128 v[152:155], v6 offset:0
v_mfma_f32_16x16x32_bf16 v[44:47], v[156:159], v[208:211], v[44:47]
ds_read_b128 v[156:159], v6 offset:1024
buffer_load_dwordx4 v[204:207], v26, s[4:7], s31 offen offset:2048 sc1
v_mfma_f32_16x16x32_bf16 v[48:51], v[160:163], v[208:211], v[48:51]
ds_read_b128 v[160:163], v6 offset:2048
v_mfma_f32_16x16x32_bf16 v[52:55], v[164:167], v[208:211], v[52:55]
ds_read_b128 v[164:167], v6 offset:3072
v_mfma_f32_16x16x32_bf16 v[56:59], v[168:171], v[208:211], v[56:59]
ds_read_b128 v[168:171], v6 offset:4096
s_waitcnt vmcnt(8) lgkmcnt(5)
v_mfma_f32_16x16x32_bf16 v[40:43], v[172:175], v[212:215], v[40:43]
ds_read_b128 v[172:175], v6 offset:5120
v_mfma_f32_16x16x32_bf16 v[44:47], v[176:179], v[212:215], v[44:47]
ds_read_b128 v[176:179], v6 offset:6144
buffer_load_dwordx4 v[208:211], v26, s[4:7], s31 offen offset:3072 sc1
v_mfma_f32_16x16x32_bf16 v[48:51], v[180:183], v[212:215], v[48:51]
ds_read_b128 v[180:183], v6 offset:7168
v_mfma_f32_16x16x32_bf16 v[52:55], v[184:187], v[212:215], v[52:55]
ds_read_b128 v[184:187], v6 offset:8192
v_mfma_f32_16x16x32_bf16 v[56:59], v[188:191], v[212:215], v[56:59]
ds_read_b128 v[188:191], v6 offset:9216
s_waitcnt vmcnt(2) lgkmcnt(5)
s_add_u32 s51, s21, 6
v_cmp_gt_u32 vcc, s51, v3
s_cbranch_vccnz M_sp_61
M_spo_62:
v_mfma_f32_16x16x32_bf16 v[40:43], v[152:155], v[216:219], v[40:43]
ds_read_b128 v[152:155], v6 offset:10240
v_mfma_f32_16x16x32_bf16 v[44:47], v[156:159], v[216:219], v[44:47]
ds_read_b128 v[156:159], v6 offset:11264
buffer_load_dwordx4 v[212:215], v26, s[4:7], s32 offen offset:0 sc1
v_mfma_f32_16x16x32_bf16 v[48:51], v[160:163], v[216:219], v[48:51]
ds_read_b128 v[160:163], v6 offset:12288
v_mfma_f32_16x16x32_bf16 v[52:55], v[164:167], v[216:219], v[52:55]
ds_read_b128 v[164:167], v6 offset:13312
v_mfma_f32_16x16x32_bf16 v[56:59], v[168:171], v[216:219], v[56:59]
ds_read_b128 v[168:171], v6 offset:14336
s_waitcnt lgkmcnt(5)
v_mfma_f32_16x16x32_bf16 v[40:43], v[172:175], v[220:223], v[40:43]
ds_read_b128 v[172:175], v6 offset:15360
v_mfma_f32_16x16x32_bf16 v[44:47], v[176:179], v[220:223], v[44:47]
ds_read_b128 v[176:179], v6 offset:16384
buffer_load_dwordx4 v[216:219], v26, s[4:7], s32 offen offset:1024 sc1
v_mfma_f32_16x16x32_bf16 v[48:51], v[180:183], v[220:223], v[48:51]
ds_read_b128 v[180:183], v6 offset:17408
v_mfma_f32_16x16x32_bf16 v[52:55], v[184:187], v[220:223], v[52:55]
ds_read_b128 v[184:187], v6 offset:18432
v_mfma_f32_16x16x32_bf16 v[56:59], v[188:191], v[220:223], v[56:59]
ds_read_b128 v[188:191], v6 offset:19456
s_waitcnt lgkmcnt(5)
v_mfma_f32_16x16x32_bf16 v[40:43], v[152:155], v[224:227], v[40:43]
ds_read_b128 v[152:155], v6 offset:20480
v_mfma_f32_16x16x32_bf16 v[44:47], v[156:159], v[224:227], v[44:47]
ds_read_b128 v[156:159], v6 offset:21504
buffer_load_dwordx4 v[220:223], v26, s[4:7], s32 offen offset:2048 sc1
v_mfma_f32_16x16x32_bf16 v[48:51], v[160:163], v[224:227], v[48:51]
ds_read_b128 v[160:163], v6 offset:22528
v_mfma_f32_16x16x32_bf16 v[52:55], v[164:167], v[224:227], v[52:55]
ds_read_b128 v[164:167], v6 offset:23552
v_mfma_f32_16x16x32_bf16 v[56:59], v[168:171], v[224:227], v[56:59]
ds_read_b128 v[168:171], v6 offset:24576
s_waitcnt lgkmcnt(5)
v_mfma_f32_16x16x32_bf16 v[40:43], v[172:175], v[192:195], v[40:43]
ds_read_b128 v[172:175], v6 offset:25600
v_mfma_f32_16x16x32_bf16 v[44:47], v[176:179], v[192:195], v[44:47]
ds_read_b128 v[176:179], v6 offset:26624
buffer_load_dwordx4 v[224:227], v26, s[4:7], s32 offen offset:3072 sc1
v_mfma_f32_16x16x32_bf16 v[48:51], v[180:183], v[192:195], v[48:51]
ds_read_b128 v[180:183], v6 offset:27648
v_mfma_f32_16x16x32_bf16 v[52:55], v[184:187], v[192:195], v[52:55]
ds_read_b128 v[184:187], v4 offset:0
v_mfma_f32_16x16x32_bf16 v[56:59], v[188:191], v[192:195], v[56:59]
ds_read_b128 v[188:191], v4 offset:1024
s_waitcnt lgkmcnt(5)
v_mfma_f32_16x16x32_bf16 v[40:43], v[152:155], v[196:199], v[40:43]
ds_read_b32 v253, v252
ds_read_b128 v[152:155], v4 offset:2048
v_mfma_f32_16x16x32_bf16 v[44:47], v[156:159], v[196:199], v[44:47]
ds_read_b128 v[156:159], v4 offset:3072
buffer_load_dwordx4 v[192:195], v26, s[4:7], s33 offen offset:0 sc1
v_mfma_f32_16x16x32_bf16 v[48:51], v[160:163], v[196:199], v[48:51]
ds_read_b128 v[160:163], v4 offset:4096
v_mfma_f32_16x16x32_bf16 v[52:55], v[164:167], v[196:199], v[52:55]
ds_read_b128 v[164:167], v4 offset:5120
v_mfma_f32_16x16x32_bf16 v[56:59], v[168:171], v[196:199], v[56:59]
ds_read_b128 v[168:171], v4 offset:6144
s_waitcnt lgkmcnt(5)
v_subrev_u32 v253, 0xa0a0a0a, v253
v_and_b32 v253, s82, v253
v_cmp_ne_u32 vcc, s82, v253
s_cbranch_vccnz M_lsp_63
M_lspo_64:
v_mfma_f32_16x16x32_bf16 v[40:43], v[172:175], v[200:203], v[40:43]
ds_read_b128 v[172:175], v4 offset:7168
v_mfma_f32_16x16x32_bf16 v[44:47], v[176:179], v[200:203], v[44:47]
ds_read_b128 v[176:179], v4 offset:8192
buffer_load_dwordx4 v[196:199], v26, s[4:7], s33 offen offset:1024 sc1
v_mfma_f32_16x16x32_bf16 v[48:51], v[180:183], v[200:203], v[48:51]
ds_read_b128 v[180:183], v4 offset:9216
v_mfma_f32_16x16x32_bf16 v[52:55], v[184:187], v[200:203], v[52:55]
ds_read_b128 v[184:187], v4 offset:10240
v_mfma_f32_16x16x32_bf16 v[56:59], v[188:191], v[200:203], v[56:59]
ds_read_b128 v[188:191], v4 offset:11264
s_waitcnt vmcnt(7) lgkmcnt(5)
v_mfma_f32_16x16x32_bf16 v[40:43], v[152:155], v[204:207], v[40:43]
ds_read_b128 v[152:155], v4 offset:12288
v_mfma_f32_16x16x32_bf16 v[44:47], v[156:159], v[204:207], v[44:47]
ds_read_b128 v[156:159], v4 offset:13312
buffer_load_dwordx4 v[200:203], v26, s[4:7], s33 offen offset:2048 sc1
v_mfma_f32_16x16x32_bf16 v[48:51], v[160:163], v[204:207], v[48:51]
ds_read_b128 v[160:163], v4 offset:14336
v_mfma_f32_16x16x32_bf16 v[52:55], v[164:167], v[204:207], v[52:55]
ds_read_b128 v[164:167], v4 offset:15360
v_mfma_f32_16x16x32_bf16 v[56:59], v[168:171], v[204:207], v[56:59]
ds_read_b128 v[168:171], v4 offset:16384
s_waitcnt vmcnt(7) lgkmcnt(5)
v_mfma_f32_16x16x32_bf16 v[40:43], v[172:175], v[208:211], v[40:43]
ds_read_b128 v[172:175], v4 offset:17408
v_mfma_f32_16x16x32_bf16 v[44:47], v[176:179], v[208:211], v[44:47]
ds_read_b128 v[176:179], v4 offset:18432
buffer_load_dwordx4 v[204:207], v26, s[4:7], s33 offen offset:3072 sc1
v_mfma_f32_16x16x32_bf16 v[48:51], v[180:183], v[208:211], v[48:51]
ds_read_b128 v[180:183], v4 offset:19456
v_mfma_f32_16x16x32_bf16 v[52:55], v[184:187], v[208:211], v[52:55]
ds_read_b128 v[184:187], v4 offset:20480
v_mfma_f32_16x16x32_bf16 v[56:59], v[188:191], v[208:211], v[56:59]
ds_read_b128 v[188:191], v4 offset:21504
s_waitcnt vmcnt(7) lgkmcnt(5)
v_mfma_f32_16x16x32_bf16 v[40:43], v[152:155], v[212:215], v[40:43]
ds_read_b128 v[152:155], v4 offset:22528
v_mfma_f32_16x16x32_bf16 v[44:47], v[156:159], v[212:215], v[44:47]
ds_read_b128 v[156:159], v4 offset:23552
buffer_load_dwordx4 v[208:211], v26, s[4:7], s34 offen offset:0 sc1
v_mfma_f32_16x16x32_bf16 v[48:51], v[160:163], v[212:215], v[48:51]
ds_read_b128 v[160:163], v4 offset:24576
v_mfma_f32_16x16x32_bf16 v[52:55], v[164:167], v[212:215], v[52:55]
ds_read_b128 v[164:167], v4 offset:25600
v_mfma_f32_16x16x32_bf16 v[56:59], v[168:171], v[212:215], v[56:59]
ds_read_b128 v[168:171], v4 offset:26624
s_waitcnt vmcnt(7) lgkmcnt(5)
v_mfma_f32_16x16x32_bf16 v[40:43], v[172:175], v[216:219], v[40:43]
ds_read_b128 v[172:175], v4 offset:27648
v_mfma_f32_16x16x32_bf16 v[44:47], v[176:179], v[216:219], v[44:47]
ds_read_b128 v[176:179], v4 offset:28672
buffer_load_dwordx4 v[212:215], v26, s[4:7], s34 offen offset:1024 sc1
v_mfma_f32_16x16x32_bf16 v[48:51], v[180:183], v[216:219], v[48:51]
ds_read_b128 v[180:183], v4 offset:29696
v_mfma_f32_16x16x32_bf16 v[52:55], v[184:187], v[216:219], v[52:55]
ds_read_b128 v[184:187], v4 offset:30720
v_mfma_f32_16x16x32_bf16 v[56:59], v[188:191], v[216:219], v[56:59]
ds_read_b128 v[188:191], v4 offset:31744
s_waitcnt vmcnt(7) lgkmcnt(5)
v_mfma_f32_16x16x32_bf16 v[40:43], v[152:155], v[220:223], v[40:43]
ds_read_b128 v[152:155], v4 offset:32768
v_mfma_f32_16x16x32_bf16 v[44:47], v[156:159], v[220:223], v[44:47]
ds_read_b128 v[156:159], v4 offset:33792
buffer_load_dwordx4 v[216:219], v26, s[4:7], s34 offen offset:2048 sc1
v_mfma_f32_16x16x32_bf16 v[48:51], v[160:163], v[220:223], v[48:51]
ds_read_b128 v[160:163], v4 offset:34816
v_mfma_f32_16x16x32_bf16 v[52:55], v[164:167], v[220:223], v[52:55]
ds_read_b128 v[164:167], v4 offset:35840
v_mfma_f32_16x16x32_bf16 v[56:59], v[168:171], v[220:223], v[56:59]
ds_read_b128 v[168:171], v4 offset:36864
s_waitcnt vmcnt(7) lgkmcnt(5)
v_mfma_f32_16x16x32_bf16 v[40:43], v[172:175], v[224:227], v[40:43]
ds_read_b128 v[172:175], v4 offset:37888
v_mfma_f32_16x16x32_bf16 v[44:47], v[176:179], v[224:227], v[44:47]
ds_read_b128 v[176:179], v4 offset:38912
buffer_load_dwordx4 v[220:223], v26, s[4:7], s34 offen offset:3072 sc1
v_mfma_f32_16x16x32_bf16 v[48:51], v[180:183], v[224:227], v[48:51]
ds_read_b128 v[180:183], v4 offset:39936
v_mfma_f32_16x16x32_bf16 v[52:55], v[184:187], v[224:227], v[52:55]
ds_read_b128 v[184:187], v4 offset:40960
v_mfma_f32_16x16x32_bf16 v[56:59], v[188:191], v[224:227], v[56:59]
ds_read_b128 v[188:191], v4 offset:41984
s_waitcnt vmcnt(7) lgkmcnt(5)
v_mfma_f32_16x16x32_bf16 v[40:43], v[152:155], v[192:195], v[40:43]
ds_read_b128 v[152:155], v4 offset:43008
v_mfma_f32_16x16x32_bf16 v[44:47], v[156:159], v[192:195], v[44:47]
ds_read_b128 v[156:159], v4 offset:44032
buffer_load_dwordx4 v[224:227], v26, s[4:7], s35 offen offset:0 sc1
v_mfma_f32_16x16x32_bf16 v[48:51], v[160:163], v[192:195], v[48:51]
ds_read_b128 v[160:163], v4 offset:45056
v_mfma_f32_16x16x32_bf16 v[52:55], v[164:167], v[192:195], v[52:55]
ds_read_b128 v[164:167], v4 offset:46080
v_mfma_f32_16x16x32_bf16 v[56:59], v[168:171], v[192:195], v[56:59]
ds_read_b128 v[168:171], v4 offset:47104
s_waitcnt vmcnt(7) lgkmcnt(5)
v_mfma_f32_16x16x32_bf16 v[40:43], v[172:175], v[196:199], v[40:43]
ds_read_b32 v253, v252
ds_read_b128 v[172:175], v4 offset:48128
v_mfma_f32_16x16x32_bf16 v[44:47], v[176:179], v[196:199], v[44:47]
ds_read_b128 v[176:179], v4 offset:49152
buffer_load_dwordx4 v[192:195], v26, s[4:7], s35 offen offset:1024 sc1
v_mfma_f32_16x16x32_bf16 v[48:51], v[180:183], v[196:199], v[48:51]
ds_read_b128 v[180:183], v4 offset:50176
v_mfma_f32_16x16x32_bf16 v[52:55], v[184:187], v[196:199], v[52:55]
ds_read_b128 v[184:187], v4 offset:51200
v_mfma_f32_16x16x32_bf16 v[56:59], v[188:191], v[196:199], v[56:59]
ds_read_b128 v[188:191], v4 offset:52224
s_waitcnt vmcnt(7) lgkmcnt(5)
v_subrev_u32 v253, 0xb0b0b0b, v253
v_and_b32 v253, s82, v253
v_cmp_ne_u32 vcc, s82, v253
s_cbranch_vccnz M_lsp_65
M_lspo_66:
v_mfma_f32_16x16x32_bf16 v[40:43], v[152:155], v[200:203], v[40:43]
ds_read_b128 v[152:155], v4 offset:53248
v_mfma_f32_16x16x32_bf16 v[44:47], v[156:159], v[200:203], v[44:47]
ds_read_b128 v[156:159], v4 offset:54272
buffer_load_dwordx4 v[196:199], v26, s[4:7], s35 offen offset:2048 sc1
v_mfma_f32_16x16x32_bf16 v[48:51], v[160:163], v[200:203], v[48:51]
ds_read_b128 v[160:163], v4 offset:55296
v_mfma_f32_16x16x32_bf16 v[52:55], v[164:167], v[200:203], v[52:55]
ds_read_b128 v[164:167], v4 offset:56320
v_mfma_f32_16x16x32_bf16 v[56:59], v[168:171], v[200:203], v[56:59]
ds_read_b128 v[168:171], v4 offset:57344
s_waitcnt vmcnt(7) lgkmcnt(5)
v_mfma_f32_16x16x32_bf16 v[40:43], v[172:175], v[204:207], v[40:43]
ds_read_b128 v[172:175], v4 offset:58368
v_mfma_f32_16x16x32_bf16 v[44:47], v[176:179], v[204:207], v[44:47]
ds_read_b128 v[176:179], v4 offset:59392
buffer_load_dwordx4 v[200:203], v26, s[4:7], s35 offen offset:3072 sc1
v_mfma_f32_16x16x32_bf16 v[48:51], v[180:183], v[204:207], v[48:51]
ds_read_b128 v[180:183], v4 offset:60416
v_mfma_f32_16x16x32_bf16 v[52:55], v[184:187], v[204:207], v[52:55]
ds_read_b128 v[184:187], v4 offset:61440
v_mfma_f32_16x16x32_bf16 v[56:59], v[188:191], v[204:207], v[56:59]
ds_read_b128 v[188:191], v4 offset:62464
s_waitcnt vmcnt(7) lgkmcnt(5)
v_mfma_f32_16x16x32_bf16 v[40:43], v[152:155], v[208:211], v[40:43]
ds_read_b128 v[152:155], v4 offset:63488
v_mfma_f32_16x16x32_bf16 v[44:47], v[156:159], v[208:211], v[44:47]
ds_read_b128 v[156:159], v4 offset:64512
v_mfma_f32_16x16x32_bf16 v[48:51], v[160:163], v[208:211], v[48:51]
ds_read_b128 v[160:163], v5 offset:0
v_mfma_f32_16x16x32_bf16 v[52:55], v[164:167], v[208:211], v[52:55]
ds_read_b128 v[164:167], v5 offset:1024
v_mfma_f32_16x16x32_bf16 v[56:59], v[168:171], v[208:211], v[56:59]
ds_read_b128 v[168:171], v5 offset:2048
s_waitcnt vmcnt(6) lgkmcnt(5)
v_mfma_f32_16x16x32_bf16 v[40:43], v[172:175], v[212:215], v[40:43]
ds_read_b128 v[172:175], v5 offset:3072
v_mfma_f32_16x16x32_bf16 v[44:47], v[176:179], v[212:215], v[44:47]
ds_read_b128 v[176:179], v5 offset:4096
v_mfma_f32_16x16x32_bf16 v[48:51], v[180:183], v[212:215], v[48:51]
ds_read_b128 v[180:183], v5 offset:5120
v_mfma_f32_16x16x32_bf16 v[52:55], v[184:187], v[212:215], v[52:55]
ds_read_b128 v[184:187], v5 offset:6144
v_mfma_f32_16x16x32_bf16 v[56:59], v[188:191], v[212:215], v[56:59]
ds_read_b128 v[188:191], v5 offset:7168
s_waitcnt vmcnt(5) lgkmcnt(5)
v_mfma_f32_16x16x32_bf16 v[40:43], v[152:155], v[216:219], v[40:43]
ds_read_b128 v[152:155], v5 offset:8192
v_mfma_f32_16x16x32_bf16 v[44:47], v[156:159], v[216:219], v[44:47]
ds_read_b128 v[156:159], v5 offset:9216
v_mfma_f32_16x16x32_bf16 v[48:51], v[160:163], v[216:219], v[48:51]
ds_read_b128 v[160:163], v5 offset:10240
v_mfma_f32_16x16x32_bf16 v[52:55], v[164:167], v[216:219], v[52:55]
ds_read_b128 v[164:167], v5 offset:11264
v_mfma_f32_16x16x32_bf16 v[56:59], v[168:171], v[216:219], v[56:59]
ds_read_b128 v[168:171], v5 offset:12288
s_waitcnt vmcnt(4) lgkmcnt(5)
v_mfma_f32_16x16x32_bf16 v[40:43], v[172:175], v[220:223], v[40:43]
ds_read_b128 v[172:175], v5 offset:13312
v_mfma_f32_16x16x32_bf16 v[44:47], v[176:179], v[220:223], v[44:47]
ds_read_b128 v[176:179], v5 offset:14336
v_mfma_f32_16x16x32_bf16 v[48:51], v[180:183], v[220:223], v[48:51]
ds_read_b128 v[180:183], v5 offset:15360
v_mfma_f32_16x16x32_bf16 v[52:55], v[184:187], v[220:223], v[52:55]
ds_read_b128 v[184:187], v5 offset:16384
v_mfma_f32_16x16x32_bf16 v[56:59], v[188:191], v[220:223], v[56:59]
ds_read_b128 v[188:191], v5 offset:17408
s_waitcnt vmcnt(3) lgkmcnt(5)
v_mfma_f32_16x16x32_bf16 v[40:43], v[152:155], v[224:227], v[40:43]
ds_read_b128 v[152:155], v5 offset:18432
v_mfma_f32_16x16x32_bf16 v[44:47], v[156:159], v[224:227], v[44:47]
ds_read_b128 v[156:159], v5 offset:19456
v_mfma_f32_16x16x32_bf16 v[48:51], v[160:163], v[224:227], v[48:51]
ds_read_b128 v[160:163], v5 offset:20480
v_mfma_f32_16x16x32_bf16 v[52:55], v[164:167], v[224:227], v[52:55]
ds_read_b128 v[164:167], v5 offset:21504
v_mfma_f32_16x16x32_bf16 v[56:59], v[168:171], v[224:227], v[56:59]
ds_read_b128 v[168:171], v5 offset:22528
s_waitcnt vmcnt(2) lgkmcnt(5)
v_mfma_f32_16x16x32_bf16 v[40:43], v[172:175], v[192:195], v[40:43]
ds_read_b128 v[172:175], v5 offset:23552
v_mfma_f32_16x16x32_bf16 v[44:47], v[176:179], v[192:195], v[44:47]
ds_read_b128 v[176:179], v5 offset:24576
v_mfma_f32_16x16x32_bf16 v[48:51], v[180:183], v[192:195], v[48:51]
ds_read_b128 v[180:183], v5 offset:25600
v_mfma_f32_16x16x32_bf16 v[52:55], v[184:187], v[192:195], v[52:55]
ds_read_b128 v[184:187], v5 offset:26624
v_mfma_f32_16x16x32_bf16 v[56:59], v[188:191], v[192:195], v[56:59]
ds_read_b128 v[188:191], v5 offset:27648
s_waitcnt vmcnt(1) lgkmcnt(5)
v_mfma_f32_16x16x32_bf16 v[40:43], v[152:155], v[196:199], v[40:43]
v_mfma_f32_16x16x32_bf16 v[44:47], v[156:159], v[196:199], v[44:47]
v_mfma_f32_16x16x32_bf16 v[48:51], v[160:163], v[196:199], v[48:51]
v_mfma_f32_16x16x32_bf16 v[52:55], v[164:167], v[196:199], v[52:55]
v_mfma_f32_16x16x32_bf16 v[56:59], v[168:171], v[196:199], v[56:59]
s_waitcnt vmcnt(0) lgkmcnt(0)
v_mfma_f32_16x16x32_bf16 v[40:43], v[172:175], v[200:203], v[40:43]
v_mfma_f32_16x16x32_bf16 v[44:47], v[176:179], v[200:203], v[44:47]
v_mfma_f32_16x16x32_bf16 v[48:51], v[180:183], v[200:203], v[48:51]
ds_add_u32 v250, v251
v_mfma_f32_16x16x32_bf16 v[52:55], v[184:187], v[200:203], v[52:55]
v_mfma_f32_16x16x32_bf16 v[56:59], v[188:191], v[200:203], v[56:59]
s_nop 3
v_cvt_pk_bf16_f32 v128, v40, v41
v_cvt_pk_bf16_f32 v129, v42, v43
v_cvt_pk_bf16_f32 v130, v44, v45
v_cvt_pk_bf16_f32 v131, v46, v47
v_cvt_pk_bf16_f32 v132, v48, v49
v_cvt_pk_bf16_f32 v133, v50, v51
v_cvt_pk_bf16_f32 v134, v52, v53
v_cvt_pk_bf16_f32 v135, v54, v55
v_cvt_pk_bf16_f32 v136, v56, v57
v_cvt_pk_bf16_f32 v137, v58, v59
s_cmp_eq_u32 s20, 1
s_cbranch_scc1 M_final
s_mov_b32 s20, 1
s_mov_b32 s21, 6
s_mov_b32 s63, s19
s_add_u32 s62, s62, 557056
s_branch M_layer
M_final:
buffer_store_dwordx2 v[128:129], v29, s[12:15], 0 offen offset:0
buffer_store_dwordx2 v[130:131], v29, s[12:15], 0 offen offset:32
buffer_store_dwordx2 v[132:133], v29, s[12:15], 0 offen offset:64
buffer_store_dwordx2 v[134:135], v29, s[12:15], 0 offen offset:96
buffer_store_dwordx2 v[136:137], v29, s[12:15], 0 offen offset:128
s_endpgm
M_slowadj:
s_mov_b32 s61, 28311552
v_add_u32 v24, 28311552, v24
v_mov_b32 v1, 28311552
s_mov_b32 s49, 40370176
v_cmp_gt_u32 vcc, s49, v17
s_nop 1
v_cndmask_b32 v3, 0, v1, vcc
v_add_u32 v17, v17, v3
v_cmp_gt_u32 vcc, s49, v18
s_nop 1
v_cndmask_b32 v3, 0, v1, vcc
v_add_u32 v18, v18, v3
v_cmp_gt_u32 vcc, s49, v19
s_nop 1
v_cndmask_b32 v3, 0, v1, vcc
v_add_u32 v19, v19, v3
v_cmp_gt_u32 vcc, s49, v20
s_nop 1
v_cndmask_b32 v3, 0, v1, vcc
v_add_u32 v20, v20, v3
v_cmp_gt_u32 vcc, s49, v21
s_nop 1
v_cndmask_b32 v3, 0, v1, vcc
v_add_u32 v21, v21, v3
v_cmp_gt_u32 vcc, s49, v22
s_nop 1
v_cndmask_b32 v3, 0, v1, vcc
v_add_u32 v22, v22, v3
s_branch M_xdone
M_slow_1:
buffer_store_dword v243, v10, s[4:7], s48 offen sc1
s_branch M_back_2
M_slow_5:
buffer_store_dwordx4 v[128:131], v8, s[4:7], s60 offen sc1
buffer_store_dwordx4 v[132:135], v8, s[4:7], s60 offen offset:1024 sc1
s_mov_b64 exec, s[44:45]
buffer_store_dwordx4 v[140:143], v9, s[4:7], s60 offen sc1
s_mov_b64 exec, -1
s_branch M_back_6
M_slow_7:
buffer_store_dword v243, v10, s[4:7], s48 offen sc1
s_branch M_back_8
M_slow_9:
s_waitcnt vmcnt(1)
buffer_store_dword v1, off, s[4:7], s23 sc1
s_branch M_back_10
M_lsp_13:
ds_read_b32 v253, v252
s_cmp_eq_u32 s22, 0
s_cbranch_scc1 M_lspo_14
s_sub_u32 s22, s22, 1
s_waitcnt lgkmcnt(0)
v_subrev_u32 v253, 0x1010101, v253
v_and_b32 v253, s82, v253
v_cmp_ne_u32 vcc, s82, v253
s_cbranch_vccnz M_lsp_13
s_branch M_lspo_14
M_sp_15:
buffer_load_dwordx4 v[232:235], v11, s[4:7], s48 offen offset:0 sc1
s_cmp_eq_u32 s22, 0
s_cbranch_scc1 M_spo_16x
s_sub_u32 s22, s22, 1
s_waitcnt vmcnt(0)
v_max3_u32 v1, v232, v233, v234
v_max_u32 v1, v1, v235
v_cmp_eq_u32 vcc, -1, v1
s_cbranch_vccnz M_sp_15
M_spo_16x:
s_waitcnt vmcnt(0)
s_branch M_spo_16
M_slow_17:
s_mov_b64 exec, s[36:37]
buffer_store_dwordx4 v[128:131], v21, s[4:7], 0 offen sc1
buffer_store_dwordx4 v[132:135], v21, s[4:7], 0 offen offset:1024 sc1
s_mov_b64 exec, s[38:39]
buffer_store_dwordx4 v[140:143], v22, s[4:7], 0 offen sc1
s_branch M_back_18
M_slow_19:
buffer_store_dword v1, off, s[4:7], s23 sc1
s_branch M_back_20
M_lsp_25:
ds_read_b32 v253, v252
s_cmp_eq_u32 s22, 0
s_cbranch_scc1 M_lspo_26
s_sub_u32 s22, s22, 1
s_waitcnt lgkmcnt(0)
v_subrev_u32 v253, 0x2020202, v253
v_and_b32 v253, s82, v253
v_cmp_ne_u32 vcc, s82, v253
s_cbranch_vccnz M_lsp_25
s_branch M_lspo_26
M_lsp_27:
ds_read_b32 v253, v252
s_cmp_eq_u32 s22, 0
s_cbranch_scc1 M_lspo_28
s_sub_u32 s22, s22, 1
s_waitcnt lgkmcnt(0)
v_subrev_u32 v253, 0x3030303, v253
v_and_b32 v253, s82, v253
v_cmp_ne_u32 vcc, s82, v253
s_cbranch_vccnz M_lsp_27
s_branch M_lspo_28
M_slow_29:
buffer_store_dwordx4 v[128:131], v8, s[4:7], s61 offen sc1
buffer_store_dwordx4 v[132:135], v8, s[4:7], s61 offen offset:1024 sc1
s_mov_b64 exec, s[44:45]
buffer_store_dwordx4 v[140:143], v9, s[4:7], s61 offen sc1
s_mov_b64 exec, -1
s_branch M_back_30
M_slow_31:
buffer_store_dword v243, v10, s[4:7], s48 offen sc1
s_branch M_back_32
M_slow_33:
s_waitcnt vmcnt(1)
buffer_store_dword v1, off, s[4:7], s23 sc1
s_branch M_back_34
M_lsp_37:
ds_read_b32 v253, v252
s_cmp_eq_u32 s22, 0
s_cbranch_scc1 M_lspo_38
s_sub_u32 s22, s22, 1
s_waitcnt lgkmcnt(0)
v_subrev_u32 v253, 0x4040404, v253
v_and_b32 v253, s82, v253
v_cmp_ne_u32 vcc, s82, v253
s_cbranch_vccnz M_lsp_37
s_branch M_lspo_38
M_sp_39:
buffer_load_dwordx4 v[232:235], v12, s[4:7], s48 offen offset:0 sc1
buffer_load_dwordx4 v[236:239], v12, s[4:7], s48 offen offset:16 sc1
s_cmp_eq_u32 s22, 0
s_cbranch_scc1 M_spo_40x
s_sub_u32 s22, s22, 1
s_waitcnt vmcnt(0)
v_max3_u32 v1, v232, v233, v234
v_max3_u32 v1, v1, v235, v236
v_max3_u32 v1, v1, v237, v238
v_max_u32 v1, v1, v239
v_cmp_eq_u32 vcc, -1, v1
s_cbranch_vccnz M_sp_39
M_spo_40x:
s_waitcnt vmcnt(0)
s_branch M_spo_40
M_lsp_41:
ds_read_b32 v253, v252
s_cmp_eq_u32 s22, 0
s_cbranch_scc1 M_lspo_42
s_sub_u32 s22, s22, 1
s_waitcnt lgkmcnt(0)
v_subrev_u32 v253, 0x5050505, v253
v_and_b32 v253, s82, v253
v_cmp_ne_u32 vcc, s82, v253
s_cbranch_vccnz M_lsp_41
s_branch M_lspo_42
M_lsp_43:
ds_read_b32 v253, v252
s_cmp_eq_u32 s22, 0
s_cbranch_scc1 M_lspo_44
s_sub_u32 s22, s22, 1
s_waitcnt lgkmcnt(0)
v_subrev_u32 v253, 0x6060606, v253
v_and_b32 v253, s82, v253
v_cmp_ne_u32 vcc, s82, v253
s_cbranch_vccnz M_lsp_43
s_branch M_lspo_44
M_slow_45:
s_waitcnt vmcnt(0)
buffer_store_dword v1, off, s[4:7], s23 sc1
s_branch M_back_46
M_sp_47:
buffer_load_dword v3, v16, s[4:7], 0 offen sc1
s_cmp_eq_u32 s22, 0
s_cbranch_scc1 M_spo_48
s_sub_u32 s22, s22, 1
s_waitcnt vmcnt(0)
v_cmp_gt_u32 vcc, s51, v3
s_cbranch_vccnz M_sp_47
s_branch M_spo_48
M_lsp_49:
ds_read_b32 v253, v252
s_cmp_eq_u32 s22, 0
s_cbranch_scc1 M_lspo_50
s_sub_u32 s22, s22, 1
s_waitcnt lgkmcnt(0)
v_subrev_u32 v253, 0x7070707, v253
v_and_b32 v253, s82, v253
v_cmp_ne_u32 vcc, s82, v253
s_cbranch_vccnz M_lsp_49
s_branch M_lspo_50
M_slow_51:
buffer_store_dword v1, off, s[4:7], s23 sc1
s_branch M_back_52
M_sp_53:
buffer_load_dword v3, v16, s[4:7], 0 offen sc1
s_cmp_eq_u32 s22, 0
s_cbranch_scc1 M_spo_54
s_sub_u32 s22, s22, 1
s_waitcnt vmcnt(0)
v_cmp_gt_u32 vcc, s51, v3
s_cbranch_vccnz M_sp_53
s_branch M_spo_54
M_slow_55:
buffer_store_dword v1, off, s[4:7], s23 sc1
s_branch M_back_56
M_lsp_57:
ds_read_b32 v253, v252
s_cmp_eq_u32 s22, 0
s_cbranch_scc1 M_lspo_58
s_sub_u32 s22, s22, 1
s_waitcnt lgkmcnt(0)
v_subrev_u32 v253, 0x8080808, v253
v_and_b32 v253, s82, v253
v_cmp_ne_u32 vcc, s82, v253
s_cbranch_vccnz M_lsp_57
s_branch M_lspo_58
M_lsp_59:
ds_read_b32 v253, v252
s_cmp_eq_u32 s22, 0
s_cbranch_scc1 M_lspo_60
s_sub_u32 s22, s22, 1
s_waitcnt lgkmcnt(0)
v_subrev_u32 v253, 0x9090909, v253
v_and_b32 v253, s82, v253
v_cmp_ne_u32 vcc, s82, v253
s_cbranch_vccnz M_lsp_59
s_branch M_lspo_60
M_sp_61:
buffer_load_dword v3, v16, s[4:7], 0 offen sc1
s_cmp_eq_u32 s22, 0
s_cbranch_scc1 M_spo_62
s_sub_u32 s22, s22, 1
s_waitcnt vmcnt(0)
v_cmp_gt_u32 vcc, s51, v3
s_cbranch_vccnz M_sp_61
s_branch M_spo_62
M_lsp_63:
ds_read_b32 v253, v252
s_cmp_eq_u32 s22, 0
s_cbranch_scc1 M_lspo_64
s_sub_u32 s22, s22, 1
s_waitcnt lgkmcnt(0)
v_subrev_u32 v253, 0xa0a0a0a, v253
v_and_b32 v253, s82, v253
v_cmp_ne_u32 vcc, s82, v253
s_cbranch_vccnz M_lsp_63
s_branch M_lspo_64
M_lsp_65:
ds_read_b32 v253, v252
s_cmp_eq_u32 s22, 0
s_cbranch_scc1 M_lspo_66
s_sub_u32 s22, s22, 1
s_waitcnt lgkmcnt(0)
v_subrev_u32 v253, 0xb0b0b0b, v253
v_and_b32 v253, s82, v253
v_cmp_ne_u32 vcc, s82, v253
s_cbranch_vccnz M_lsp_65
s_branch M_lspo_66
M_loader:
ds_add_u32 v250, v251 offset:52
s_waitcnt lgkmcnt(0)
s_mov_b32 s4, s48
s_and_b32 s5, s49, 0xffff
s_mov_b32 s6, 0x10000000
s_mov_b32 s7, 0x00020000
s_sub_u32 s18, s18, 4
s_lshl_b32 s44, s18, 10
v_add_u32 v1, s44, v4
v_add_u32 v4, s44, v4
v_add_u32 v5, 0x10000, v4
v_add_u32 v6, 0x20000, v4
s_mov_b32 s26, s3
s_mul_i32 s60, s17, 102400
s_add_u32 s61, s60, 6586368
s_add_u32 s60, s60, 5767168
s_mul_i32 s62, s3, 122880
s_add_u32 s62, s62, 7405568
s_mul_i32 s63, s17, 245760
s_add_u32 s63, s63, 9371648
s_lshl_b32 s45, s16, 2
s_add_u32 s45, s45, s18
s_mul_i32 s46, s45, 20480
s_lshl_b32 s47, s17, 11
s_add_u32 s47, s47, s46
s_lshr_b32 s24, s17, 1
s_add_u32 s24, s24, 16
s_lshl_b32 s24, s24, 10
s_and_b32 s25, s17, 1
s_lshl_b32 s25, s25, 9
s_add_u32 s24, s24, s25
s_add_u32 s24, s24, s46
s_sub_u32 s24, s24, s47
s_sub_u32 s24, s24, 2048
v_subrev_u32 v8, 44, v0
v_cmp_le_u32 vcc, 44, v0
v_mov_b32 v10, 0
v_mov_b32 v11, 3145728
v_cndmask_b32 v8, v0, v8, vcc
v_cndmask_b32 v10, v10, v11, vcc
v_cmp_le_u32 vcc, 16, v8
v_lshlrev_b32 v9, 7, v8
v_mov_b32 v11, s24
v_add_u32 v9, s47, v9
v_cndmask_b32 v11, 0, v11, vcc
v_add_u32 v9, v9, v11
v_add_u32 v10, v10, v9
v_subrev_u32 v8, 20, v0
v_cmp_gt_u32 vcc, 24, v8
v_lshrrev_b32 v11, 3, v8
v_and_b32 v8, 7, v8
v_lshlrev_b32 v11, 17, v11
v_lshl_add_u32 v8, v8, 7, v11
s_lshl_b32 s45, s45, 10
s_add_u32 s45, s45, 40370176
v_add_u32 v8, s45, v8
v_mov_b32 v2, s45
v_cndmask_b32 v2, v2, v8, vcc
v_add_u32 v8, 557056, v8
v_cndmask_b32 v3, v10, v8, vcc
v_min_u32 v8, 47, v0
v_cmp_le_u32 vcc, 24, v8
v_subrev_u32 v9, 24, v8
s_lshr_b32 s45, s16, 1
s_lshl_b32 s45, s45, 2
s_add_u32 s45, s45, s18
s_mul_i32 s45, s45, 98304
v_cndmask_b32 v8, v8, v9, vcc
v_mov_b32 v9, 49152
v_cndmask_b32 v9, 0, v9, vcc
v_lshrrev_b32 v10, 3, v8
v_and_b32 v8, 7, v8
v_lshlrev_b32 v10, 14, v10
v_lshl_add_u32 v8, v8, 7, v10
v_add_u32 v8, v8, v9
s_lshl_b32 s46, s26, 10
s_add_u32 s45, s45, s46
s_add_u32 s45, s45, 34078720
v_add_u32 v248, s45, v8
v_add_u32 v250, 8, v250
s_mov_b32 s30, s82
s_mov_b32 s31, s82
s_mov_b32 s32, 0
s_mov_b32 s33, 0
s_mov_b32 s22, 4000000
s_and_b32 s45, s18, 1
s_lshl_b32 s45, s45, 6
v_add_u32 v8, s45, v0
s_mul_i32 s45, s17, 320
s_add_u32 s45, s45, 11337728
s_mul_i32 s46, s26, 384
s_add_u32 s46, s46, 11388928
s_cmp_ge_u32 s18, 2
s_cselect_b32 s45, s46, s45
s_cselect_b32 s46, 16, 0
s_cselect_b32 s47, 320, 0
s_add_u32 s46, s46, 79
v_min_u32 v8, s46, v8
v_lshlrev_b32 v8, 2, v8
v_add_u32 v249, s45, v8
s_add_u32 s47, s47, 159744
v_add_u32 v254, s47, v8
v_mov_b32 v12, 160552
M_lsln:
ds_read_b32 v13, v12
s_cmp_eq_u32 s22, 0
s_cbranch_scc1 M_loln
s_sub_u32 s22, s22, 1
s_waitcnt lgkmcnt(0)
v_cmp_eq_u32 vcc, s82, v13
s_cbranch_vccnz M_lsln
M_loln:
s_waitcnt lgkmcnt(0)
v_readfirstlane_b32 s36, v13
s_cmp_lg_u32 s18, 3
s_cbranch_scc1 M_nl2a
s_and_b32 s38, s2, 7
s_lshl_b32 s38, s38, 7
s_add_u32 s38, s38, 11526144
v_and_b32 v7, 7, v0
v_lshlrev_b32 v7, 2, v7
s_and_b32 s39, s2, 7
s_lshl_b32 s39, s39, 8
s_add_u32 s39, s39, 11524304
M_q2a:
buffer_load_dword v253, off, s[4:7], s39 sc1
s_cmp_eq_u32 s22, 0
s_cbranch_scc1 M_qo2a
s_sub_u32 s22, s22, 1
s_waitcnt vmcnt(0)
v_cmp_ne_u32 vcc, 1, v253
s_cbranch_vccnz M_q2a
M_qo2a:
M_p2a:
buffer_load_dword v253, v7, s[4:7], s38 offen sc1
s_cmp_eq_u32 s22, 0
s_cbranch_scc1 M_po2a
s_sub_u32 s22, s22, 1
s_waitcnt vmcnt(0)
v_cmp_ne_u32 vcc, s36, v253
s_cbranch_vccnz M_p2a
M_po2a:
v_mov_b32 v7, 160536
ds_write_b32 v7, v7
M_nl2a:
v_mov_b32 v7, 160536
M_lsl2a:
ds_read_b32 v253, v7
s_cmp_eq_u32 s22, 0
s_cbranch_scc1 M_lol2a
s_sub_u32 s22, s22, 1
s_waitcnt lgkmcnt(0)
v_cmp_eq_u32 vcc, s82, v253
s_cbranch_vccnz M_lsl2a
M_lol2a:
s_waitcnt lgkmcnt(0)
s_setprio 0
buffer_load_dword v7, v2, s[4:7], 0 offen sc1
s_add_u32 s43, s60, 0
s_add_u32 s40, s44, 0
s_mov_b32 s41, 10
M_ld_67:
s_mov_b32 m0, s40
s_add_u32 s40, s40, 4096
s_cmp_ge_u32 s40, 159744
s_cselect_b32 s42, 159744, 0
s_sub_u32 s40, s40, s42
s_waitcnt vmcnt(23)
buffer_load_dwordx4 v1, s[4:7], s43 offen sc1 lds
s_add_u32 s43, s43, 4096
s_sub_u32 s41, s41, 1
s_cmp_lg_u32 s41, 0
s_cbranch_scc1 M_ld_67
ds_read_b32 v253, v252 offset:36
s_waitcnt lgkmcnt(0)
v_readfirstlane_b32 s34, v253
s_nop 0
s_sub_u32 s35, s34, 0x1010101
s_and_b32 s35, s35, s82
s_cmp_eq_u32 s35, s82
s_cbranch_scc1 M_go_68
s_waitcnt vmcnt(0)
M_fs_69:
ds_read_b32 v253, v252 offset:36
s_cmp_eq_u32 s22, 0
s_cbranch_scc1 M_go_68
s_sub_u32 s22, s22, 1
s_waitcnt lgkmcnt(0)
v_readfirstlane_b32 s34, v253
s_nop 0
s_sub_u32 s35, s34, 0x1010101
s_and_b32 s35, s35, s82
s_cmp_eq_u32 s35, s82
s_cbranch_scc1 M_go_68

s_branch M_fs_69
M_go_68:
s_add_u32 s43, s60, 40960
s_add_u32 s40, s44, 40960
s_mov_b32 s41, 10
M_ld_70:
s_mov_b32 m0, s40
s_add_u32 s40, s40, 4096
s_cmp_ge_u32 s40, 159744
s_cselect_b32 s42, 159744, 0
s_sub_u32 s40, s40, s42
s_waitcnt vmcnt(23)
buffer_load_dwordx4 v1, s[4:7], s43 offen sc1 lds
s_add_u32 s43, s43, 4096
s_sub_u32 s41, s41, 1
s_cmp_lg_u32 s41, 0
s_cbranch_scc1 M_ld_70
s_waitcnt vmcnt(10)
ds_read_b128 v[8:11], v4 offset:0
ds_read_b128 v[12:15], v4 offset:4096
ds_read_b128 v[16:19], v4 offset:8192
ds_read_b128 v[20:23], v4 offset:12288
ds_read_b128 v[24:27], v4 offset:16384
ds_read_b128 v[28:31], v4 offset:20480
ds_read_b128 v[32:35], v4 offset:24576
ds_read_b128 v[36:39], v4 offset:28672
ds_read_b128 v[40:43], v4 offset:32768
ds_read_b128 v[44:47], v4 offset:36864
s_waitcnt lgkmcnt(0)
s_add_u32 s43, s60, 81920
s_add_u32 s40, s44, 81920
s_mov_b32 s41, 1
M_ld_71:
s_mov_b32 m0, s40
s_add_u32 s40, s40, 4096
s_cmp_ge_u32 s40, 159744
s_cselect_b32 s42, 159744, 0
s_sub_u32 s40, s40, s42
s_waitcnt vmcnt(23)
buffer_load_dwordx4 v1, s[4:7], s43 offen sc1 lds
s_add_u32 s43, s43, 4096
s_sub_u32 s41, s41, 1
s_cmp_lg_u32 s41, 0
s_cbranch_scc1 M_ld_71
s_waitcnt vmcnt(1)
ds_read_b128 v[48:51], v4 offset:40960
ds_read_b128 v[52:55], v4 offset:45056
ds_read_b128 v[56:59], v4 offset:49152
ds_read_b128 v[60:63], v4 offset:53248
ds_read_b128 v[64:67], v4 offset:57344
ds_read_b128 v[68:71], v4 offset:61440
ds_read_b128 v[72:75], v5 offset:0
ds_read_b128 v[76:79], v5 offset:4096
ds_read_b128 v[80:83], v5 offset:8192
ds_read_b128 v[84:87], v5 offset:12288
s_waitcnt lgkmcnt(0)
ds_read_b32 v253, v252 offset:52
s_waitcnt lgkmcnt(0)
v_readfirstlane_b32 s34, v253
s_nop 0
s_sub_u32 s35, s34, 0x1010101
s_and_b32 s35, s35, s82
s_cmp_eq_u32 s35, s82
s_cbranch_scc1 M_go_72
s_waitcnt vmcnt(0)
M_fs_73:
ds_read_b32 v253, v252 offset:52
s_cmp_eq_u32 s22, 0
s_cbranch_scc1 M_go_72
s_sub_u32 s22, s22, 1
s_waitcnt lgkmcnt(0)
v_readfirstlane_b32 s34, v253
s_nop 0
s_sub_u32 s35, s34, 0x1010101
s_and_b32 s35, s35, s82
s_cmp_eq_u32 s35, s82
s_cbranch_scc1 M_go_72

s_branch M_fs_73
M_go_72:
s_add_u32 s43, s60, 86016
s_add_u32 s40, s44, 86016
s_mov_b32 s41, 4
M_ld_74:
s_mov_b32 m0, s40
s_add_u32 s40, s40, 4096
s_cmp_ge_u32 s40, 159744
s_cselect_b32 s42, 159744, 0
s_sub_u32 s40, s40, s42
s_waitcnt vmcnt(23)
buffer_load_dwordx4 v1, s[4:7], s43 offen sc1 lds
s_add_u32 s43, s43, 4096
s_sub_u32 s41, s41, 1
s_cmp_lg_u32 s41, 0
s_cbranch_scc1 M_ld_74
s_lshr_b32 s37, s18, 1
s_cmp_lg_u32 s37, 0
s_cbranch_scc1 M_cs_75
buffer_load_dword v128, v249, s[4:7], 0 offen sc1
v_add_u32 v249, 2560, v249
buffer_load_dword v129, v249, s[4:7], 0 offen sc1
v_add_u32 v249, 2560, v249
buffer_load_dword v130, v249, s[4:7], 0 offen sc1
v_add_u32 v249, 2560, v249
buffer_load_dword v131, v249, s[4:7], 0 offen sc1
v_add_u32 v249, 2560, v249
buffer_load_dword v132, v249, s[4:7], 0 offen sc1
v_add_u32 v249, 2560, v249
buffer_load_dword v133, v249, s[4:7], 0 offen sc1
v_add_u32 v249, 2560, v249
buffer_load_dword v134, v249, s[4:7], 0 offen sc1
v_add_u32 v249, 2560, v249
buffer_load_dword v135, v249, s[4:7], 0 offen sc1
v_add_u32 v249, 2560, v249
buffer_load_dword v136, v249, s[4:7], 0 offen sc1
v_add_u32 v249, 2560, v249
buffer_load_dword v137, v249, s[4:7], 0 offen sc1
v_add_u32 v249, 2560, v249
buffer_load_dword v138, v249, s[4:7], 0 offen sc1
v_add_u32 v249, 2560, v249
buffer_load_dword v139, v249, s[4:7], 0 offen sc1
v_add_u32 v249, 2560, v249
buffer_load_dword v140, v249, s[4:7], 0 offen sc1
v_add_u32 v249, 2560, v249
buffer_load_dword v141, v249, s[4:7], 0 offen sc1
v_add_u32 v249, 2560, v249
buffer_load_dword v142, v249, s[4:7], 0 offen sc1
v_add_u32 v249, 2560, v249
buffer_load_dword v143, v249, s[4:7], 0 offen sc1
v_add_u32 v249, 2560, v249
buffer_load_dword v144, v249, s[4:7], 0 offen sc1
v_add_u32 v249, 2560, v249
buffer_load_dword v145, v249, s[4:7], 0 offen sc1
v_add_u32 v249, 2560, v249
buffer_load_dword v146, v249, s[4:7], 0 offen sc1
v_add_u32 v249, 2560, v249
buffer_load_dword v147, v249, s[4:7], 0 offen sc1
v_add_u32 v249, 2560, v249
s_waitcnt vmcnt(0)
v_add_f32 v128, v128, v129
v_add_f32 v128, v128, v130
v_add_f32 v128, v128, v131
v_add_f32 v128, v128, v132
v_add_f32 v128, v128, v133
v_add_f32 v128, v128, v134
v_add_f32 v128, v128, v135
v_add_f32 v128, v128, v136
v_add_f32 v128, v128, v137
v_add_f32 v128, v128, v138
v_add_f32 v128, v128, v139
v_add_f32 v128, v128, v140
v_add_f32 v128, v128, v141
v_add_f32 v128, v128, v142
v_add_f32 v128, v128, v143
v_add_f32 v128, v128, v144
v_add_f32 v128, v128, v145
v_add_f32 v128, v128, v146
v_add_f32 v128, v128, v147
ds_write_b32 v254, v128
s_waitcnt lgkmcnt(0)
M_cs_75:
s_waitcnt vmcnt(4)
ds_read_b128 v[88:91], v5 offset:16384
s_waitcnt lgkmcnt(0)
s_waitcnt vmcnt(0)
s_cmp_ge_u32 s32, 1
s_cbranch_scc1 M_pb_76
s_mov_b32 s32, 1
ds_add_u32 v250, v251 offset:0
M_pb_76:
ds_read_b128 v[92:95], v5 offset:20480
ds_read_b128 v[96:99], v5 offset:24576
ds_read_b128 v[100:103], v5 offset:28672
ds_read_b128 v[104:107], v5 offset:32768
s_waitcnt lgkmcnt(0)
s_cmp_lg_u32 s18, 3
s_cbranch_scc1 M_nl2b
s_and_b32 s38, s2, 7
s_lshl_b32 s38, s38, 7
s_add_u32 s38, s38, 11526176
v_and_b32 v7, 7, v0
v_lshlrev_b32 v7, 2, v7
s_and_b32 s39, s2, 7
s_lshl_b32 s39, s39, 8
s_add_u32 s39, s39, 11524308
M_q2b:
buffer_load_dword v253, off, s[4:7], s39 sc1
s_cmp_eq_u32 s22, 0
s_cbranch_scc1 M_qo2b
s_sub_u32 s22, s22, 1
s_waitcnt vmcnt(0)
v_cmp_ne_u32 vcc, 1, v253
s_cbranch_vccnz M_q2b
M_qo2b:
M_p2b:
buffer_load_dword v253, v7, s[4:7], s38 offen sc1
s_cmp_eq_u32 s22, 0
s_cbranch_scc1 M_po2b
s_sub_u32 s22, s22, 1
s_waitcnt vmcnt(0)
v_cmp_ne_u32 vcc, s36, v253
s_cbranch_vccnz M_p2b
M_po2b:
v_mov_b32 v7, 160560
ds_write_b32 v7, v7
M_nl2b:
v_mov_b32 v7, 160560
M_lsl2b:
ds_read_b32 v253, v7
s_cmp_eq_u32 s22, 0
s_cbranch_scc1 M_lol2b
s_sub_u32 s22, s22, 1
s_waitcnt lgkmcnt(0)
v_cmp_eq_u32 vcc, s82, v253
s_cbranch_vccnz M_lsl2b
M_lol2b:
s_waitcnt lgkmcnt(0)
s_lshr_b32 s37, s18, 1
s_cmp_lg_u32 s37, 1
s_cbranch_scc1 M_cs_77
buffer_load_dword v128, v249, s[4:7], 0 offen sc1
v_add_u32 v249, 6144, v249
buffer_load_dword v129, v249, s[4:7], 0 offen sc1
v_add_u32 v249, 6144, v249
buffer_load_dword v130, v249, s[4:7], 0 offen sc1
v_add_u32 v249, 6144, v249
buffer_load_dword v131, v249, s[4:7], 0 offen sc1
v_add_u32 v249, 6144, v249
buffer_load_dword v132, v249, s[4:7], 0 offen sc1
v_add_u32 v249, 6144, v249
buffer_load_dword v133, v249, s[4:7], 0 offen sc1
v_add_u32 v249, 6144, v249
buffer_load_dword v134, v249, s[4:7], 0 offen sc1
v_add_u32 v249, 6144, v249
buffer_load_dword v135, v249, s[4:7], 0 offen sc1
v_add_u32 v249, 6144, v249
buffer_load_dword v136, v249, s[4:7], 0 offen sc1
v_add_u32 v249, 6144, v249
buffer_load_dword v137, v249, s[4:7], 0 offen sc1
v_add_u32 v249, 6144, v249
buffer_load_dword v138, v249, s[4:7], 0 offen sc1
v_add_u32 v249, 6144, v249
buffer_load_dword v139, v249, s[4:7], 0 offen sc1
v_add_u32 v249, 6144, v249
buffer_load_dword v140, v249, s[4:7], 0 offen sc1
v_add_u32 v249, 6144, v249
buffer_load_dword v141, v249, s[4:7], 0 offen sc1
v_add_u32 v249, 6144, v249
buffer_load_dword v142, v249, s[4:7], 0 offen sc1
v_add_u32 v249, 6144, v249
buffer_load_dword v143, v249, s[4:7], 0 offen sc1
v_add_u32 v249, 6144, v249
buffer_load_dword v144, v249, s[4:7], 0 offen sc1
v_add_u32 v249, 6144, v249
buffer_load_dword v145, v249, s[4:7], 0 offen sc1
v_add_u32 v249, 6144, v249
buffer_load_dword v146, v249, s[4:7], 0 offen sc1
v_add_u32 v249, 6144, v249
buffer_load_dword v147, v249, s[4:7], 0 offen sc1
v_add_u32 v249, 6144, v249
s_waitcnt vmcnt(0)
v_add_f32 v128, v128, v129
v_add_f32 v128, v128, v130
v_add_f32 v128, v128, v131
v_add_f32 v128, v128, v132
v_add_f32 v128, v128, v133
v_add_f32 v128, v128, v134
v_add_f32 v128, v128, v135
v_add_f32 v128, v128, v136
v_add_f32 v128, v128, v137
v_add_f32 v128, v128, v138
v_add_f32 v128, v128, v139
v_add_f32 v128, v128, v140
v_add_f32 v128, v128, v141
v_add_f32 v128, v128, v142
v_add_f32 v128, v128, v143
v_add_f32 v128, v128, v144
v_add_f32 v128, v128, v145
v_add_f32 v128, v128, v146
v_add_f32 v128, v128, v147
ds_write_b32 v254, v128
s_waitcnt lgkmcnt(0)
M_cs_77:
s_add_u32 s43, s61, 0
s_add_u32 s40, s44, 102400
s_mov_b32 s41, 6
M_ld_78:
s_mov_b32 m0, s40
s_add_u32 s40, s40, 4096
s_cmp_ge_u32 s40, 159744
s_cselect_b32 s42, 159744, 0
s_sub_u32 s40, s40, s42
s_waitcnt vmcnt(7)
buffer_load_dwordx4 v1, s[4:7], s43 offen sc1 lds
s_add_u32 s43, s43, 4096
s_sub_u32 s41, s41, 1
s_cmp_lg_u32 s41, 0
s_cbranch_scc1 M_ld_78
s_add_u32 s43, s61, 24576
s_add_u32 s40, s44, 126976
s_mov_b32 s41, 5
M_ld_79:
s_mov_b32 m0, s40
s_add_u32 s40, s40, 4096
s_cmp_ge_u32 s40, 159744
s_cselect_b32 s42, 159744, 0
s_sub_u32 s40, s40, s42
s_waitcnt vmcnt(7)
buffer_load_dwordx4 v1, s[4:7], s43 offen sc1 lds
s_add_u32 s43, s43, 4096
s_sub_u32 s41, s41, 1
s_cmp_lg_u32 s41, 0
s_cbranch_scc1 M_ld_79
s_waitcnt vmcnt(5)
ds_read_b128 v[108:111], v5 offset:36864
ds_read_b128 v[112:115], v5 offset:40960
ds_read_b128 v[116:119], v5 offset:45056
ds_read_b128 v[120:123], v5 offset:49152
ds_read_b128 v[124:127], v5 offset:53248
ds_read_b128 v[128:131], v5 offset:57344
s_waitcnt lgkmcnt(0)
ds_read_b32 v253, v252 offset:16
s_waitcnt lgkmcnt(0)
v_readfirstlane_b32 s34, v253
s_nop 0
s_sub_u32 s35, s34, 0x1010101
s_and_b32 s35, s35, s82
s_cmp_eq_u32 s35, s82
s_cbranch_scc1 M_go_80
s_waitcnt vmcnt(0)
M_fs_81:
ds_read_b32 v253, v252 offset:16
s_cmp_eq_u32 s22, 0
s_cbranch_scc1 M_go_80
s_sub_u32 s22, s22, 1
s_waitcnt lgkmcnt(0)
v_readfirstlane_b32 s34, v253
s_nop 0
s_sub_u32 s35, s34, 0x1010101
s_and_b32 s35, s35, s82
s_cmp_eq_u32 s35, s82
s_cbranch_scc1 M_go_80

s_branch M_fs_81
M_go_80:
s_add_u32 s43, s61, 45056
s_add_u32 s40, s44, 147456
s_mov_b32 s41, 3
M_ld_82:
s_mov_b32 m0, s40
s_add_u32 s40, s40, 4096
s_cmp_ge_u32 s40, 159744
s_cselect_b32 s42, 159744, 0
s_sub_u32 s40, s40, s42
s_waitcnt vmcnt(7)
buffer_load_dwordx4 v1, s[4:7], s43 offen sc1 lds
s_add_u32 s43, s43, 4096
s_sub_u32 s41, s41, 1
s_cmp_lg_u32 s41, 0
s_cbranch_scc1 M_ld_82
s_waitcnt vmcnt(3)
ds_read_b128 v[132:135], v5 offset:61440
ds_read_b128 v[136:139], v6 offset:0
ds_read_b128 v[140:143], v6 offset:4096
ds_read_b128 v[144:147], v6 offset:8192
ds_read_b128 v[148:151], v6 offset:12288
s_waitcnt lgkmcnt(0)
s_sub_u32 s35, s30, 0x1010101
s_and_b32 s35, s35, s82
s_cmp_eq_u32 s35, s82
s_cbranch_scc1 M_go_83
ds_read_b32 v253, v252 offset:0
s_waitcnt lgkmcnt(0)
v_readfirstlane_b32 s30, v253
s_nop 0
s_sub_u32 s35, s30, 0x1010101
s_and_b32 s35, s35, s82
s_cmp_eq_u32 s35, s82
s_cbranch_scc1 M_go_83
s_waitcnt vmcnt(0)
s_cmp_ge_u32 s32, 2
s_cbranch_scc1 M_pb_85
s_mov_b32 s32, 2
ds_add_u32 v250, v251 offset:0
M_pb_85:
M_fs_84:
ds_read_b32 v253, v252 offset:0
s_cmp_eq_u32 s22, 0
s_cbranch_scc1 M_go_83
s_sub_u32 s22, s22, 1
s_waitcnt lgkmcnt(0)
v_readfirstlane_b32 s30, v253
s_nop 0
s_sub_u32 s35, s30, 0x1010101
s_and_b32 s35, s35, s82
s_cmp_eq_u32 s35, s82
s_cbranch_scc1 M_go_83

s_branch M_fs_84
M_go_83:
s_add_u32 s43, s61, 57344
s_add_u32 s40, s44, 0
s_mov_b32 s41, 5
M_ld_86:
s_mov_b32 m0, s40
s_add_u32 s40, s40, 4096
s_cmp_ge_u32 s40, 159744
s_cselect_b32 s42, 159744, 0
s_sub_u32 s40, s40, s42
s_waitcnt vmcnt(3)
buffer_load_dwordx4 v1, s[4:7], s43 offen sc1 lds
s_add_u32 s43, s43, 4096
s_sub_u32 s41, s41, 1
s_cmp_lg_u32 s41, 0
s_cbranch_scc1 M_ld_86
s_waitcnt vmcnt(5)
s_cmp_ge_u32 s32, 2
s_cbranch_scc1 M_pb_87
s_mov_b32 s32, 2
ds_add_u32 v250, v251 offset:0
M_pb_87:
ds_read_b128 v[152:155], v6 offset:16384
ds_read_b128 v[156:159], v6 offset:20480
ds_read_b128 v[160:163], v6 offset:24576
s_waitcnt lgkmcnt(0)
s_sub_u32 s35, s30, 0x2020202
s_and_b32 s35, s35, s82
s_cmp_eq_u32 s35, s82
s_cbranch_scc1 M_go_88
ds_read_b32 v253, v252 offset:0
s_waitcnt lgkmcnt(0)
v_readfirstlane_b32 s30, v253
s_nop 0
s_sub_u32 s35, s30, 0x2020202
s_and_b32 s35, s35, s82
s_cmp_eq_u32 s35, s82
s_cbranch_scc1 M_go_88
s_waitcnt vmcnt(0)
M_fs_89:
ds_read_b32 v253, v252 offset:0
s_cmp_eq_u32 s22, 0
s_cbranch_scc1 M_go_88
s_sub_u32 s22, s22, 1
s_waitcnt lgkmcnt(0)
v_readfirstlane_b32 s30, v253
s_nop 0
s_sub_u32 s35, s30, 0x2020202
s_and_b32 s35, s35, s82
s_cmp_eq_u32 s35, s82
s_cbranch_scc1 M_go_88

s_branch M_fs_89
M_go_88:
s_add_u32 s43, s61, 77824
s_add_u32 s40, s44, 20480
s_mov_b32 s41, 5
M_ld_90:
s_mov_b32 m0, s40
s_add_u32 s40, s40, 4096
s_cmp_ge_u32 s40, 159744
s_cselect_b32 s42, 159744, 0
s_sub_u32 s40, s40, s42
s_waitcnt vmcnt(3)
buffer_load_dwordx4 v1, s[4:7], s43 offen sc1 lds
s_add_u32 s43, s43, 4096
s_sub_u32 s41, s41, 1
s_cmp_lg_u32 s41, 0
s_cbranch_scc1 M_ld_90
s_waitcnt vmcnt(5)
s_sub_u32 s35, s30, 0x3030303
s_and_b32 s35, s35, s82
s_cmp_eq_u32 s35, s82
s_cbranch_scc1 M_go_91
ds_read_b32 v253, v252 offset:0
s_waitcnt lgkmcnt(0)
v_readfirstlane_b32 s30, v253
s_nop 0
s_sub_u32 s35, s30, 0x3030303
s_and_b32 s35, s35, s82
s_cmp_eq_u32 s35, s82
s_cbranch_scc1 M_go_91
s_waitcnt vmcnt(0)
M_fs_92:
ds_read_b32 v253, v252 offset:0
s_cmp_eq_u32 s22, 0
s_cbranch_scc1 M_go_91
s_sub_u32 s22, s22, 1
s_waitcnt lgkmcnt(0)
v_readfirstlane_b32 s30, v253
s_nop 0
s_sub_u32 s35, s30, 0x3030303
s_and_b32 s35, s35, s82
s_cmp_eq_u32 s35, s82
s_cbranch_scc1 M_go_91

s_branch M_fs_92
M_go_91:
s_add_u32 s43, s61, 98304
s_add_u32 s40, s44, 40960
s_mov_b32 s41, 1
M_ld_93:
s_mov_b32 m0, s40
s_add_u32 s40, s40, 4096
s_cmp_ge_u32 s40, 159744
s_cselect_b32 s42, 159744, 0
s_sub_u32 s40, s40, s42
s_waitcnt vmcnt(3)
buffer_load_dwordx4 v1, s[4:7], s43 offen sc1 lds
s_add_u32 s43, s43, 4096
s_sub_u32 s41, s41, 1
s_cmp_lg_u32 s41, 0
s_cbranch_scc1 M_ld_93
s_waitcnt vmcnt(1)
s_sub_u32 s35, s30, 0x4040404
s_and_b32 s35, s35, s82
s_cmp_eq_u32 s35, s82
s_cbranch_scc1 M_go_94
ds_read_b32 v253, v252 offset:0
s_waitcnt lgkmcnt(0)
v_readfirstlane_b32 s30, v253
s_nop 0
s_sub_u32 s35, s30, 0x4040404
s_and_b32 s35, s35, s82
s_cmp_eq_u32 s35, s82
s_cbranch_scc1 M_go_94
s_waitcnt vmcnt(0)
s_cmp_ge_u32 s32, 3
s_cbranch_scc1 M_pb_96
s_mov_b32 s32, 3
ds_add_u32 v250, v251 offset:0
M_pb_96:
M_fs_95:
ds_read_b32 v253, v252 offset:0
s_cmp_eq_u32 s22, 0
s_cbranch_scc1 M_go_94
s_sub_u32 s22, s22, 1
s_waitcnt lgkmcnt(0)
v_readfirstlane_b32 s30, v253
s_nop 0
s_sub_u32 s35, s30, 0x4040404
s_and_b32 s35, s35, s82
s_cmp_eq_u32 s35, s82
s_cbranch_scc1 M_go_94

s_branch M_fs_95
M_go_94:
s_add_u32 s43, s62, 0
s_add_u32 s40, s44, 45056
s_mov_b32 s41, 5
M_ld_97:
s_mov_b32 m0, s40
s_add_u32 s40, s40, 4096
s_cmp_ge_u32 s40, 159744
s_cselect_b32 s42, 159744, 0
s_sub_u32 s40, s40, s42
s_waitcnt vmcnt(3)
buffer_load_dwordx4 v1, s[4:7], s43 offen sc1 lds
s_add_u32 s43, s43, 4096
s_sub_u32 s41, s41, 1
s_cmp_lg_u32 s41, 0
s_cbranch_scc1 M_ld_97
s_waitcnt vmcnt(5)
s_cmp_ge_u32 s32, 3
s_cbranch_scc1 M_pb_98
s_mov_b32 s32, 3
ds_add_u32 v250, v251 offset:0
M_pb_98:
s_sub_u32 s35, s30, 0x5050505
s_and_b32 s35, s35, s82
s_cmp_eq_u32 s35, s82
s_cbranch_scc1 M_go_99
ds_read_b32 v253, v252 offset:0
s_waitcnt lgkmcnt(0)
v_readfirstlane_b32 s30, v253
s_nop 0
s_sub_u32 s35, s30, 0x5050505
s_and_b32 s35, s35, s82
s_cmp_eq_u32 s35, s82
s_cbranch_scc1 M_go_99
s_waitcnt vmcnt(0)
M_fs_100:
ds_read_b32 v253, v252 offset:0
s_cmp_eq_u32 s22, 0
s_cbranch_scc1 M_go_99
s_sub_u32 s22, s22, 1
s_waitcnt lgkmcnt(0)
v_readfirstlane_b32 s30, v253
s_nop 0
s_sub_u32 s35, s30, 0x5050505
s_and_b32 s35, s35, s82
s_cmp_eq_u32 s35, s82
s_cbranch_scc1 M_go_99

s_branch M_fs_100
M_go_99:
s_add_u32 s43, s62, 20480
s_add_u32 s40, s44, 65536
s_mov_b32 s41, 5
M_ld_101:
s_mov_b32 m0, s40
s_add_u32 s40, s40, 4096
s_cmp_ge_u32 s40, 159744
s_cselect_b32 s42, 159744, 0
s_sub_u32 s40, s40, s42
s_waitcnt vmcnt(3)
buffer_load_dwordx4 v1, s[4:7], s43 offen sc1 lds
s_add_u32 s43, s43, 4096
s_sub_u32 s41, s41, 1
s_cmp_lg_u32 s41, 0
s_cbranch_scc1 M_ld_101
s_waitcnt vmcnt(5)
ds_read_b128 v[164:167], v4 offset:45056
ds_read_b128 v[168:171], v4 offset:49152
ds_read_b128 v[172:175], v4 offset:53248
ds_read_b128 v[176:179], v4 offset:57344
ds_read_b128 v[180:183], v4 offset:61440
s_waitcnt lgkmcnt(0)
s_add_u32 s43, s62, 40960
s_add_u32 s40, s44, 86016
s_mov_b32 s41, 4
M_ld_102:
s_mov_b32 m0, s40
s_add_u32 s40, s40, 4096
s_cmp_ge_u32 s40, 159744
s_cselect_b32 s42, 159744, 0
s_sub_u32 s40, s40, s42
s_waitcnt vmcnt(3)
buffer_load_dwordx4 v1, s[4:7], s43 offen sc1 lds
s_add_u32 s43, s43, 4096
s_sub_u32 s41, s41, 1
s_cmp_lg_u32 s41, 0
s_cbranch_scc1 M_ld_102
s_waitcnt vmcnt(4)
ds_read_b128 v[184:187], v5 offset:0
ds_read_b128 v[188:191], v5 offset:4096
ds_read_b128 v[192:195], v5 offset:8192
ds_read_b128 v[196:199], v5 offset:12288
ds_read_b128 v[200:203], v5 offset:16384
s_waitcnt lgkmcnt(0)
s_sub_u32 s35, s30, 0x6060606
s_and_b32 s35, s35, s82
s_cmp_eq_u32 s35, s82
s_cbranch_scc1 M_go_103
ds_read_b32 v253, v252 offset:0
s_waitcnt lgkmcnt(0)
v_readfirstlane_b32 s30, v253
s_nop 0
s_sub_u32 s35, s30, 0x6060606
s_and_b32 s35, s35, s82
s_cmp_eq_u32 s35, s82
s_cbranch_scc1 M_go_103
s_waitcnt vmcnt(0)
s_cmp_ge_u32 s32, 4
s_cbranch_scc1 M_pb_105
s_mov_b32 s32, 4
ds_add_u32 v250, v251 offset:0
M_pb_105:
M_fs_104:
ds_read_b32 v253, v252 offset:0
s_cmp_eq_u32 s22, 0
s_cbranch_scc1 M_go_103
s_sub_u32 s22, s22, 1
s_waitcnt lgkmcnt(0)
v_readfirstlane_b32 s30, v253
s_nop 0
s_sub_u32 s35, s30, 0x6060606
s_and_b32 s35, s35, s82
s_cmp_eq_u32 s35, s82
s_cbranch_scc1 M_go_103

s_branch M_fs_104
M_go_103:
s_add_u32 s43, s62, 57344
s_add_u32 s40, s44, 102400
s_mov_b32 s41, 5
M_ld_106:
s_mov_b32 m0, s40
s_add_u32 s40, s40, 4096
s_cmp_ge_u32 s40, 159744
s_cselect_b32 s42, 159744, 0
s_sub_u32 s40, s40, s42
s_waitcnt vmcnt(5)
buffer_load_dwordx4 v1, s[4:7], s43 offen sc1 lds
s_add_u32 s43, s43, 4096
s_sub_u32 s41, s41, 1
s_cmp_lg_u32 s41, 0
s_cbranch_scc1 M_ld_106
s_waitcnt vmcnt(5)
s_cmp_ge_u32 s32, 4
s_cbranch_scc1 M_pb_107
s_mov_b32 s32, 4
ds_add_u32 v250, v251 offset:0
M_pb_107:
ds_read_b128 v[204:207], v5 offset:20480
ds_read_b128 v[208:211], v5 offset:24576
ds_read_b128 v[212:215], v5 offset:28672
ds_read_b128 v[216:219], v5 offset:32768
s_waitcnt lgkmcnt(0)
s_add_u32 s43, s62, 77824
s_add_u32 s40, s44, 122880
s_mov_b32 s41, 2
M_ld_108:
s_mov_b32 m0, s40
s_add_u32 s40, s40, 4096
s_cmp_ge_u32 s40, 159744
s_cselect_b32 s42, 159744, 0
s_sub_u32 s40, s40, s42
s_waitcnt vmcnt(5)
buffer_load_dwordx4 v1, s[4:7], s43 offen sc1 lds
s_add_u32 s43, s43, 4096
s_sub_u32 s41, s41, 1
s_cmp_lg_u32 s41, 0
s_cbranch_scc1 M_ld_108
s_waitcnt vmcnt(2)
ds_read_b128 v[220:223], v5 offset:36864
ds_read_b128 v[224:227], v5 offset:40960
ds_read_b128 v[228:231], v5 offset:45056
ds_read_b128 v[232:235], v5 offset:49152
ds_read_b128 v[236:239], v5 offset:53248
s_waitcnt lgkmcnt(0)
s_sub_u32 s35, s30, 0x7070707
s_and_b32 s35, s35, s82
s_cmp_eq_u32 s35, s82
s_cbranch_scc1 M_go_109
ds_read_b32 v253, v252 offset:0
s_waitcnt lgkmcnt(0)
v_readfirstlane_b32 s30, v253
s_nop 0
s_sub_u32 s35, s30, 0x7070707
s_and_b32 s35, s35, s82
s_cmp_eq_u32 s35, s82
s_cbranch_scc1 M_go_109
s_waitcnt vmcnt(0)
s_cmp_ge_u32 s32, 5
s_cbranch_scc1 M_pb_111
s_mov_b32 s32, 5
ds_add_u32 v250, v251 offset:0
M_pb_111:
M_fs_110:
ds_read_b32 v253, v252 offset:0
s_cmp_eq_u32 s22, 0
s_cbranch_scc1 M_go_109
s_sub_u32 s22, s22, 1
s_waitcnt lgkmcnt(0)
v_readfirstlane_b32 s30, v253
s_nop 0
s_sub_u32 s35, s30, 0x7070707
s_and_b32 s35, s35, s82
s_cmp_eq_u32 s35, s82
s_cbranch_scc1 M_go_109

s_branch M_fs_110
M_go_109:
s_add_u32 s43, s62, 86016
s_add_u32 s40, s44, 131072
s_mov_b32 s41, 5
M_ld_112:
s_mov_b32 m0, s40
s_add_u32 s40, s40, 4096
s_cmp_ge_u32 s40, 159744
s_cselect_b32 s42, 159744, 0
s_sub_u32 s40, s40, s42
s_waitcnt vmcnt(5)
buffer_load_dwordx4 v1, s[4:7], s43 offen sc1 lds
s_add_u32 s43, s43, 4096
s_sub_u32 s41, s41, 1
s_cmp_lg_u32 s41, 0
s_cbranch_scc1 M_ld_112
s_waitcnt vmcnt(5)
s_cmp_ge_u32 s32, 5
s_cbranch_scc1 M_pb_113
s_mov_b32 s32, 5
ds_add_u32 v250, v251 offset:0
M_pb_113:
ds_read_b128 v[240:243], v5 offset:57344
ds_read_b128 v[244:247], v5 offset:61440
s_waitcnt lgkmcnt(0)
s_add_u32 s43, s62, 106496
s_add_u32 s40, s44, 151552
s_mov_b32 s41, 4
M_ld_114:
s_mov_b32 m0, s40
s_add_u32 s40, s40, 4096
s_cmp_ge_u32 s40, 159744
s_cselect_b32 s42, 159744, 0
s_sub_u32 s40, s40, s42
s_waitcnt vmcnt(5)
buffer_load_dwordx4 v1, s[4:7], s43 offen sc1 lds
s_add_u32 s43, s43, 4096
s_sub_u32 s41, s41, 1
s_cmp_lg_u32 s41, 0
s_cbranch_scc1 M_ld_114
s_waitcnt vmcnt(4)
s_add_u32 s43, s63, 0
s_add_u32 s40, s44, 8192
s_mov_b32 s41, 5
M_ld_115:
s_mov_b32 m0, s40
s_add_u32 s40, s40, 4096
s_cmp_ge_u32 s40, 159744
s_cselect_b32 s42, 159744, 0
s_sub_u32 s40, s40, s42
s_waitcnt vmcnt(7)
buffer_load_dwordx4 v1, s[4:7], s43 offen sc1 lds
s_add_u32 s43, s43, 4096
s_sub_u32 s41, s41, 1
s_cmp_lg_u32 s41, 0
s_cbranch_scc1 M_ld_115
s_waitcnt vmcnt(5)
s_cmp_ge_u32 s32, 6
s_cbranch_scc1 M_pb_116
s_mov_b32 s32, 6
ds_add_u32 v250, v251 offset:0
M_pb_116:
s_add_u32 s43, s63, 20480
s_add_u32 s40, s44, 28672
s_mov_b32 s41, 5
M_ld_117:
s_mov_b32 m0, s40
s_add_u32 s40, s40, 4096
s_cmp_ge_u32 s40, 159744
s_cselect_b32 s42, 159744, 0
s_sub_u32 s40, s40, s42
s_waitcnt vmcnt(7)
buffer_load_dwordx4 v1, s[4:7], s43 offen sc1 lds
s_add_u32 s43, s43, 4096
s_sub_u32 s41, s41, 1
s_cmp_lg_u32 s41, 0
s_cbranch_scc1 M_ld_117
s_waitcnt vmcnt(5)
s_sub_u32 s35, s30, 0x8080808
s_and_b32 s35, s35, s82
s_cmp_eq_u32 s35, s82
s_cbranch_scc1 M_go_118
ds_read_b32 v253, v252 offset:0
s_waitcnt lgkmcnt(0)
v_readfirstlane_b32 s30, v253
s_nop 0
s_sub_u32 s35, s30, 0x8080808
s_and_b32 s35, s35, s82
s_cmp_eq_u32 s35, s82
s_cbranch_scc1 M_go_118
s_waitcnt vmcnt(0)
M_fs_119:
ds_read_b32 v253, v252 offset:0
s_cmp_eq_u32 s22, 0
s_cbranch_scc1 M_go_118
s_sub_u32 s22, s22, 1
s_waitcnt lgkmcnt(0)
v_readfirstlane_b32 s30, v253
s_nop 0
s_sub_u32 s35, s30, 0x8080808
s_and_b32 s35, s35, s82
s_cmp_eq_u32 s35, s82
s_cbranch_scc1 M_go_118

s_branch M_fs_119
M_go_118:
s_add_u32 s43, s63, 40960
s_add_u32 s40, s44, 49152
s_mov_b32 s41, 5
M_ld_120:
s_mov_b32 m0, s40
s_add_u32 s40, s40, 4096
s_cmp_ge_u32 s40, 159744
s_cselect_b32 s42, 159744, 0
s_sub_u32 s40, s40, s42
s_waitcnt vmcnt(7)
buffer_load_dwordx4 v1, s[4:7], s43 offen sc1 lds
s_add_u32 s43, s43, 4096
s_sub_u32 s41, s41, 1
s_cmp_lg_u32 s41, 0
s_cbranch_scc1 M_ld_120
s_waitcnt vmcnt(5)
s_sub_u32 s35, s30, 0x9090909
s_and_b32 s35, s35, s82
s_cmp_eq_u32 s35, s82
s_cbranch_scc1 M_go_121
ds_read_b32 v253, v252 offset:0
s_waitcnt lgkmcnt(0)
v_readfirstlane_b32 s30, v253
s_nop 0
s_sub_u32 s35, s30, 0x9090909
s_and_b32 s35, s35, s82
s_cmp_eq_u32 s35, s82
s_cbranch_scc1 M_go_121
s_waitcnt vmcnt(0)
M_fs_122:
ds_read_b32 v253, v252 offset:0
s_cmp_eq_u32 s22, 0
s_cbranch_scc1 M_go_121
s_sub_u32 s22, s22, 1
s_waitcnt lgkmcnt(0)
v_readfirstlane_b32 s30, v253
s_nop 0
s_sub_u32 s35, s30, 0x9090909
s_and_b32 s35, s35, s82
s_cmp_eq_u32 s35, s82
s_cbranch_scc1 M_go_121

s_branch M_fs_122
M_go_121:
s_add_u32 s43, s63, 61440
s_add_u32 s40, s44, 69632
s_mov_b32 s41, 5
M_ld_123:
s_mov_b32 m0, s40
s_add_u32 s40, s40, 4096
s_cmp_ge_u32 s40, 159744
s_cselect_b32 s42, 159744, 0
s_sub_u32 s40, s40, s42
s_waitcnt vmcnt(7)
buffer_load_dwordx4 v1, s[4:7], s43 offen sc1 lds
s_add_u32 s43, s43, 4096
s_sub_u32 s41, s41, 1
s_cmp_lg_u32 s41, 0
s_cbranch_scc1 M_ld_123
s_waitcnt vmcnt(5)
s_sub_u32 s35, s30, 0xa0a0a0a
s_and_b32 s35, s35, s82
s_cmp_eq_u32 s35, s82
s_cbranch_scc1 M_go_124
ds_read_b32 v253, v252 offset:0
s_waitcnt lgkmcnt(0)
v_readfirstlane_b32 s30, v253
s_nop 0
s_sub_u32 s35, s30, 0xa0a0a0a
s_and_b32 s35, s35, s82
s_cmp_eq_u32 s35, s82
s_cbranch_scc1 M_go_124
s_waitcnt vmcnt(0)
s_cmp_ge_u32 s32, 7
s_cbranch_scc1 M_pb_126
s_mov_b32 s32, 7
ds_add_u32 v250, v251 offset:0
M_pb_126:
M_fs_125:
ds_read_b32 v253, v252 offset:0
s_cmp_eq_u32 s22, 0
s_cbranch_scc1 M_go_124
s_sub_u32 s22, s22, 1
s_waitcnt lgkmcnt(0)
v_readfirstlane_b32 s30, v253
s_nop 0
s_sub_u32 s35, s30, 0xa0a0a0a
s_and_b32 s35, s35, s82
s_cmp_eq_u32 s35, s82
s_cbranch_scc1 M_go_124

s_branch M_fs_125
M_go_124:
s_add_u32 s43, s63, 81920
s_add_u32 s40, s44, 90112
s_mov_b32 s41, 5
M_ld_127:
s_mov_b32 m0, s40
s_add_u32 s40, s40, 4096
s_cmp_ge_u32 s40, 159744
s_cselect_b32 s42, 159744, 0
s_sub_u32 s40, s40, s42
s_waitcnt vmcnt(7)
buffer_load_dwordx4 v1, s[4:7], s43 offen sc1 lds
s_add_u32 s43, s43, 4096
s_sub_u32 s41, s41, 1
s_cmp_lg_u32 s41, 0
s_cbranch_scc1 M_ld_127
s_waitcnt vmcnt(5)
s_cmp_ge_u32 s32, 7
s_cbranch_scc1 M_pb_128
s_mov_b32 s32, 7
ds_add_u32 v250, v251 offset:0
M_pb_128:
s_sub_u32 s35, s30, 0xb0b0b0b
s_and_b32 s35, s35, s82
s_cmp_eq_u32 s35, s82
s_cbranch_scc1 M_go_129
ds_read_b32 v253, v252 offset:0
s_waitcnt lgkmcnt(0)
v_readfirstlane_b32 s30, v253
s_nop 0
s_sub_u32 s35, s30, 0xb0b0b0b
s_and_b32 s35, s35, s82
s_cmp_eq_u32 s35, s82
s_cbranch_scc1 M_go_129
s_waitcnt vmcnt(0)
M_fs_130:
ds_read_b32 v253, v252 offset:0
s_cmp_eq_u32 s22, 0
s_cbranch_scc1 M_go_129
s_sub_u32 s22, s22, 1
s_waitcnt lgkmcnt(0)
v_readfirstlane_b32 s30, v253
s_nop 0
s_sub_u32 s35, s30, 0xb0b0b0b
s_and_b32 s35, s35, s82
s_cmp_eq_u32 s35, s82
s_cbranch_scc1 M_go_129

s_branch M_fs_130
M_go_129:
s_add_u32 s43, s63, 102400
s_add_u32 s40, s44, 110592
s_mov_b32 s41, 5
M_ld_131:
s_mov_b32 m0, s40
s_add_u32 s40, s40, 4096
s_cmp_ge_u32 s40, 159744
s_cselect_b32 s42, 159744, 0
s_sub_u32 s40, s40, s42
s_waitcnt vmcnt(7)
buffer_load_dwordx4 v1, s[4:7], s43 offen sc1 lds
s_add_u32 s43, s43, 4096
s_sub_u32 s41, s41, 1
s_cmp_lg_u32 s41, 0
s_cbranch_scc1 M_ld_131
s_waitcnt vmcnt(5)
buffer_load_dword v7, v3, s[4:7], 0 offen sc1
s_waitcnt vmcnt(1)
s_cmp_ge_u32 s32, 8
s_cbranch_scc1 M_pb_132
s_mov_b32 s32, 8
ds_add_u32 v250, v251 offset:0
M_pb_132:
s_sub_u32 s35, s30, 0xc0c0c0c
s_and_b32 s35, s35, s82
s_cmp_eq_u32 s35, s82
s_cbranch_scc1 M_go_133
M_fs_134:
ds_read_b32 v253, v252 offset:0
s_cmp_eq_u32 s22, 0
s_cbranch_scc1 M_go_133
s_sub_u32 s22, s22, 1
s_waitcnt lgkmcnt(0)
v_readfirstlane_b32 s30, v253
s_nop 0
s_sub_u32 s35, s30, 0xc0c0c0c
s_and_b32 s35, s35, s82
s_cmp_eq_u32 s35, s82
s_cbranch_scc1 M_go_133

s_branch M_fs_134
M_go_133:
s_add_u32 s43, s63, 122880
s_add_u32 s40, s44, 131072
s_mov_b32 s41, 5
M_ld_135:
s_mov_b32 m0, s40
s_add_u32 s40, s40, 4096
s_cmp_ge_u32 s40, 159744
s_cselect_b32 s42, 159744, 0
s_sub_u32 s40, s40, s42
s_waitcnt vmcnt(7)
buffer_load_dwordx4 v1, s[4:7], s43 offen sc1 lds
s_add_u32 s43, s43, 4096
s_sub_u32 s41, s41, 1
s_cmp_lg_u32 s41, 0
s_cbranch_scc1 M_ld_135
s_add_u32 s43, s63, 143360
s_add_u32 s40, s44, 151552
s_mov_b32 s41, 4
M_ld_136:
s_mov_b32 m0, s40
s_add_u32 s40, s40, 4096
s_cmp_ge_u32 s40, 159744
s_cselect_b32 s42, 159744, 0
s_sub_u32 s40, s40, s42
s_waitcnt vmcnt(7)
buffer_load_dwordx4 v1, s[4:7], s43 offen sc1 lds
s_add_u32 s43, s43, 4096
s_sub_u32 s41, s41, 1
s_cmp_lg_u32 s41, 0
s_cbranch_scc1 M_ld_136
s_waitcnt vmcnt(4)
s_sub_u32 s35, s30, 0xe0e0e0e
s_and_b32 s35, s35, s82
s_cmp_eq_u32 s35, s82
s_cbranch_scc1 M_go_137
ds_read_b32 v253, v252 offset:0
s_waitcnt lgkmcnt(0)
v_readfirstlane_b32 s30, v253
s_nop 0
s_sub_u32 s35, s30, 0xe0e0e0e
s_and_b32 s35, s35, s82
s_cmp_eq_u32 s35, s82
s_cbranch_scc1 M_go_137
s_waitcnt vmcnt(0)
s_cmp_ge_u32 s32, 9
s_cbranch_scc1 M_pb_139
s_mov_b32 s32, 9
ds_add_u32 v250, v251 offset:0
M_pb_139:
M_fs_138:
ds_read_b32 v253, v252 offset:0
s_cmp_eq_u32 s22, 0
s_cbranch_scc1 M_go_137
s_sub_u32 s22, s22, 1
s_waitcnt lgkmcnt(0)
v_readfirstlane_b32 s30, v253
s_nop 0
s_sub_u32 s35, s30, 0xe0e0e0e
s_and_b32 s35, s35, s82
s_cmp_eq_u32 s35, s82
s_cbranch_scc1 M_go_137

s_branch M_fs_138
M_go_137:
s_add_u32 s43, s63, 159744
s_add_u32 s40, s44, 8192
s_mov_b32 s41, 5
M_ld_140:
s_mov_b32 m0, s40
s_add_u32 s40, s40, 4096
s_cmp_ge_u32 s40, 159744
s_cselect_b32 s42, 159744, 0
s_sub_u32 s40, s40, s42
s_waitcnt vmcnt(7)
buffer_load_dwordx4 v1, s[4:7], s43 offen sc1 lds
s_add_u32 s43, s43, 4096
s_sub_u32 s41, s41, 1
s_cmp_lg_u32 s41, 0
s_cbranch_scc1 M_ld_140
s_waitcnt vmcnt(5)
s_cmp_ge_u32 s32, 9
s_cbranch_scc1 M_pb_141
s_mov_b32 s32, 9
ds_add_u32 v250, v251 offset:0
M_pb_141:
s_sub_u32 s35, s30, 0x10101010
s_and_b32 s35, s35, s82
s_cmp_eq_u32 s35, s82
s_cbranch_scc1 M_go_142
ds_read_b32 v253, v252 offset:0
s_waitcnt lgkmcnt(0)
v_readfirstlane_b32 s30, v253
s_nop 0
s_sub_u32 s35, s30, 0x10101010
s_and_b32 s35, s35, s82
s_cmp_eq_u32 s35, s82
s_cbranch_scc1 M_go_142
s_waitcnt vmcnt(0)
M_fs_143:
ds_read_b32 v253, v252 offset:0
s_cmp_eq_u32 s22, 0
s_cbranch_scc1 M_go_142
s_sub_u32 s22, s22, 1
s_waitcnt lgkmcnt(0)
v_readfirstlane_b32 s30, v253
s_nop 0
s_sub_u32 s35, s30, 0x10101010
s_and_b32 s35, s35, s82
s_cmp_eq_u32 s35, s82
s_cbranch_scc1 M_go_142

s_branch M_fs_143
M_go_142:
s_add_u32 s43, s63, 180224
s_add_u32 s40, s44, 28672
s_mov_b32 s41, 5
M_ld_144:
s_mov_b32 m0, s40
s_add_u32 s40, s40, 4096
s_cmp_ge_u32 s40, 159744
s_cselect_b32 s42, 159744, 0
s_sub_u32 s40, s40, s42
s_waitcnt vmcnt(7)
buffer_load_dwordx4 v1, s[4:7], s43 offen sc1 lds
s_add_u32 s43, s43, 4096
s_sub_u32 s41, s41, 1
s_cmp_lg_u32 s41, 0
s_cbranch_scc1 M_ld_144
s_waitcnt vmcnt(5)
s_sub_u32 s35, s30, 0x11111111
s_and_b32 s35, s35, s82
s_cmp_eq_u32 s35, s82
s_cbranch_scc1 M_go_145
ds_read_b32 v253, v252 offset:0
s_waitcnt lgkmcnt(0)
v_readfirstlane_b32 s30, v253
s_nop 0
s_sub_u32 s35, s30, 0x11111111
s_and_b32 s35, s35, s82
s_cmp_eq_u32 s35, s82
s_cbranch_scc1 M_go_145
s_waitcnt vmcnt(0)
M_fs_146:
ds_read_b32 v253, v252 offset:0
s_cmp_eq_u32 s22, 0
s_cbranch_scc1 M_go_145
s_sub_u32 s22, s22, 1
s_waitcnt lgkmcnt(0)
v_readfirstlane_b32 s30, v253
s_nop 0
s_sub_u32 s35, s30, 0x11111111
s_and_b32 s35, s35, s82
s_cmp_eq_u32 s35, s82
s_cbranch_scc1 M_go_145

s_branch M_fs_146
M_go_145:
s_add_u32 s43, s63, 200704
s_add_u32 s40, s44, 49152
s_mov_b32 s41, 1
M_ld_147:
s_mov_b32 m0, s40
s_add_u32 s40, s40, 4096
s_cmp_ge_u32 s40, 159744
s_cselect_b32 s42, 159744, 0
s_sub_u32 s40, s40, s42
s_waitcnt vmcnt(7)
buffer_load_dwordx4 v1, s[4:7], s43 offen sc1 lds
s_add_u32 s43, s43, 4096
s_sub_u32 s41, s41, 1
s_cmp_lg_u32 s41, 0
s_cbranch_scc1 M_ld_147
s_waitcnt vmcnt(1)
s_sub_u32 s35, s30, 0x13131313
s_and_b32 s35, s35, s82
s_cmp_eq_u32 s35, s82
s_cbranch_scc1 M_go_148
ds_read_b32 v253, v252 offset:0
s_waitcnt lgkmcnt(0)
v_readfirstlane_b32 s30, v253
s_nop 0
s_sub_u32 s35, s30, 0x13131313
s_and_b32 s35, s35, s82
s_cmp_eq_u32 s35, s82
s_cbranch_scc1 M_go_148
s_waitcnt vmcnt(0)
s_cmp_ge_u32 s32, 10
s_cbranch_scc1 M_pb_150
s_mov_b32 s32, 10
ds_add_u32 v250, v251 offset:0
M_pb_150:
M_fs_149:
ds_read_b32 v253, v252 offset:0
s_cmp_eq_u32 s22, 0
s_cbranch_scc1 M_go_148
s_sub_u32 s22, s22, 1
s_waitcnt lgkmcnt(0)
v_readfirstlane_b32 s30, v253
s_nop 0
s_sub_u32 s35, s30, 0x13131313
s_and_b32 s35, s35, s82
s_cmp_eq_u32 s35, s82
s_cbranch_scc1 M_go_148

s_branch M_fs_149
M_go_148:
s_add_u32 s43, s63, 204800
s_add_u32 s40, s44, 53248
s_mov_b32 s41, 5
M_ld_151:
s_mov_b32 m0, s40
s_add_u32 s40, s40, 4096
s_cmp_ge_u32 s40, 159744
s_cselect_b32 s42, 159744, 0
s_sub_u32 s40, s40, s42
s_waitcnt vmcnt(7)
buffer_load_dwordx4 v1, s[4:7], s43 offen sc1 lds
s_add_u32 s43, s43, 4096
s_sub_u32 s41, s41, 1
s_cmp_lg_u32 s41, 0
s_cbranch_scc1 M_ld_151
s_waitcnt vmcnt(5)
s_cmp_ge_u32 s32, 10
s_cbranch_scc1 M_pb_152
s_mov_b32 s32, 10
ds_add_u32 v250, v251 offset:0
M_pb_152:
s_sub_u32 s35, s30, 0x15151515
s_and_b32 s35, s35, s82
s_cmp_eq_u32 s35, s82
s_cbranch_scc1 M_go_153
ds_read_b32 v253, v252 offset:0
s_waitcnt lgkmcnt(0)
v_readfirstlane_b32 s30, v253
s_nop 0
s_sub_u32 s35, s30, 0x15151515
s_and_b32 s35, s35, s82
s_cmp_eq_u32 s35, s82
s_cbranch_scc1 M_go_153
s_waitcnt vmcnt(0)
M_fs_154:
ds_read_b32 v253, v252 offset:0
s_cmp_eq_u32 s22, 0
s_cbranch_scc1 M_go_153
s_sub_u32 s22, s22, 1
s_waitcnt lgkmcnt(0)
v_readfirstlane_b32 s30, v253
s_nop 0
s_sub_u32 s35, s30, 0x15151515
s_and_b32 s35, s35, s82
s_cmp_eq_u32 s35, s82
s_cbranch_scc1 M_go_153

s_branch M_fs_154
M_go_153:
s_add_u32 s43, s63, 225280
s_add_u32 s40, s44, 73728
s_mov_b32 s41, 5
M_ld_155:
s_mov_b32 m0, s40
s_add_u32 s40, s40, 4096
s_cmp_ge_u32 s40, 159744
s_cselect_b32 s42, 159744, 0
s_sub_u32 s40, s40, s42
s_waitcnt vmcnt(7)
buffer_load_dwordx4 v1, s[4:7], s43 offen sc1 lds
s_add_u32 s43, s43, 4096
s_sub_u32 s41, s41, 1
s_cmp_lg_u32 s41, 0
s_cbranch_scc1 M_ld_155
s_waitcnt vmcnt(5)
s_sub_u32 s35, s30, 0x16161616
s_and_b32 s35, s35, s82
s_cmp_eq_u32 s35, s82
s_cbranch_scc1 M_go_156
ds_read_b32 v253, v252 offset:0
s_waitcnt lgkmcnt(0)
v_readfirstlane_b32 s30, v253
s_nop 0
s_sub_u32 s35, s30, 0x16161616
s_and_b32 s35, s35, s82
s_cmp_eq_u32 s35, s82
s_cbranch_scc1 M_go_156
s_waitcnt vmcnt(0)
s_cmp_ge_u32 s32, 11
s_cbranch_scc1 M_pb_158
s_mov_b32 s32, 11
ds_add_u32 v250, v251 offset:0
M_pb_158:
M_fs_157:
ds_read_b32 v253, v252 offset:0
s_cmp_eq_u32 s22, 0
s_cbranch_scc1 M_go_156
s_sub_u32 s22, s22, 1
s_waitcnt lgkmcnt(0)
v_readfirstlane_b32 s30, v253
s_nop 0
s_sub_u32 s35, s30, 0x16161616
s_and_b32 s35, s35, s82
s_cmp_eq_u32 s35, s82
s_cbranch_scc1 M_go_156

s_branch M_fs_157
M_go_156:
s_waitcnt vmcnt(0)
s_cmp_ge_u32 s32, 11
s_cbranch_scc1 M_pb_159
s_mov_b32 s32, 11
ds_add_u32 v250, v251 offset:0
M_pb_159:
s_waitcnt vmcnt(0)
ds_write_b128 v4, v[8:11] offset:0
ds_write_b128 v4, v[12:15] offset:4096
ds_write_b128 v4, v[16:19] offset:8192
ds_write_b128 v4, v[20:23] offset:12288
ds_write_b128 v4, v[24:27] offset:16384
ds_write_b128 v4, v[28:31] offset:20480
ds_write_b128 v4, v[32:35] offset:24576
ds_write_b128 v4, v[36:39] offset:28672
ds_write_b128 v4, v[40:43] offset:32768
ds_write_b128 v4, v[44:47] offset:36864
s_waitcnt lgkmcnt(0)
s_waitcnt vmcnt(0)
ds_write_b128 v4, v[48:51] offset:40960
ds_write_b128 v4, v[52:55] offset:45056
ds_write_b128 v4, v[56:59] offset:49152
ds_write_b128 v4, v[60:63] offset:53248
ds_write_b128 v4, v[64:67] offset:57344
ds_write_b128 v4, v[68:71] offset:61440
ds_write_b128 v5, v[72:75] offset:0
ds_write_b128 v5, v[76:79] offset:4096
ds_write_b128 v5, v[80:83] offset:8192
ds_write_b128 v5, v[84:87] offset:12288
s_waitcnt lgkmcnt(0)
s_waitcnt vmcnt(0)
ds_write_b128 v5, v[88:91] offset:16384
ds_write_b128 v5, v[92:95] offset:20480
ds_write_b128 v5, v[96:99] offset:24576
ds_write_b128 v5, v[100:103] offset:28672
ds_write_b128 v5, v[104:107] offset:32768
s_waitcnt lgkmcnt(0)
s_cmp_ge_u32 s33, 1
s_cbranch_scc1 M_pb_160
s_mov_b32 s33, 1
ds_add_u32 v250, v251 offset:4
M_pb_160:
s_waitcnt vmcnt(0)
ds_write_b128 v5, v[108:111] offset:36864
ds_write_b128 v5, v[112:115] offset:40960
ds_write_b128 v5, v[116:119] offset:45056
ds_write_b128 v5, v[120:123] offset:49152
ds_write_b128 v5, v[124:127] offset:53248
ds_write_b128 v5, v[128:131] offset:57344
ds_write_b128 v5, v[132:135] offset:61440
ds_write_b128 v6, v[136:139] offset:0
ds_write_b128 v6, v[140:143] offset:4096
ds_write_b128 v6, v[144:147] offset:8192
s_waitcnt lgkmcnt(0)
s_waitcnt vmcnt(0)
ds_write_b128 v6, v[148:151] offset:12288
ds_write_b128 v6, v[152:155] offset:16384
ds_write_b128 v6, v[156:159] offset:20480
ds_write_b128 v6, v[160:163] offset:24576
s_waitcnt lgkmcnt(0)
s_cmp_ge_u32 s33, 2
s_cbranch_scc1 M_pb_161
s_mov_b32 s33, 2
ds_add_u32 v250, v251 offset:4
M_pb_161:
s_sub_u32 s35, s31, 0x1010101
s_and_b32 s35, s35, s82
s_cmp_eq_u32 s35, s82
s_cbranch_scc1 M_go_162
M_fs_163:
ds_read_b32 v253, v252 offset:4
s_cmp_eq_u32 s22, 0
s_cbranch_scc1 M_go_162
s_sub_u32 s22, s22, 1
s_waitcnt lgkmcnt(0)
v_readfirstlane_b32 s31, v253
s_nop 0
s_sub_u32 s35, s31, 0x1010101
s_and_b32 s35, s35, s82
s_cmp_eq_u32 s35, s82
s_cbranch_scc1 M_go_162

s_branch M_fs_163
M_go_162:
s_add_u32 s43, s61, 57344
s_add_u32 s40, s44, 0
s_mov_b32 s41, 5
M_ld_164:
s_mov_b32 m0, s40
s_add_u32 s40, s40, 4096
s_cmp_ge_u32 s40, 159744
s_cselect_b32 s42, 159744, 0
s_sub_u32 s40, s40, s42
s_waitcnt vmcnt(3)
buffer_load_dwordx4 v1, s[4:7], s43 offen sc1 lds
s_add_u32 s43, s43, 4096
s_sub_u32 s41, s41, 1
s_cmp_lg_u32 s41, 0
s_cbranch_scc1 M_ld_164
s_sub_u32 s35, s31, 0x2020202
s_and_b32 s35, s35, s82
s_cmp_eq_u32 s35, s82
s_cbranch_scc1 M_go_165
ds_read_b32 v253, v252 offset:4
s_waitcnt lgkmcnt(0)
v_readfirstlane_b32 s31, v253
s_nop 0
s_sub_u32 s35, s31, 0x2020202
s_and_b32 s35, s35, s82
s_cmp_eq_u32 s35, s82
s_cbranch_scc1 M_go_165
s_waitcnt vmcnt(0)
M_fs_166:
ds_read_b32 v253, v252 offset:4
s_cmp_eq_u32 s22, 0
s_cbranch_scc1 M_go_165
s_sub_u32 s22, s22, 1
s_waitcnt lgkmcnt(0)
v_readfirstlane_b32 s31, v253
s_nop 0
s_sub_u32 s35, s31, 0x2020202
s_and_b32 s35, s35, s82
s_cmp_eq_u32 s35, s82
s_cbranch_scc1 M_go_165

s_branch M_fs_166
M_go_165:
s_add_u32 s43, s61, 77824
s_add_u32 s40, s44, 20480
s_mov_b32 s41, 5
M_ld_167:
s_mov_b32 m0, s40
s_add_u32 s40, s40, 4096
s_cmp_ge_u32 s40, 159744
s_cselect_b32 s42, 159744, 0
s_sub_u32 s40, s40, s42
s_waitcnt vmcnt(3)
buffer_load_dwordx4 v1, s[4:7], s43 offen sc1 lds
s_add_u32 s43, s43, 4096
s_sub_u32 s41, s41, 1
s_cmp_lg_u32 s41, 0
s_cbranch_scc1 M_ld_167
s_waitcnt vmcnt(5)
s_sub_u32 s35, s31, 0x3030303
s_and_b32 s35, s35, s82
s_cmp_eq_u32 s35, s82
s_cbranch_scc1 M_go_168
ds_read_b32 v253, v252 offset:4
s_waitcnt lgkmcnt(0)
v_readfirstlane_b32 s31, v253
s_nop 0
s_sub_u32 s35, s31, 0x3030303
s_and_b32 s35, s35, s82
s_cmp_eq_u32 s35, s82
s_cbranch_scc1 M_go_168
s_waitcnt vmcnt(0)
M_fs_169:
ds_read_b32 v253, v252 offset:4
s_cmp_eq_u32 s22, 0
s_cbranch_scc1 M_go_168
s_sub_u32 s22, s22, 1
s_waitcnt lgkmcnt(0)
v_readfirstlane_b32 s31, v253
s_nop 0
s_sub_u32 s35, s31, 0x3030303
s_and_b32 s35, s35, s82
s_cmp_eq_u32 s35, s82
s_cbranch_scc1 M_go_168

s_branch M_fs_169
M_go_168:
s_add_u32 s43, s61, 98304
s_add_u32 s40, s44, 40960
s_mov_b32 s41, 1
M_ld_170:
s_mov_b32 m0, s40
s_add_u32 s40, s40, 4096
s_cmp_ge_u32 s40, 159744
s_cselect_b32 s42, 159744, 0
s_sub_u32 s40, s40, s42
s_waitcnt vmcnt(3)
buffer_load_dwordx4 v1, s[4:7], s43 offen sc1 lds
s_add_u32 s43, s43, 4096
s_sub_u32 s41, s41, 1
s_cmp_lg_u32 s41, 0
s_cbranch_scc1 M_ld_170
s_waitcnt vmcnt(1)
s_sub_u32 s35, s31, 0x4040404
s_and_b32 s35, s35, s82
s_cmp_eq_u32 s35, s82
s_cbranch_scc1 M_go_171
ds_read_b32 v253, v252 offset:4
s_waitcnt lgkmcnt(0)
v_readfirstlane_b32 s31, v253
s_nop 0
s_sub_u32 s35, s31, 0x4040404
s_and_b32 s35, s35, s82
s_cmp_eq_u32 s35, s82
s_cbranch_scc1 M_go_171
s_waitcnt vmcnt(0)
s_cmp_ge_u32 s33, 3
s_cbranch_scc1 M_pb_173
s_mov_b32 s33, 3
ds_add_u32 v250, v251 offset:4
M_pb_173:
M_fs_172:
ds_read_b32 v253, v252 offset:4
s_cmp_eq_u32 s22, 0
s_cbranch_scc1 M_go_171
s_sub_u32 s22, s22, 1
s_waitcnt lgkmcnt(0)
v_readfirstlane_b32 s31, v253
s_nop 0
s_sub_u32 s35, s31, 0x4040404
s_and_b32 s35, s35, s82
s_cmp_eq_u32 s35, s82
s_cbranch_scc1 M_go_171

s_branch M_fs_172
M_go_171:
s_waitcnt vmcnt(0)
s_cmp_ge_u32 s33, 3
s_cbranch_scc1 M_pb_174
s_mov_b32 s33, 3
ds_add_u32 v250, v251 offset:4
M_pb_174:
s_waitcnt vmcnt(0)
ds_write_b128 v4, v[164:167] offset:45056
ds_write_b128 v4, v[168:171] offset:49152
ds_write_b128 v4, v[172:175] offset:53248
ds_write_b128 v4, v[176:179] offset:57344
ds_write_b128 v4, v[180:183] offset:61440
s_waitcnt lgkmcnt(0)
s_sub_u32 s35, s31, 0x5050505
s_and_b32 s35, s35, s82
s_cmp_eq_u32 s35, s82
s_cbranch_scc1 M_go_175
M_fs_176:
ds_read_b32 v253, v252 offset:4
s_cmp_eq_u32 s22, 0
s_cbranch_scc1 M_go_175
s_sub_u32 s22, s22, 1
s_waitcnt lgkmcnt(0)
v_readfirstlane_b32 s31, v253
s_nop 0
s_sub_u32 s35, s31, 0x5050505
s_and_b32 s35, s35, s82
s_cmp_eq_u32 s35, s82
s_cbranch_scc1 M_go_175

s_branch M_fs_176
M_go_175:
s_waitcnt vmcnt(0)
ds_write_b128 v5, v[184:187] offset:0
ds_write_b128 v5, v[188:191] offset:4096
ds_write_b128 v5, v[192:195] offset:8192
ds_write_b128 v5, v[196:199] offset:12288
ds_write_b128 v5, v[200:203] offset:16384
s_waitcnt lgkmcnt(0)
s_waitcnt vmcnt(0)
ds_write_b128 v5, v[204:207] offset:20480
ds_write_b128 v5, v[208:211] offset:24576
ds_write_b128 v5, v[212:215] offset:28672
ds_write_b128 v5, v[216:219] offset:32768
s_waitcnt lgkmcnt(0)
s_cmp_ge_u32 s33, 4
s_cbranch_scc1 M_pb_177
s_mov_b32 s33, 4
ds_add_u32 v250, v251 offset:4
M_pb_177:
s_sub_u32 s35, s31, 0x6060606
s_and_b32 s35, s35, s82
s_cmp_eq_u32 s35, s82
s_cbranch_scc1 M_go_178
M_fs_179:
ds_read_b32 v253, v252 offset:4
s_cmp_eq_u32 s22, 0
s_cbranch_scc1 M_go_178
s_sub_u32 s22, s22, 1
s_waitcnt lgkmcnt(0)
v_readfirstlane_b32 s31, v253
s_nop 0
s_sub_u32 s35, s31, 0x6060606
s_and_b32 s35, s35, s82
s_cmp_eq_u32 s35, s82
s_cbranch_scc1 M_go_178

s_branch M_fs_179
M_go_178:
s_waitcnt vmcnt(0)
ds_write_b128 v5, v[220:223] offset:36864
ds_write_b128 v5, v[224:227] offset:40960
ds_write_b128 v5, v[228:231] offset:45056
ds_write_b128 v5, v[232:235] offset:49152
ds_write_b128 v5, v[236:239] offset:53248
s_waitcnt lgkmcnt(0)
s_waitcnt vmcnt(0)
ds_write_b128 v5, v[240:243] offset:57344
ds_write_b128 v5, v[244:247] offset:61440
s_waitcnt lgkmcnt(0)
s_cmp_ge_u32 s33, 5
s_cbranch_scc1 M_pb_180
s_mov_b32 s33, 5
ds_add_u32 v250, v251 offset:4
M_pb_180:
s_sub_u32 s35, s31, 0x7070707
s_and_b32 s35, s35, s82
s_cmp_eq_u32 s35, s82
s_cbranch_scc1 M_go_181
M_fs_182:
ds_read_b32 v253, v252 offset:4
s_cmp_eq_u32 s22, 0
s_cbranch_scc1 M_go_181
s_sub_u32 s22, s22, 1
s_waitcnt lgkmcnt(0)
v_readfirstlane_b32 s31, v253
s_nop 0
s_sub_u32 s35, s31, 0x7070707
s_and_b32 s35, s35, s82
s_cmp_eq_u32 s35, s82
s_cbranch_scc1 M_go_181

s_branch M_fs_182
M_go_181:
s_add_u32 s43, s62, 86016
s_add_u32 s40, s44, 131072
s_mov_b32 s41, 5
M_ld_183:
s_mov_b32 m0, s40
s_add_u32 s40, s40, 4096
s_cmp_ge_u32 s40, 159744
s_cselect_b32 s42, 159744, 0
s_sub_u32 s40, s40, s42
s_waitcnt vmcnt(5)
buffer_load_dwordx4 v1, s[4:7], s43 offen sc1 lds
s_add_u32 s43, s43, 4096
s_sub_u32 s41, s41, 1
s_cmp_lg_u32 s41, 0
s_cbranch_scc1 M_ld_183
s_add_u32 s43, s62, 106496
s_add_u32 s40, s44, 151552
s_mov_b32 s41, 4
M_ld_184:
s_mov_b32 m0, s40
s_add_u32 s40, s40, 4096
s_cmp_ge_u32 s40, 159744
s_cselect_b32 s42, 159744, 0
s_sub_u32 s40, s40, s42
s_waitcnt vmcnt(5)
buffer_load_dwordx4 v1, s[4:7], s43 offen sc1 lds
s_add_u32 s43, s43, 4096
s_sub_u32 s41, s41, 1
s_cmp_lg_u32 s41, 0
s_cbranch_scc1 M_ld_184
s_waitcnt vmcnt(4)
s_add_u32 s43, s63, 0
s_add_u32 s40, s44, 8192
s_mov_b32 s41, 5
M_ld_185:
s_mov_b32 m0, s40
s_add_u32 s40, s40, 4096
s_cmp_ge_u32 s40, 159744
s_cselect_b32 s42, 159744, 0
s_sub_u32 s40, s40, s42
s_waitcnt vmcnt(7)
buffer_load_dwordx4 v1, s[4:7], s43 offen sc1 lds
s_add_u32 s43, s43, 4096
s_sub_u32 s41, s41, 1
s_cmp_lg_u32 s41, 0
s_cbranch_scc1 M_ld_185
s_waitcnt vmcnt(5)
s_cmp_ge_u32 s33, 6
s_cbranch_scc1 M_pb_186
s_mov_b32 s33, 6
ds_add_u32 v250, v251 offset:4
M_pb_186:
s_add_u32 s43, s63, 20480
s_add_u32 s40, s44, 28672
s_mov_b32 s41, 5
M_ld_187:
s_mov_b32 m0, s40
s_add_u32 s40, s40, 4096
s_cmp_ge_u32 s40, 159744
s_cselect_b32 s42, 159744, 0
s_sub_u32 s40, s40, s42
s_waitcnt vmcnt(7)
buffer_load_dwordx4 v1, s[4:7], s43 offen sc1 lds
s_add_u32 s43, s43, 4096
s_sub_u32 s41, s41, 1
s_cmp_lg_u32 s41, 0
s_cbranch_scc1 M_ld_187
s_waitcnt vmcnt(5)
s_sub_u32 s35, s31, 0x8080808
s_and_b32 s35, s35, s82
s_cmp_eq_u32 s35, s82
s_cbranch_scc1 M_go_188
ds_read_b32 v253, v252 offset:4
s_waitcnt lgkmcnt(0)
v_readfirstlane_b32 s31, v253
s_nop 0
s_sub_u32 s35, s31, 0x8080808
s_and_b32 s35, s35, s82
s_cmp_eq_u32 s35, s82
s_cbranch_scc1 M_go_188
s_waitcnt vmcnt(0)
M_fs_189:
ds_read_b32 v253, v252 offset:4
s_cmp_eq_u32 s22, 0
s_cbranch_scc1 M_go_188
s_sub_u32 s22, s22, 1
s_waitcnt lgkmcnt(0)
v_readfirstlane_b32 s31, v253
s_nop 0
s_sub_u32 s35, s31, 0x8080808
s_and_b32 s35, s35, s82
s_cmp_eq_u32 s35, s82
s_cbranch_scc1 M_go_188

s_branch M_fs_189
M_go_188:
s_add_u32 s43, s63, 40960
s_add_u32 s40, s44, 49152
s_mov_b32 s41, 5
M_ld_190:
s_mov_b32 m0, s40
s_add_u32 s40, s40, 4096
s_cmp_ge_u32 s40, 159744
s_cselect_b32 s42, 159744, 0
s_sub_u32 s40, s40, s42
s_waitcnt vmcnt(7)
buffer_load_dwordx4 v1, s[4:7], s43 offen sc1 lds
s_add_u32 s43, s43, 4096
s_sub_u32 s41, s41, 1
s_cmp_lg_u32 s41, 0
s_cbranch_scc1 M_ld_190
s_waitcnt vmcnt(5)
s_sub_u32 s35, s31, 0x9090909
s_and_b32 s35, s35, s82
s_cmp_eq_u32 s35, s82
s_cbranch_scc1 M_go_191
ds_read_b32 v253, v252 offset:4
s_waitcnt lgkmcnt(0)
v_readfirstlane_b32 s31, v253
s_nop 0
s_sub_u32 s35, s31, 0x9090909
s_and_b32 s35, s35, s82
s_cmp_eq_u32 s35, s82
s_cbranch_scc1 M_go_191
s_waitcnt vmcnt(0)
M_fs_192:
ds_read_b32 v253, v252 offset:4
s_cmp_eq_u32 s22, 0
s_cbranch_scc1 M_go_191
s_sub_u32 s22, s22, 1
s_waitcnt lgkmcnt(0)
v_readfirstlane_b32 s31, v253
s_nop 0
s_sub_u32 s35, s31, 0x9090909
s_and_b32 s35, s35, s82
s_cmp_eq_u32 s35, s82
s_cbranch_scc1 M_go_191

s_branch M_fs_192
M_go_191:
s_add_u32 s43, s63, 61440
s_add_u32 s40, s44, 69632
s_mov_b32 s41, 5
M_ld_193:
s_mov_b32 m0, s40
s_add_u32 s40, s40, 4096
s_cmp_ge_u32 s40, 159744
s_cselect_b32 s42, 159744, 0
s_sub_u32 s40, s40, s42
s_waitcnt vmcnt(7)
buffer_load_dwordx4 v1, s[4:7], s43 offen sc1 lds
s_add_u32 s43, s43, 4096
s_sub_u32 s41, s41, 1
s_cmp_lg_u32 s41, 0
s_cbranch_scc1 M_ld_193
s_waitcnt vmcnt(5)
s_sub_u32 s35, s31, 0xa0a0a0a
s_and_b32 s35, s35, s82
s_cmp_eq_u32 s35, s82
s_cbranch_scc1 M_go_194
ds_read_b32 v253, v252 offset:4
s_waitcnt lgkmcnt(0)
v_readfirstlane_b32 s31, v253
s_nop 0
s_sub_u32 s35, s31, 0xa0a0a0a
s_and_b32 s35, s35, s82
s_cmp_eq_u32 s35, s82
s_cbranch_scc1 M_go_194
s_waitcnt vmcnt(0)
s_cmp_ge_u32 s33, 7
s_cbranch_scc1 M_pb_196
s_mov_b32 s33, 7
ds_add_u32 v250, v251 offset:4
M_pb_196:
M_fs_195:
ds_read_b32 v253, v252 offset:4
s_cmp_eq_u32 s22, 0
s_cbranch_scc1 M_go_194
s_sub_u32 s22, s22, 1
s_waitcnt lgkmcnt(0)
v_readfirstlane_b32 s31, v253
s_nop 0
s_sub_u32 s35, s31, 0xa0a0a0a
s_and_b32 s35, s35, s82
s_cmp_eq_u32 s35, s82
s_cbranch_scc1 M_go_194

s_branch M_fs_195
M_go_194:
s_add_u32 s43, s63, 81920
s_add_u32 s40, s44, 90112
s_mov_b32 s41, 5
M_ld_197:
s_mov_b32 m0, s40
s_add_u32 s40, s40, 4096
s_cmp_ge_u32 s40, 159744
s_cselect_b32 s42, 159744, 0
s_sub_u32 s40, s40, s42
s_waitcnt vmcnt(7)
buffer_load_dwordx4 v1, s[4:7], s43 offen sc1 lds
s_add_u32 s43, s43, 4096
s_sub_u32 s41, s41, 1
s_cmp_lg_u32 s41, 0
s_cbranch_scc1 M_ld_197
s_waitcnt vmcnt(5)
s_cmp_ge_u32 s33, 7
s_cbranch_scc1 M_pb_198
s_mov_b32 s33, 7
ds_add_u32 v250, v251 offset:4
M_pb_198:
s_sub_u32 s35, s31, 0xb0b0b0b
s_and_b32 s35, s35, s82
s_cmp_eq_u32 s35, s82
s_cbranch_scc1 M_go_199
ds_read_b32 v253, v252 offset:4
s_waitcnt lgkmcnt(0)
v_readfirstlane_b32 s31, v253
s_nop 0
s_sub_u32 s35, s31, 0xb0b0b0b
s_and_b32 s35, s35, s82
s_cmp_eq_u32 s35, s82
s_cbranch_scc1 M_go_199
s_waitcnt vmcnt(0)
M_fs_200:
ds_read_b32 v253, v252 offset:4
s_cmp_eq_u32 s22, 0
s_cbranch_scc1 M_go_199
s_sub_u32 s22, s22, 1
s_waitcnt lgkmcnt(0)
v_readfirstlane_b32 s31, v253
s_nop 0
s_sub_u32 s35, s31, 0xb0b0b0b
s_and_b32 s35, s35, s82
s_cmp_eq_u32 s35, s82
s_cbranch_scc1 M_go_199

s_branch M_fs_200
M_go_199:
s_add_u32 s43, s63, 102400
s_add_u32 s40, s44, 110592
s_mov_b32 s41, 5
M_ld_201:
s_mov_b32 m0, s40
s_add_u32 s40, s40, 4096
s_cmp_ge_u32 s40, 159744
s_cselect_b32 s42, 159744, 0
s_sub_u32 s40, s40, s42
s_waitcnt vmcnt(7)
buffer_load_dwordx4 v1, s[4:7], s43 offen sc1 lds
s_add_u32 s43, s43, 4096
s_sub_u32 s41, s41, 1
s_cmp_lg_u32 s41, 0
s_cbranch_scc1 M_ld_201
s_waitcnt vmcnt(5)
s_sub_u32 s35, s31, 0xc0c0c0c
s_and_b32 s35, s35, s82
s_cmp_eq_u32 s35, s82
s_cbranch_scc1 M_go_202
ds_read_b32 v253, v252 offset:4
s_waitcnt lgkmcnt(0)
v_readfirstlane_b32 s31, v253
s_nop 0
s_sub_u32 s35, s31, 0xc0c0c0c
s_and_b32 s35, s35, s82
s_cmp_eq_u32 s35, s82
s_cbranch_scc1 M_go_202
s_waitcnt vmcnt(0)
s_cmp_ge_u32 s33, 8
s_cbranch_scc1 M_pb_204
s_mov_b32 s33, 8
ds_add_u32 v250, v251 offset:4
M_pb_204:
M_fs_203:
ds_read_b32 v253, v252 offset:4
s_cmp_eq_u32 s22, 0
s_cbranch_scc1 M_go_202
s_sub_u32 s22, s22, 1
s_waitcnt lgkmcnt(0)
v_readfirstlane_b32 s31, v253
s_nop 0
s_sub_u32 s35, s31, 0xc0c0c0c
s_and_b32 s35, s35, s82
s_cmp_eq_u32 s35, s82
s_cbranch_scc1 M_go_202

s_branch M_fs_203
M_go_202:
s_add_u32 s43, s63, 122880
s_add_u32 s40, s44, 131072
s_mov_b32 s41, 5
M_ld_205:
s_mov_b32 m0, s40
s_add_u32 s40, s40, 4096
s_cmp_ge_u32 s40, 159744
s_cselect_b32 s42, 159744, 0
s_sub_u32 s40, s40, s42
s_waitcnt vmcnt(7)
buffer_load_dwordx4 v1, s[4:7], s43 offen sc1 lds
s_add_u32 s43, s43, 4096
s_sub_u32 s41, s41, 1
s_cmp_lg_u32 s41, 0
s_cbranch_scc1 M_ld_205
s_waitcnt vmcnt(5)
s_cmp_ge_u32 s33, 8
s_cbranch_scc1 M_pb_206
s_mov_b32 s33, 8
ds_add_u32 v250, v251 offset:4
M_pb_206:
s_add_u32 s43, s63, 143360
s_add_u32 s40, s44, 151552
s_mov_b32 s41, 4
M_ld_207:
s_mov_b32 m0, s40
s_add_u32 s40, s40, 4096
s_cmp_ge_u32 s40, 159744
s_cselect_b32 s42, 159744, 0
s_sub_u32 s40, s40, s42
s_waitcnt vmcnt(7)
buffer_load_dwordx4 v1, s[4:7], s43 offen sc1 lds
s_add_u32 s43, s43, 4096
s_sub_u32 s41, s41, 1
s_cmp_lg_u32 s41, 0
s_cbranch_scc1 M_ld_207
s_waitcnt vmcnt(4)
s_sub_u32 s35, s31, 0xe0e0e0e
s_and_b32 s35, s35, s82
s_cmp_eq_u32 s35, s82
s_cbranch_scc1 M_go_208
ds_read_b32 v253, v252 offset:4
s_waitcnt lgkmcnt(0)
v_readfirstlane_b32 s31, v253
s_nop 0
s_sub_u32 s35, s31, 0xe0e0e0e
s_and_b32 s35, s35, s82
s_cmp_eq_u32 s35, s82
s_cbranch_scc1 M_go_208
s_waitcnt vmcnt(0)
s_cmp_ge_u32 s33, 9
s_cbranch_scc1 M_pb_210
s_mov_b32 s33, 9
ds_add_u32 v250, v251 offset:4
M_pb_210:
M_fs_209:
ds_read_b32 v253, v252 offset:4
s_cmp_eq_u32 s22, 0
s_cbranch_scc1 M_go_208
s_sub_u32 s22, s22, 1
s_waitcnt lgkmcnt(0)
v_readfirstlane_b32 s31, v253
s_nop 0
s_sub_u32 s35, s31, 0xe0e0e0e
s_and_b32 s35, s35, s82
s_cmp_eq_u32 s35, s82
s_cbranch_scc1 M_go_208

s_branch M_fs_209
M_go_208:
s_add_u32 s43, s63, 159744
s_add_u32 s40, s44, 8192
s_mov_b32 s41, 5
M_ld_211:
s_mov_b32 m0, s40
s_add_u32 s40, s40, 4096
s_cmp_ge_u32 s40, 159744
s_cselect_b32 s42, 159744, 0
s_sub_u32 s40, s40, s42
s_waitcnt vmcnt(7)
buffer_load_dwordx4 v1, s[4:7], s43 offen sc1 lds
s_add_u32 s43, s43, 4096
s_sub_u32 s41, s41, 1
s_cmp_lg_u32 s41, 0
s_cbranch_scc1 M_ld_211
s_waitcnt vmcnt(5)
s_cmp_ge_u32 s33, 9
s_cbranch_scc1 M_pb_212
s_mov_b32 s33, 9
ds_add_u32 v250, v251 offset:4
M_pb_212:
s_sub_u32 s35, s31, 0x10101010
s_and_b32 s35, s35, s82
s_cmp_eq_u32 s35, s82
s_cbranch_scc1 M_go_213
ds_read_b32 v253, v252 offset:4
s_waitcnt lgkmcnt(0)
v_readfirstlane_b32 s31, v253
s_nop 0
s_sub_u32 s35, s31, 0x10101010
s_and_b32 s35, s35, s82
s_cmp_eq_u32 s35, s82
s_cbranch_scc1 M_go_213
s_waitcnt vmcnt(0)
M_fs_214:
ds_read_b32 v253, v252 offset:4
s_cmp_eq_u32 s22, 0
s_cbranch_scc1 M_go_213
s_sub_u32 s22, s22, 1
s_waitcnt lgkmcnt(0)
v_readfirstlane_b32 s31, v253
s_nop 0
s_sub_u32 s35, s31, 0x10101010
s_and_b32 s35, s35, s82
s_cmp_eq_u32 s35, s82
s_cbranch_scc1 M_go_213

s_branch M_fs_214
M_go_213:
s_add_u32 s43, s63, 180224
s_add_u32 s40, s44, 28672
s_mov_b32 s41, 5
M_ld_215:
s_mov_b32 m0, s40
s_add_u32 s40, s40, 4096
s_cmp_ge_u32 s40, 159744
s_cselect_b32 s42, 159744, 0
s_sub_u32 s40, s40, s42
s_waitcnt vmcnt(7)
buffer_load_dwordx4 v1, s[4:7], s43 offen sc1 lds
s_add_u32 s43, s43, 4096
s_sub_u32 s41, s41, 1
s_cmp_lg_u32 s41, 0
s_cbranch_scc1 M_ld_215
s_waitcnt vmcnt(5)
s_sub_u32 s35, s31, 0x11111111
s_and_b32 s35, s35, s82
s_cmp_eq_u32 s35, s82
s_cbranch_scc1 M_go_216
ds_read_b32 v253, v252 offset:4
s_waitcnt lgkmcnt(0)
v_readfirstlane_b32 s31, v253
s_nop 0
s_sub_u32 s35, s31, 0x11111111
s_and_b32 s35, s35, s82
s_cmp_eq_u32 s35, s82
s_cbranch_scc1 M_go_216
s_waitcnt vmcnt(0)
M_fs_217:
ds_read_b32 v253, v252 offset:4
s_cmp_eq_u32 s22, 0
s_cbranch_scc1 M_go_216
s_sub_u32 s22, s22, 1
s_waitcnt lgkmcnt(0)
v_readfirstlane_b32 s31, v253
s_nop 0
s_sub_u32 s35, s31, 0x11111111
s_and_b32 s35, s35, s82
s_cmp_eq_u32 s35, s82
s_cbranch_scc1 M_go_216

s_branch M_fs_217
M_go_216:
s_add_u32 s43, s63, 200704
s_add_u32 s40, s44, 49152
s_mov_b32 s41, 1
M_ld_218:
s_mov_b32 m0, s40
s_add_u32 s40, s40, 4096
s_cmp_ge_u32 s40, 159744
s_cselect_b32 s42, 159744, 0
s_sub_u32 s40, s40, s42
s_waitcnt vmcnt(7)
buffer_load_dwordx4 v1, s[4:7], s43 offen sc1 lds
s_add_u32 s43, s43, 4096
s_sub_u32 s41, s41, 1
s_cmp_lg_u32 s41, 0
s_cbranch_scc1 M_ld_218
s_waitcnt vmcnt(1)
s_sub_u32 s35, s31, 0x13131313
s_and_b32 s35, s35, s82
s_cmp_eq_u32 s35, s82
s_cbranch_scc1 M_go_219
ds_read_b32 v253, v252 offset:4
s_waitcnt lgkmcnt(0)
v_readfirstlane_b32 s31, v253
s_nop 0
s_sub_u32 s35, s31, 0x13131313
s_and_b32 s35, s35, s82
s_cmp_eq_u32 s35, s82
s_cbranch_scc1 M_go_219
s_waitcnt vmcnt(0)
s_cmp_ge_u32 s33, 10
s_cbranch_scc1 M_pb_221
s_mov_b32 s33, 10
ds_add_u32 v250, v251 offset:4
M_pb_221:
M_fs_220:
ds_read_b32 v253, v252 offset:4
s_cmp_eq_u32 s22, 0
s_cbranch_scc1 M_go_219
s_sub_u32 s22, s22, 1
s_waitcnt lgkmcnt(0)
v_readfirstlane_b32 s31, v253
s_nop 0
s_sub_u32 s35, s31, 0x13131313
s_and_b32 s35, s35, s82
s_cmp_eq_u32 s35, s82
s_cbranch_scc1 M_go_219

s_branch M_fs_220
M_go_219:
s_add_u32 s43, s63, 204800
s_add_u32 s40, s44, 53248
s_mov_b32 s41, 5
M_ld_222:
s_mov_b32 m0, s40
s_add_u32 s40, s40, 4096
s_cmp_ge_u32 s40, 159744
s_cselect_b32 s42, 159744, 0
s_sub_u32 s40, s40, s42
s_waitcnt vmcnt(7)
buffer_load_dwordx4 v1, s[4:7], s43 offen sc1 lds
s_add_u32 s43, s43, 4096
s_sub_u32 s41, s41, 1
s_cmp_lg_u32 s41, 0
s_cbranch_scc1 M_ld_222
s_waitcnt vmcnt(5)
s_cmp_ge_u32 s33, 10
s_cbranch_scc1 M_pb_223
s_mov_b32 s33, 10
ds_add_u32 v250, v251 offset:4
M_pb_223:
s_sub_u32 s35, s31, 0x15151515
s_and_b32 s35, s35, s82
s_cmp_eq_u32 s35, s82
s_cbranch_scc1 M_go_224
ds_read_b32 v253, v252 offset:4
s_waitcnt lgkmcnt(0)
v_readfirstlane_b32 s31, v253
s_nop 0
s_sub_u32 s35, s31, 0x15151515
s_and_b32 s35, s35, s82
s_cmp_eq_u32 s35, s82
s_cbranch_scc1 M_go_224
s_waitcnt vmcnt(0)
M_fs_225:
ds_read_b32 v253, v252 offset:4
s_cmp_eq_u32 s22, 0
s_cbranch_scc1 M_go_224
s_sub_u32 s22, s22, 1
s_waitcnt lgkmcnt(0)
v_readfirstlane_b32 s31, v253
s_nop 0
s_sub_u32 s35, s31, 0x15151515
s_and_b32 s35, s35, s82
s_cmp_eq_u32 s35, s82
s_cbranch_scc1 M_go_224

s_branch M_fs_225
M_go_224:
s_add_u32 s43, s63, 225280
s_add_u32 s40, s44, 73728
s_mov_b32 s41, 5
M_ld_226:
s_mov_b32 m0, s40
s_add_u32 s40, s40, 4096
s_cmp_ge_u32 s40, 159744
s_cselect_b32 s42, 159744, 0
s_sub_u32 s40, s40, s42
s_waitcnt vmcnt(7)
buffer_load_dwordx4 v1, s[4:7], s43 offen sc1 lds
s_add_u32 s43, s43, 4096
s_sub_u32 s41, s41, 1
s_cmp_lg_u32 s41, 0
s_cbranch_scc1 M_ld_226
s_waitcnt vmcnt(5)
s_waitcnt vmcnt(0)
s_cmp_ge_u32 s33, 11
s_cbranch_scc1 M_pb_227
s_mov_b32 s33, 11
ds_add_u32 v250, v251 offset:4
M_pb_227:
s_lshl_b32 s36, s2, 2
s_add_u32 s36, s36, s18
s_cmp_lg_u32 s36, 0
s_cbranch_scc1 M_ncl
s_load_dwordx2 s[36:37], s[0:1], 96
v_mov_b32 v7, 0
s_waitcnt lgkmcnt(0)
s_mov_b32 s8, s36
s_and_b32 s9, s37, 0xffff
s_mov_b32 s10, 0x100
s_mov_b32 s11, 0x00020000
buffer_store_dword v7, off, s[8:11], 0
M_ncl:
M_end:
s_endpgm
code_end:
.section .rodata,"a"
.p2align 6
.amdhsa_kernel interleave_layers__ssm_conv_h3__mixer_s_mlp__prompt_kernel
  .amdhsa_next_free_vgpr 256
  .amdhsa_next_free_sgpr 102
  .amdhsa_accum_offset 256
  .amdhsa_group_segment_fixed_size 0
  .amdhsa_kernarg_size 112
  .amdhsa_user_sgpr_count 2
  .amdhsa_user_sgpr_kernarg_segment_ptr 1
  .amdhsa_system_sgpr_workgroup_id_x 1
.end_amdhsa_kernel
```
